```python
import torch

def _softmax(x, axis=-1):
    return torch.softmax(x, dim=axis)
def _gelu(x):
    return torch.nn.functional.gelu(x, approximate="tanh")
def _silu(x):
    return torch.nn.functional.silu(x)
def _sigmoid(x):
    return torch.sigmoid(x)
def _layernorm(x, axis=-1, eps=1e-5):
    m = x.mean(dim=axis, keepdim=True)
    v = x.var(dim=axis, keepdim=True, unbiased=False)
    return (x - m) / torch.sqrt(v + eps)
def _scatter_add(tgt, idx, src, axis=0):
    return tgt.clone().index_add_(axis, idx, src)
def _segment_sum(src, seg, n):
    out = torch.zeros((n,) + src.shape[1:], dtype=src.dtype)
    return out.index_add_(0, seg, src)
def _pad(x, pw):
    flat = tuple(v for pair in reversed(pw) for v in pair)
    return torch.nn.functional.pad(x, flat)

kernel_name = 'parallel_sum__linear_kernel_hedgehog__glu_gated_glu__prompt'

def setup_inputs():

    _w = (lambda a: (lambda t: t.to(torch.bfloat16) if t.is_floating_point() else t)(torch.as_tensor(a)))
    def _A_setup():
        B, S, D, H = 1, 2048, 512, 32
        Dh = D // H
        return {
            "x": _w((lambda *s: torch.randn(*s, dtype=torch.bfloat16) * 0.05)(B, S, D)),
            "wqkv": _w((lambda *s: torch.randn(*s, dtype=torch.bfloat16) * 0.4)(D, 3 * D)),
            "w_phi": _w((lambda *s: torch.randn(*s, dtype=torch.bfloat16) * 0.4)(H, Dh, Dh) * (Dh ** -0.5)),
            "wo": _w((lambda *s: torch.randn(*s, dtype=torch.bfloat16) * 0.1)(D, D)),
        }
    _A_in = _A_setup()

    def _B_setup():
        B, S, D, F = 1, 2048, 512, 1376
        return {
            "x": _w((lambda *s: torch.randn(*s, dtype=torch.bfloat16) * 0.05)(B, S, D)),
            "w_gate": _w((lambda *s: torch.randn(*s, dtype=torch.bfloat16) * 0.05)(D, F)),
            "w_up": _w((lambda *s: torch.randn(*s, dtype=torch.bfloat16) * 0.05)(D, F)),
            "w_down": _w((lambda *s: torch.randn(*s, dtype=torch.bfloat16) * 0.05)(F, D)),
        }
    _B_in = _B_setup()

    return {
        "A_x": _A_in["x"],
        "A_wqkv": _A_in["wqkv"],
        "A_w_phi": _A_in["w_phi"],
        "A_wo": _A_in["wo"],
        "B_x": _B_in["x"],
        "B_w_gate": _B_in["w_gate"],
        "B_w_up": _B_in["w_up"],
        "B_w_down": _B_in["w_down"],
    }

def reference(A_x, A_wqkv, A_w_phi, A_wo, B_x, B_w_gate, B_w_up, B_w_down):
    def _A_ref(x, wqkv, w_phi, wo):
        B, S, D = x.shape
        H = 32; Dh = D // H
        qkv = (lambda x, *d: x.permute(*d))((x @ wqkv).reshape(B, S, 3, H, Dh), 2, 0, 3, 1, 4)
        q, k, v = qkv[0], qkv[1], qkv[2]
        pq = torch.einsum("bhsd,hdf->bhsf", q, w_phi)
        pk = torch.einsum("bhsd,hdf->bhsf", k, w_phi)
        phi_q = torch.concatenate([_softmax(pq, axis=-1), _softmax(-pq, axis=-1)], axis=-1)
        phi_k = torch.concatenate([_softmax(pk, axis=-1), _softmax(-pk, axis=-1)], axis=-1)
        kv = torch.einsum("bhsf,bhsd->bhfd", phi_k, v)
        z  = torch.einsum("bhsf->bhf", phi_k)
        num = torch.einsum("bhqf,bhfd->bhqd", phi_q, kv)
        den = torch.einsum("bhqf,bhf->bhq", phi_q, z)[..., None] + 1e-6
        o = num / den
        return (lambda x, *d: x.permute(*d))(o, 0, 2, 1, 3).reshape(B, S, D) @ wo

    def _B_ref(x, w_gate, w_up, w_down):
        g = torch.einsum("bsd,df->bsf", x, w_gate)
        u = torch.einsum("bsd,df->bsf", x, w_up)
        h = _sigmoid(g) * u
        return torch.einsum("bsf,fd->bsd", h, w_down)

    x = A_x
    xn = _layernorm(x, axis=-1)
    return x + _A_ref(xn, A_wqkv, A_w_phi, A_wo) + _B_ref(xn, B_w_gate, B_w_up, B_w_down)
```

```asm
; @launch grid=(256,1,1) block=(512,1,1) lds=163840
.amdgcn_target "amdgcn-amd-amdhsa--gfx950"
.text
.globl parallel_sum__linear_kernel_hedgehog__glu_gated_glu__prompt_kernel
.p2align 12
.p2align 8
.type parallel_sum__linear_kernel_hedgehog__glu_gated_glu__prompt_kernel,@function
parallel_sum__linear_kernel_hedgehog__glu_gated_glu__prompt_kernel:
  s_cmp_ge_u32 s2, 256
  s_cbranch_scc1 parallel_sum__linear_kernel_hedgehog__glu_gated_glu__prompt_kernel_end
  s_getpc_b64 s[100:101]
parallel_sum__linear_kernel_hedgehog__glu_gated_glu__prompt_kernel_pc:
  v_and_b32 v236, 15, v0
  v_bfe_u32 v237, v0, 4, 2
  v_lshlrev_b32 v236, 7, v236
  v_lshl_add_u32 v236, v237, 14, v236
  v_bfe_u32 v237, v0, 6, 1
  v_lshl_add_u32 v236, v237, 11, v236
  v_cmp_gt_u32 vcc, 128, v0
  s_nop 1
  s_cbranch_vccz parallel_sum__linear_kernel_hedgehog__glu_gated_glu__prompt_kernel_np
  global_load_dword v237, v236, s[100:101]
parallel_sum__linear_kernel_hedgehog__glu_gated_glu__prompt_kernel_np:
  s_load_dwordx2 s[56:57], s[0:1], 0
  s_load_dwordx2 s[36:37], s[0:1], 8
  s_load_dwordx4 s[40:43], s[0:1], 40
  s_load_dwordx2 s[70:71], s[0:1], 80
  s_load_dwordx2 s[28:29], s[0:1], 80
  s_load_dwordx2 s[32:33], s[0:1], 80
  s_load_dwordx2 s[44:45], s[0:1], 16
  s_load_dwordx2 s[52:53], s[0:1], 24
  s_load_dwordx2 s[48:49], s[0:1], 56
  s_load_dwordx2 s[60:61], s[0:1], 64
  v_lshrrev_b32 v12, 6, v0
  v_and_b32 v1, 63, v0
  v_readfirstlane_b32 s20, v12
  s_bfe_u32 s66, s2, 0x30003
  s_brev_b32 s65, s2
  s_bfe_u32 s65, s65, 0x20018
  s_and_b32 s21, s2, 1
  s_lshl_b32 s21, s21, 3
  s_add_u32 s21, s21, s66
  s_lshr_b32 s19, s66, 2
  s_and_b32 s18, s66, 3
  s_lshl_b32 s18, s18, 1
  s_and_b32 s25, s2, 6
  s_lshl1_add_u32 s25, s25, s65
  s_lshr_b32 s22, s25, 1
  s_and_b32 s67, s25, 1
  s_mul_i32 s26, s22, 11
  s_min_u32 s26, s26, 75
  s_and_b32 s66, s26, 1
  s_sub_u32 s68, 6, s67
  s_cmp_eq_u32 s66, s67
  s_cselect_b32 s68, s68, 0
  s_add_u32 s26, s26, s68
  s_and_b32 s23, s20, 1
  s_bfe_u32 s24, s20, 0x10001
  s_and_b32 s27, s20, 3
  s_mov_b32 s58, 0x200000
  s_mov_b32 s59, 0x20000
  s_mov_b32 s38, 0x180000
  s_mov_b32 s39, 0x20000
  s_lshr_b32 s66, s20, 2
  s_lshl1_add_u32 s66, s67, s66
  s_cmp_eq_u32 s66, 1
  s_cbranch_scc1 parallel_sum__linear_kernel_hedgehog__glu_gated_glu__prompt_kernel_r1
  s_cmp_eq_u32 s66, 3
  s_cbranch_scc1 parallel_sum__linear_kernel_hedgehog__glu_gated_glu__prompt_kernel_r3
  s_cmp_eq_u32 s66, 2
  s_cbranch_scc1 parallel_sum__linear_kernel_hedgehog__glu_gated_glu__prompt_kernel_r2
parallel_sum__linear_kernel_hedgehog__glu_gated_glu__prompt_kernel_r0:
  s_mov_b32 s30, 0x2000000
  s_mov_b32 s31, 0x20000
  s_mov_b32 s34, 0xac0000
  s_mov_b32 s35, 0x20000
  s_mov_b32 s46, 0x4000
  s_mov_b32 s47, 0x20000
  s_mov_b32 s54, 0x80000
  s_mov_b32 s55, 0x20000
  s_mov_b32 s50, 0x158000
  s_mov_b32 s51, 0x20000
  s_mov_b32 s62, 0x200000
  s_mov_b32 s63, 0x20000
  s_lshl4_add_u32 s17, s21, s25
  s_and_b32 s64, s2, 7
  s_bfe_u32 s66, s2, 0x20003
  s_lshl2_add_u32 s4, s64, s66
  s_lshr_b32 s5, s2, 5
  s_lshl2_add_u32 s64, s17, s27
  s_lshl_b32 s64, s64, 11
  v_lshrrev_b32 v157, 5, v1
  v_lshlrev_b32 v156, 4, v1
  v_lshl_add_u32 v156, v157, 9, v156
  s_waitcnt lgkmcnt(0)
  buffer_load_dwordx4 v[128:131], v156, s[56:59], s64 offen offset:0
  buffer_load_dwordx4 v[132:135], v156, s[56:59], s64 offen offset:512
  v_lshlrev_b32 v157, 3, v157
  s_mov_b32 s64, 0xaf0000
  s_load_dword s12, s[70:71], s64
  s_lshl_b32 s65, s24, 10
  s_add_u32 m0, s65, 156032
  s_lshl_b32 s64, s22, 11
  s_add_u32 s64, s64, s65
  v_lshlrev_b32 v12, 4, v1
  buffer_load_dwordx4 v12, s[44:47], s64 offen lds
  s_cmp_lg_u32 s20, 3
  s_cbranch_scc1 pf46
  s_getpc_b64 s[100:101]
pf46pc:
  s_bfe_u32 s64, s2, 0x30003
  s_lshl_b32 s64, s64, 13
  v_lshl_add_u32 v236, v1, 7, s64
  v_min_u32 v236, parallel_sum__linear_kernel_hedgehog__glu_gated_glu__prompt_kernel_end-parallel_sum__linear_kernel_hedgehog__glu_gated_glu__prompt_kernel, v236
  s_sub_u32 s100, s100, pf46pc-parallel_sum__linear_kernel_hedgehog__glu_gated_glu__prompt_kernel
  s_subb_u32 s101, s101, 0
  global_load_dword v237, v236, s[100:101]
pf46:
  s_branch parallel_sum__linear_kernel_hedgehog__glu_gated_glu__prompt_kernel_b0
parallel_sum__linear_kernel_hedgehog__glu_gated_glu__prompt_kernel_r2:
  s_mov_b32 s30, 0x2000000
  s_mov_b32 s31, 0x20000
  s_mov_b32 s34, 0xac0000
  s_mov_b32 s35, 0x20000
  s_mov_b32 s46, 0x4000
  s_mov_b32 s47, 0x20000
  s_mov_b32 s54, 0x80000
  s_mov_b32 s55, 0x20000
  s_mov_b32 s50, 0x158000
  s_mov_b32 s51, 0x20000
  s_mov_b32 s62, 0x200000
  s_mov_b32 s63, 0x20000
  s_lshl4_add_u32 s17, s21, s25
  s_and_b32 s64, s2, 7
  s_bfe_u32 s66, s2, 0x20003
  s_lshl2_add_u32 s4, s64, s66
  s_lshr_b32 s5, s2, 5
  s_lshl2_add_u32 s64, s17, s27
  s_lshl_b32 s64, s64, 11
  v_lshrrev_b32 v157, 5, v1
  v_lshlrev_b32 v156, 4, v1
  v_lshl_add_u32 v156, v157, 9, v156
  s_waitcnt lgkmcnt(0)
  buffer_load_dwordx4 v[128:131], v156, s[56:59], s64 offen offset:0
  buffer_load_dwordx4 v[132:135], v156, s[56:59], s64 offen offset:512
  v_lshlrev_b32 v157, 3, v157
  s_mov_b32 s64, 0xaf0000
  s_load_dword s12, s[70:71], s64
  s_lshl_b32 s65, s24, 10
  s_add_u32 m0, s65, 156032
  s_lshl_b32 s64, s22, 11
  s_add_u32 s64, s64, s65
  v_lshlrev_b32 v12, 4, v1
  buffer_load_dwordx4 v12, s[44:47], s64 offen lds
  s_cmp_lg_u32 s20, 3
  s_cbranch_scc1 pf52
  s_getpc_b64 s[100:101]
pf52pc:
  s_bfe_u32 s64, s2, 0x30003
  s_lshl_b32 s64, s64, 13
  v_lshl_add_u32 v236, v1, 7, s64
  v_min_u32 v236, parallel_sum__linear_kernel_hedgehog__glu_gated_glu__prompt_kernel_end-parallel_sum__linear_kernel_hedgehog__glu_gated_glu__prompt_kernel, v236
  s_sub_u32 s100, s100, pf52pc-parallel_sum__linear_kernel_hedgehog__glu_gated_glu__prompt_kernel
  s_subb_u32 s101, s101, 0
  global_load_dword v237, v236, s[100:101]
pf52:
  s_branch parallel_sum__linear_kernel_hedgehog__glu_gated_glu__prompt_kernel_b2
parallel_sum__linear_kernel_hedgehog__glu_gated_glu__prompt_kernel_r3:
  v_lshrrev_b32 v12, 3, v1
  v_and_b32 v13, 7, v1
  v_lshrrev_b32 v14, 4, v1
  s_lshl_b32 s64, s23, 2
  v_add_u32 v14, s64, v14
  v_xor_b32 v14, v14, v13
  v_lshlrev_b32 v14, 4, v14
  v_lshl_add_u32 v24, v12, 10, v14
  s_lshl_b32 s64, s21, 17
  s_lshl_b32 s65, s27, 13
  s_add_u32 s64, s64, s65
  v_add_u32 v24, s64, v24
  s_lshl_b32 s10, s27, 10
  v_lshlrev_b32 v14, 1, v12
  v_and_b32 v14, 4, v14
  v_xor_b32 v14, v14, v13
  v_lshlrev_b32 v14, 4, v14
  v_mul_u32_u24 v12, 3072, v12
  v_add_u32 v14, v14, v12
  s_mul_i32 s64, s27, 24576
  s_lshl_b32 s65, s22, 7
  s_add_u32 s64, s64, s65
  v_add_u32 v25, s64, v14
  s_add_u32 s9, s18, 0
  s_and_b32 s9, s9, 7
  s_lshl_b32 s8, s9, 7
  s_mul_i32 s9, s9, 196608
  s_add_u32 m0, s10, 49216
  s_add_u32 s7, s8, 0
  s_waitcnt lgkmcnt(0)
  buffer_load_dwordx4 v24, s[56:59], s7 offen lds
  s_add_u32 m0, s10, 53312
  s_add_u32 s7, s8, 32768
  buffer_load_dwordx4 v24, s[56:59], s7 offen lds
  s_mov_b32 s64, 0xaf0000
  s_load_dword s12, s[70:71], s64
  s_add_u32 m0, s10, 57408
  s_add_u32 s7, s8, 65536
  buffer_load_dwordx4 v24, s[56:59], s7 offen lds
  s_add_u32 m0, s10, 61504
  s_add_u32 s7, s8, 98304
  buffer_load_dwordx4 v24, s[56:59], s7 offen lds
  s_add_u32 m0, s10, 65600
  s_add_u32 s7, s9, 0
  buffer_load_dwordx4 v25, s[36:39], s7 offen lds
  s_add_u32 m0, s10, 69696
  s_add_u32 s7, s9, 98304
  buffer_load_dwordx4 v25, s[36:39], s7 offen lds
  s_mov_b32 s30, 0x2000000
  s_mov_b32 s31, 0x20000
  s_mov_b32 s34, 0xac0000
  s_mov_b32 s35, 0x20000
  s_mov_b32 s46, 0x4000
  s_mov_b32 s47, 0x20000
  s_mov_b32 s54, 0x80000
  s_mov_b32 s55, 0x20000
  s_add_u32 s9, s18, 1
  s_and_b32 s9, s9, 7
  s_lshl_b32 s8, s9, 7
  s_mul_i32 s9, s9, 196608
  s_add_u32 m0, s10, 73824
  s_add_u32 s7, s8, 0
  buffer_load_dwordx4 v24, s[56:59], s7 offen lds
  s_mov_b32 s50, 0x158000
  s_mov_b32 s51, 0x20000
  s_mov_b32 s62, 0x200000
  s_mov_b32 s63, 0x20000
  s_lshl4_add_u32 s17, s21, s25
  s_and_b32 s64, s2, 7
  s_bfe_u32 s66, s2, 0x20003
  s_lshl2_add_u32 s4, s64, s66
  s_add_u32 m0, s10, 77920
  s_add_u32 s7, s8, 32768
  buffer_load_dwordx4 v24, s[56:59], s7 offen lds
  s_lshr_b32 s5, s2, 5
  v_and_b32 v12, 31, v1
  v_bfe_u32 v13, v1, 1, 3
  v_lshrrev_b32 v14, 5, v1
  v_xor_b32 v13, v13, v14
  v_lshlrev_b32 v13, 4, v13
  v_lshl_add_u32 v13, v12, 7, v13
  s_lshl_b32 s64, s27, 12
  s_add_u32 m0, s10, 82016
  s_add_u32 s7, s8, 65536
  buffer_load_dwordx4 v24, s[56:59], s7 offen lds
  v_add_u32 v32, s64, v13
  v_xor_b32 v33, 32, v32
  v_xor_b32 v34, 64, v32
  v_xor_b32 v35, 96, v32
  v_add_u32 v36, 73824, v32
  v_add_u32 v37, 73824, v33
  v_add_u32 v38, 73824, v34
  v_add_u32 v39, 73824, v35
  s_add_u32 m0, s10, 86112
  s_add_u32 s7, s8, 98304
  buffer_load_dwordx4 v24, s[56:59], s7 offen lds
  v_lshrrev_b32 v14, 5, v1
  v_bfe_u32 v12, v1, 2, 2
  v_lshl_add_u32 v12, v14, 3, v12
  v_and_b32 v13, 3, v1
  v_lshlrev_b32 v13, 3, v13
  v_bfe_u32 v14, v1, 4, 1
  v_mul_u32_u24 v22, 192, v12
  v_mul_u32_u24 v15, 12320, v14
  s_add_u32 m0, s10, 90208
  s_add_u32 s7, s9, 0
  buffer_load_dwordx4 v25, s[36:39], s7 offen lds
  v_add3_u32 v22, v22, v13, v15
  v_add_u32 v21, 131328, v22
  v_add_u32 v23, 73824, v22
  v_and_b32 v12, 31, v1
  v_lshlrev_b32 v12, 3, v12
  s_lshl_b32 s64, s21, 2
  s_add_u32 s64, s64, s27
  s_lshl_b32 s64, s64, 8
  s_add_u32 m0, s10, 94304
  s_add_u32 s7, s9, 98304
  buffer_load_dwordx4 v25, s[36:39], s7 offen lds
  s_add_u32 s64, s64, 0x1780000
  v_add_u32 v46, s64, v12
  s_mov_b32 s15, 0x03020302
  s_mov_b32 s16, 0x01000100
  s_lshr_b32 s64, s21, 3
  s_lshl_b32 s64, s64, 4
  s_add_u32 s64, s64, s25
  s_mul_i32 s64, s64, 18432
  s_add_u32 s9, s18, 2
  s_and_b32 s9, s9, 7
  s_lshl_b32 s8, s9, 7
  s_mul_i32 s9, s9, 196608
  s_add_u32 m0, s10, 98432
  s_add_u32 s7, s8, 0
  buffer_load_dwordx4 v24, s[56:59], s7 offen lds
  s_add_u32 s11, s64, 0x1400000
  s_lshl_b32 s64, s27, 8
  s_add_u32 s64, s64, 160640
  v_lshlrev_b32 v16, 2, v1
  v_add_u32 v16, s64, v16
  v_and_b32 v17, 3, v1
  v_mul_u32_u24 v17, 260, v17
  v_add_u32 v17, 160640, v17
  s_add_u32 m0, s10, 102528
  s_add_u32 s7, s8, 32768
  buffer_load_dwordx4 v24, s[56:59], s7 offen lds
  v_mov_b32 v12, 0
  ds_write_b32 v16, v12 offset:0
  ds_write_b32 v16, v12 offset:1024
  s_lshl_b32 s64, s21, 2
  s_add_u32 s64, s64, s27
  s_lshl_b32 s64, s64, 11
  v_and_b32 v18, 56, v1
  v_add_u32 v18, v18, v1
  s_add_u32 m0, s10, 106624
  s_add_u32 s7, s8, 65536
  buffer_load_dwordx4 v24, s[56:59], s7 offen lds
  v_lshl_add_u32 v18, v18, 4, s64
  s_waitcnt lgkmcnt(0)
  s_mul_i32 s12, s12, 1664525
  s_add_u32 s12, s12, 1013904223
  s_add_u32 m0, s10, 110720
  s_add_u32 s7, s8, 98304
  buffer_load_dwordx4 v24, s[56:59], s7 offen lds
  s_add_u32 m0, s10, 114816
  s_add_u32 s7, s9, 0
  buffer_load_dwordx4 v25, s[36:39], s7 offen lds
  s_add_u32 m0, s10, 118912
  s_add_u32 s7, s9, 98304
  buffer_load_dwordx4 v25, s[36:39], s7 offen lds
  s_branch parallel_sum__linear_kernel_hedgehog__glu_gated_glu__prompt_kernel_b3
parallel_sum__linear_kernel_hedgehog__glu_gated_glu__prompt_kernel_r1:
  v_lshrrev_b32 v12, 3, v1
  v_and_b32 v13, 7, v1
  v_lshrrev_b32 v14, 4, v1
  s_lshl_b32 s64, s23, 2
  v_add_u32 v14, s64, v14
  v_xor_b32 v14, v14, v13
  v_lshlrev_b32 v14, 4, v14
  v_lshl_add_u32 v24, v12, 10, v14
  s_lshl_b32 s64, s21, 17
  s_lshl_b32 s65, s27, 13
  s_add_u32 s64, s64, s65
  v_add_u32 v24, s64, v24
  s_lshl_b32 s10, s27, 10
  v_lshlrev_b32 v14, 1, v12
  v_and_b32 v14, 4, v14
  v_xor_b32 v14, v14, v13
  v_lshlrev_b32 v14, 4, v14
  v_mul_u32_u24 v12, 3072, v12
  v_add_u32 v14, v14, v12
  s_mul_i32 s64, s27, 24576
  s_lshl_b32 s65, s22, 7
  s_add_u32 s64, s64, s65
  s_add_u32 s64, s64, 1024
  v_add_u32 v25, s64, v14
  v_xor_b32 v26, 32, v25
  v_add_u32 v26, 1024, v26
  s_add_u32 s9, s18, 0
  s_and_b32 s9, s9, 7
  s_lshl_b32 s8, s9, 7
  s_mul_i32 s9, s9, 196608
  s_add_u32 m0, s10, 0
  s_add_u32 s7, s8, 0
  s_waitcnt lgkmcnt(0)
  buffer_load_dwordx4 v24, s[56:59], s7 offen lds
  s_add_u32 m0, s10, 4096
  s_add_u32 s7, s8, 32768
  buffer_load_dwordx4 v24, s[56:59], s7 offen lds
  s_mov_b32 s64, 0xaf0000
  s_load_dword s12, s[70:71], s64
  s_add_u32 m0, s10, 8192
  s_add_u32 s7, s8, 65536
  buffer_load_dwordx4 v24, s[56:59], s7 offen lds
  s_add_u32 m0, s10, 12288
  s_add_u32 s7, s8, 98304
  buffer_load_dwordx4 v24, s[56:59], s7 offen lds
  s_add_u32 m0, s10, 16384
  s_add_u32 s7, s9, 0
  buffer_load_dwordx4 v25, s[36:39], s7 offen lds
  s_add_u32 m0, s10, 24576
  s_add_u32 s7, s9, 0
  buffer_load_dwordx4 v26, s[36:39], s7 offen lds
  s_add_u32 m0, s10, 20480
  s_add_u32 s7, s9, 98304
  buffer_load_dwordx4 v25, s[36:39], s7 offen lds
  s_add_u32 m0, s10, 28672
  s_add_u32 s7, s9, 98304
  buffer_load_dwordx4 v26, s[36:39], s7 offen lds
  s_mov_b32 s30, 0x2000000
  s_mov_b32 s31, 0x20000
  s_mov_b32 s34, 0xac0000
  s_mov_b32 s35, 0x20000
  s_mov_b32 s46, 0x4000
  s_mov_b32 s47, 0x20000
  s_mov_b32 s54, 0x80000
  s_mov_b32 s55, 0x20000
  s_add_u32 s9, s18, 1
  s_and_b32 s9, s9, 7
  s_lshl_b32 s8, s9, 7
  s_mul_i32 s9, s9, 196608
  s_add_u32 m0, s10, 32768
  s_add_u32 s7, s8, 0
  buffer_load_dwordx4 v24, s[56:59], s7 offen lds
  s_mov_b32 s50, 0x158000
  s_mov_b32 s51, 0x20000
  s_mov_b32 s62, 0x200000
  s_mov_b32 s63, 0x20000
  s_lshl4_add_u32 s17, s21, s25
  s_and_b32 s64, s2, 7
  s_bfe_u32 s66, s2, 0x20003
  s_lshl2_add_u32 s4, s64, s66
  s_add_u32 m0, s10, 36864
  s_add_u32 s7, s8, 32768
  buffer_load_dwordx4 v24, s[56:59], s7 offen lds
  s_lshr_b32 s5, s2, 5
  v_and_b32 v12, 31, v1
  v_bfe_u32 v13, v1, 1, 3
  v_lshrrev_b32 v14, 5, v1
  v_xor_b32 v13, v13, v14
  v_lshlrev_b32 v13, 4, v13
  v_lshl_add_u32 v13, v12, 7, v13
  s_lshl_b32 s64, s27, 12
  s_add_u32 m0, s10, 40960
  s_add_u32 s7, s8, 65536
  buffer_load_dwordx4 v24, s[56:59], s7 offen lds
  v_add_u32 v32, s64, v13
  v_xor_b32 v33, 32, v32
  v_xor_b32 v34, 64, v32
  v_xor_b32 v35, 96, v32
  v_add_u32 v36, 65536, v32
  v_add_u32 v37, 65536, v33
  v_add_u32 v38, 65536, v34
  v_add_u32 v39, 65536, v35
  s_add_u32 m0, s10, 45056
  s_add_u32 s7, s8, 98304
  buffer_load_dwordx4 v24, s[56:59], s7 offen lds
  v_lshrrev_b32 v14, 5, v1
  v_bfe_u32 v12, v1, 2, 2
  v_lshl_add_u32 v12, v14, 3, v12
  v_and_b32 v13, 3, v1
  v_lshlrev_b32 v13, 3, v13
  v_bfe_u32 v14, v1, 4, 1
  v_mul_u32_u24 v22, 160, v12
  v_mul_u32_u24 v15, 10368, v14
  s_add_u32 m0, s10, 49152
  s_add_u32 s7, s9, 0
  buffer_load_dwordx4 v25, s[36:39], s7 offen lds
  v_add3_u32 v22, v22, v13, v15
  v_add_u32 v21, 131328, v22
  v_add_u32 v23, 62208, v22
  v_and_b32 v12, 31, v1
  v_lshlrev_b32 v12, 3, v12
  s_lshl_b32 s64, s21, 2
  s_add_u32 s64, s64, s27
  s_lshl_b32 s64, s64, 8
  s_add_u32 m0, s10, 57344
  s_add_u32 s7, s9, 0
  buffer_load_dwordx4 v26, s[36:39], s7 offen lds
  s_add_u32 s64, s64, 0x1780000
  v_add_u32 v46, s64, v12
  s_mov_b32 s15, 0x03020302
  s_mov_b32 s16, 0x01000100
  s_lshr_b32 s64, s21, 3
  s_lshl_b32 s64, s64, 4
  s_add_u32 s64, s64, s25
  s_mul_i32 s64, s64, 18432
  s_add_u32 m0, s10, 53248
  s_add_u32 s7, s9, 98304
  buffer_load_dwordx4 v25, s[36:39], s7 offen lds
  s_add_u32 s11, s64, 0x1400000
  s_lshl_b32 s64, s27, 8
  s_add_u32 s64, s64, 160640
  v_lshlrev_b32 v16, 2, v1
  v_add_u32 v16, s64, v16
  v_and_b32 v17, 3, v1
  v_mul_u32_u24 v17, 260, v17
  v_add_u32 v17, 160640, v17
  s_add_u32 m0, s10, 61440
  s_add_u32 s7, s9, 98304
  buffer_load_dwordx4 v26, s[36:39], s7 offen lds
  v_mov_b32 v12, 0
  ds_write_b32 v16, v12 offset:0
  ds_write_b32 v16, v12 offset:1024
  s_lshl_b32 s64, s21, 2
  s_add_u32 s64, s64, s27
  s_lshl_b32 s64, s64, 11
  v_and_b32 v18, 56, v1
  v_add_u32 v18, v18, v1
  v_lshl_add_u32 v18, v18, 4, s64
  s_waitcnt lgkmcnt(0)
  s_mul_i32 s12, s12, 1664525
  s_add_u32 s12, s12, 1013904223
  s_waitcnt vmcnt(8)
  s_waitcnt lgkmcnt(0)
  s_barrier
  s_cmp_lg_u32 s19, 0
  s_cbranch_scc1 xj1_0
  ds_read_b128 v[128:131], v32 offset:0
  ds_read_b128 v[132:135], v33 offset:0
  ds_read_b128 v[136:139], v34 offset:0
  ds_read_b128 v[140:143], v35 offset:0
  s_branch xj1
xj1_0:
  ds_read_b128 v[240:243], v32 offset:0
  ds_read_b128 v[244:247], v33 offset:0
  ds_read_b128 v[248:251], v34 offset:0
  ds_read_b128 v[252:255], v35 offset:0
xj1:
  s_add_u32 s9, s18, 2
  s_and_b32 s9, s9, 7
  s_lshl_b32 s8, s9, 7
  s_mul_i32 s9, s9, 196608
  s_add_u32 m0, s10, 65536
  s_add_u32 s7, s8, 0
  buffer_load_dwordx4 v24, s[56:59], s7 offen lds
  s_add_u32 m0, s10, 69632
  s_add_u32 s7, s8, 32768
  buffer_load_dwordx4 v24, s[56:59], s7 offen lds
  s_add_u32 m0, s10, 73728
  s_add_u32 s7, s8, 65536
  buffer_load_dwordx4 v24, s[56:59], s7 offen lds
  s_add_u32 m0, s10, 77824
  s_add_u32 s7, s8, 98304
  buffer_load_dwordx4 v24, s[56:59], s7 offen lds
  s_add_u32 m0, s10, 81920
  s_add_u32 s7, s9, 0
  buffer_load_dwordx4 v25, s[36:39], s7 offen lds
  s_add_u32 m0, s10, 90112
  s_add_u32 s7, s9, 0
  buffer_load_dwordx4 v26, s[36:39], s7 offen lds
  s_add_u32 m0, s10, 86016
  s_add_u32 s7, s9, 98304
  buffer_load_dwordx4 v25, s[36:39], s7 offen lds
  s_add_u32 m0, s10, 94208
  s_add_u32 s7, s9, 98304
  buffer_load_dwordx4 v26, s[36:39], s7 offen lds
  s_waitcnt vmcnt(8)
  s_waitcnt lgkmcnt(0)
  s_barrier
  s_cmp_lg_u32 s19, 0
  s_cbranch_scc1 xj2_0
  ds_read_b128 v[144:147], v32 offset:32768
  ds_read_b128 v[148:151], v33 offset:32768
  ds_read_b128 v[152:155], v34 offset:32768
  ds_read_b128 v[156:159], v35 offset:32768
  s_branch xj2
xj2_0:
  ds_read_b128 v[128:131], v32 offset:32768
  ds_read_b128 v[132:135], v33 offset:32768
  ds_read_b128 v[136:139], v34 offset:32768
  ds_read_b128 v[140:143], v35 offset:32768
xj2:
  s_add_u32 s9, s18, 3
  s_and_b32 s9, s9, 7
  s_lshl_b32 s8, s9, 7
  s_mul_i32 s9, s9, 196608
  s_add_u32 m0, s10, 98304
  s_add_u32 s7, s8, 0
  buffer_load_dwordx4 v24, s[56:59], s7 offen lds
  s_add_u32 m0, s10, 102400
  s_add_u32 s7, s8, 32768
  buffer_load_dwordx4 v24, s[56:59], s7 offen lds
  s_add_u32 m0, s10, 106496
  s_add_u32 s7, s8, 65536
  buffer_load_dwordx4 v24, s[56:59], s7 offen lds
  s_add_u32 m0, s10, 110592
  s_add_u32 s7, s8, 98304
  buffer_load_dwordx4 v24, s[56:59], s7 offen lds
  s_add_u32 m0, s10, 114688
  s_add_u32 s7, s9, 0
  buffer_load_dwordx4 v25, s[36:39], s7 offen lds
  s_add_u32 m0, s10, 122880
  s_add_u32 s7, s9, 0
  buffer_load_dwordx4 v26, s[36:39], s7 offen lds
  s_add_u32 m0, s10, 118784
  s_add_u32 s7, s9, 98304
  buffer_load_dwordx4 v25, s[36:39], s7 offen lds
  s_add_u32 m0, s10, 126976
  s_add_u32 s7, s9, 98304
  buffer_load_dwordx4 v26, s[36:39], s7 offen lds
  s_waitcnt vmcnt(8)
  s_waitcnt lgkmcnt(0)
  s_barrier
  s_cmp_lg_u32 s19, 0
  s_cbranch_scc1 xj3_0
  ds_read_b128 v[160:163], v36 offset:0
  ds_read_b128 v[164:167], v37 offset:0
  ds_read_b128 v[168:171], v38 offset:0
  ds_read_b128 v[172:175], v39 offset:0
  s_branch xj3
xj3_0:
  ds_read_b128 v[144:147], v36 offset:0
  ds_read_b128 v[148:151], v37 offset:0
  ds_read_b128 v[152:155], v38 offset:0
  ds_read_b128 v[156:159], v39 offset:0
xj3:
  s_add_u32 s9, s18, 4
  s_and_b32 s9, s9, 7
  s_lshl_b32 s8, s9, 7
  s_mul_i32 s9, s9, 196608
  s_add_u32 m0, s10, 0
  s_add_u32 s7, s8, 0
  buffer_load_dwordx4 v24, s[56:59], s7 offen lds
  s_add_u32 m0, s10, 4096
  s_add_u32 s7, s8, 32768
  buffer_load_dwordx4 v24, s[56:59], s7 offen lds
  s_add_u32 m0, s10, 8192
  s_add_u32 s7, s8, 65536
  buffer_load_dwordx4 v24, s[56:59], s7 offen lds
  s_add_u32 m0, s10, 12288
  s_add_u32 s7, s8, 98304
  buffer_load_dwordx4 v24, s[56:59], s7 offen lds
  s_add_u32 m0, s10, 16384
  s_add_u32 s7, s9, 0
  buffer_load_dwordx4 v25, s[36:39], s7 offen lds
  s_add_u32 m0, s10, 24576
  s_add_u32 s7, s9, 0
  buffer_load_dwordx4 v26, s[36:39], s7 offen lds
  s_add_u32 m0, s10, 20480
  s_add_u32 s7, s9, 98304
  buffer_load_dwordx4 v25, s[36:39], s7 offen lds
  s_add_u32 m0, s10, 28672
  s_add_u32 s7, s9, 98304
  buffer_load_dwordx4 v26, s[36:39], s7 offen lds
  s_waitcnt vmcnt(8)
  s_waitcnt lgkmcnt(0)
  s_barrier
  s_cmp_lg_u32 s19, 0
  s_cbranch_scc1 xj4_0
  ds_read_b128 v[176:179], v36 offset:32768
  ds_read_b128 v[180:183], v37 offset:32768
  ds_read_b128 v[184:187], v38 offset:32768
  ds_read_b128 v[188:191], v39 offset:32768
  s_branch xj4
xj4_0:
  ds_read_b128 v[160:163], v36 offset:32768
  ds_read_b128 v[164:167], v37 offset:32768
  ds_read_b128 v[168:171], v38 offset:32768
  ds_read_b128 v[172:175], v39 offset:32768
xj4:
  s_add_u32 s9, s18, 5
  s_and_b32 s9, s9, 7
  s_lshl_b32 s8, s9, 7
  s_mul_i32 s9, s9, 196608
  s_add_u32 m0, s10, 32768
  s_add_u32 s7, s8, 0
  buffer_load_dwordx4 v24, s[56:59], s7 offen lds
  s_mul_i32 s64, s23, 88064
  s_lshl_b32 s65, s26, 5
  s_add_u32 s64, s64, s65
  v_add_u32 v12, 0, v1
  v_mul_u32_u24 v13, 6554, v12
  v_lshrrev_b32 v13, 16, v13
  v_mul_u32_u24 v13, 2592, v13
  v_lshl_add_u32 v13, v12, 4, v13
  s_add_u32 m0, s10, 36864
  s_add_u32 s7, s8, 32768
  buffer_load_dwordx4 v24, s[56:59], s7 offen lds
  v_add_u32 v8, s64, v13
  v_add_u32 v12, 64, v1
  v_mul_u32_u24 v13, 6554, v12
  v_lshrrev_b32 v13, 16, v13
  v_mul_u32_u24 v13, 2592, v13
  v_lshl_add_u32 v13, v12, 4, v13
  v_add_u32 v9, s64, v13
  v_add_u32 v12, 128, v1
  s_add_u32 m0, s10, 40960
  s_add_u32 s7, s8, 65536
  buffer_load_dwordx4 v24, s[56:59], s7 offen lds
  v_mul_u32_u24 v13, 6554, v12
  v_lshrrev_b32 v13, 16, v13
  v_mul_u32_u24 v13, 2592, v13
  v_lshl_add_u32 v13, v12, 4, v13
  v_add_u32 v10, s64, v13
  v_add_u32 v12, 192, v1
  v_mul_u32_u24 v13, 6554, v12
  v_lshrrev_b32 v13, 16, v13
  s_add_u32 m0, s10, 45056
  s_add_u32 s7, s8, 98304
  buffer_load_dwordx4 v24, s[56:59], s7 offen lds
  v_mul_u32_u24 v13, 2592, v13
  v_lshl_add_u32 v13, v12, 4, v13
  v_add_u32 v11, s64, v13
  v_add_u32 v12, 256, v1
  v_mul_u32_u24 v13, 6554, v12
  v_lshrrev_b32 v13, 16, v13
  v_mul_u32_u24 v13, 2592, v13
  v_lshl_add_u32 v13, v12, 4, v13
  s_add_u32 m0, s10, 49152
  s_add_u32 s7, s9, 0
  buffer_load_dwordx4 v25, s[36:39], s7 offen lds
  v_add_u32 v20, s64, v13
  s_mul_i32 s13, s24, 10368
  s_mul_i32 s64, s23, 5120
  s_add_u32 s13, s13, s64
  s_cmp_eq_u32 s24, 0
  s_cselect_b32 s40, s40, s42
  s_cselect_b32 s41, s41, s43
  s_mov_b32 s42, 0x158000
  s_add_u32 m0, s10, 57344
  s_add_u32 s7, s9, 0
  buffer_load_dwordx4 v26, s[36:39], s7 offen lds
  s_mov_b32 s43, 0x20000
  s_mul_i32 s44, s27, 360448
  s_add_u32 s45, s44, 262144
  s_min_u32 s45, s45, 1310720
  s_add_u32 s46, s44, 98304
  s_sub_u32 s47, s45, 81920
  s_mov_b32 s100, s12
  s_mov_b32 s101, s12
  s_add_u32 m0, s10, 53248
  s_add_u32 s7, s9, 98304
  buffer_load_dwordx4 v25, s[36:39], s7 offen lds
  s_lshl2_add_u32 s68, s4, s27
  s_lshl_b32 s68, s68, 12
  s_add_u32 s68, s68, 0xb80000
  s_lshl1_add_u32 s64, s21, s24
  s_lshr_b32 s65, s25, 2
  s_lshl2_add_u32 s64, s64, s65
  s_lshl_b32 s64, s64, 5
  s_and_b32 s65, s25, 3
  s_add_u32 m0, s10, 61440
  s_add_u32 s7, s9, 98304
  buffer_load_dwordx4 v26, s[36:39], s7 offen lds
  s_lshl1_add_u32 s65, s65, s23
  s_add_u32 s64, s64, s65
  s_lshl_b32 s64, s64, 7
  s_add_u32 s69, s64, 0xb80000
  s_lshl_b32 s6, s27, 11
  v_lshrrev_b32 v12, 3, v1
  v_and_b32 v13, 7, v1
  v_lshlrev_b32 v2, 1, v12
  v_and_b32 v2, 4, v2
  v_xor_b32 v2, v2, v13
  v_lshlrev_b32 v2, 4, v2
  v_lshl_add_u32 v2, v12, 10, v2
  s_lshl_b32 s64, s5, 7
  v_add_u32 v2, s64, v2
  v_lshlrev_b32 v6, 4, v13
  v_lshl_add_u32 v6, v12, 10, v6
  s_lshl_b32 s65, s4, 16
  s_add_u32 s64, s64, s65
  s_lshl_b32 s65, s20, 13
  s_add_u32 s64, s64, s65
  v_add_u32 v6, s64, v6
  s_lshl_b32 s64, s4, 12
  v_and_b32 v3, 56, v1
  v_add_u32 v3, v3, v1
  v_lshl_add_u32 v3, v3, 4, s64
  v_lshrrev_b32 v4, 5, v1
  v_lshlrev_b32 v4, 9, v4
  v_bfe_u32 v5, v1, 2, 2
  v_lshl_add_u32 v4, v5, 7, v4
  v_and_b32 v5, 8, v1
  v_lshl_add_u32 v4, v5, 3, v4
  v_and_b32 v5, 16, v1
  v_lshl_add_u32 v4, v5, 1, v4
  v_and_b32 v5, 3, v1
  v_lshl_add_u32 v4, v5, 3, v4
  v_add_u32 v4, s6, v4
  v_xor_b32 v5, 64, v4
  s_waitcnt vmcnt(8)
  s_waitcnt lgkmcnt(0)
  s_barrier
  s_cmp_lg_u32 s19, 0
  s_cbranch_scc1 xj5_0
  ds_read_b128 v[192:195], v32 offset:0
  ds_read_b128 v[196:199], v33 offset:0
  ds_read_b128 v[200:203], v34 offset:0
  ds_read_b128 v[204:207], v35 offset:0
  s_branch xj5
xj5_0:
  ds_read_b128 v[176:179], v32 offset:0
  ds_read_b128 v[180:183], v33 offset:0
  ds_read_b128 v[184:187], v34 offset:0
  ds_read_b128 v[188:191], v35 offset:0
xj5:
  s_add_u32 s9, s18, 6
  s_and_b32 s9, s9, 7
  s_lshl_b32 s8, s9, 7
  s_mul_i32 s9, s9, 196608
  s_add_u32 m0, s10, 65536
  s_add_u32 s7, s8, 0
  buffer_load_dwordx4 v24, s[56:59], s7 offen lds
  s_add_u32 m0, s10, 69632
  s_add_u32 s7, s8, 32768
  buffer_load_dwordx4 v24, s[56:59], s7 offen lds
  s_add_u32 m0, s10, 73728
  s_add_u32 s7, s8, 65536
  buffer_load_dwordx4 v24, s[56:59], s7 offen lds
  s_add_u32 m0, s10, 77824
  s_add_u32 s7, s8, 98304
  buffer_load_dwordx4 v24, s[56:59], s7 offen lds
  s_add_u32 m0, s10, 81920
  s_add_u32 s7, s9, 0
  buffer_load_dwordx4 v25, s[36:39], s7 offen lds
  s_add_u32 m0, s10, 90112
  s_add_u32 s7, s9, 0
  buffer_load_dwordx4 v26, s[36:39], s7 offen lds
  s_add_u32 m0, s10, 86016
  s_add_u32 s7, s9, 98304
  buffer_load_dwordx4 v25, s[36:39], s7 offen lds
  s_add_u32 m0, s10, 94208
  s_add_u32 s7, s9, 98304
  buffer_load_dwordx4 v26, s[36:39], s7 offen lds
  s_waitcnt vmcnt(8)
  s_waitcnt lgkmcnt(0)
  s_barrier
  s_cmp_lg_u32 s19, 0
  s_cbranch_scc1 xj6_0
  ds_read_b128 v[208:211], v32 offset:32768
  ds_read_b128 v[212:215], v33 offset:32768
  ds_read_b128 v[216:219], v34 offset:32768
  ds_read_b128 v[220:223], v35 offset:32768
  s_branch xj6
xj6_0:
  ds_read_b128 v[192:195], v32 offset:32768
  ds_read_b128 v[196:199], v33 offset:32768
  ds_read_b128 v[200:203], v34 offset:32768
  ds_read_b128 v[204:207], v35 offset:32768
xj6:
  buffer_load_dwordx2 v[124:125], v46, s[28:31], 0 offen sc1
  s_add_u32 s9, s18, 7
  s_and_b32 s9, s9, 7
  s_lshl_b32 s8, s9, 7
  s_mul_i32 s9, s9, 196608
  s_add_u32 m0, s10, 98304
  s_add_u32 s7, s8, 0
  buffer_load_dwordx4 v24, s[56:59], s7 offen lds
  s_add_u32 m0, s10, 102400
  s_add_u32 s7, s8, 32768
  buffer_load_dwordx4 v24, s[56:59], s7 offen lds
  s_add_u32 m0, s10, 106496
  s_add_u32 s7, s8, 65536
  buffer_load_dwordx4 v24, s[56:59], s7 offen lds
  s_add_u32 m0, s10, 110592
  s_add_u32 s7, s8, 98304
  buffer_load_dwordx4 v24, s[56:59], s7 offen lds
  s_add_u32 m0, s10, 114688
  s_add_u32 s7, s9, 0
  buffer_load_dwordx4 v25, s[36:39], s7 offen lds
  s_add_u32 m0, s10, 122880
  s_add_u32 s7, s9, 0
  buffer_load_dwordx4 v26, s[36:39], s7 offen lds
  s_add_u32 m0, s10, 118784
  s_add_u32 s7, s9, 98304
  buffer_load_dwordx4 v25, s[36:39], s7 offen lds
  s_add_u32 m0, s10, 126976
  s_add_u32 s7, s9, 98304
  buffer_load_dwordx4 v26, s[36:39], s7 offen lds
  s_waitcnt vmcnt(9)
  s_waitcnt lgkmcnt(0)
  s_barrier
  s_cmp_lg_u32 s19, 0
  s_cbranch_scc1 xj7_0
  ds_read_b128 v[224:227], v36 offset:0
  ds_read_b128 v[228:231], v37 offset:0
  ds_read_b128 v[232:235], v38 offset:0
  ds_read_b128 v[236:239], v39 offset:0
  s_branch xj7
xj7_0:
  ds_read_b128 v[208:211], v36 offset:0
  ds_read_b128 v[212:215], v37 offset:0
  ds_read_b128 v[216:219], v38 offset:0
  ds_read_b128 v[220:223], v39 offset:0
xj7:
  s_add_u32 s9, s18, s19
  s_add_u32 s9, s9, 0
  s_and_b32 s9, s9, 7
  s_mul_i32 s9, s9, 176128
  s_add_u32 m0, s13, 131328
  s_add_u32 s7, s9, 0
  buffer_load_dwordx4 v8, s[40:43], s7 offen lds
  s_add_u32 m0, s13, 132352
  s_add_u32 s7, s9, 0
  buffer_load_dwordx4 v9, s[40:43], s7 offen lds
  s_add_u32 m0, s13, 133376
  s_add_u32 s7, s9, 0
  buffer_load_dwordx4 v10, s[40:43], s7 offen lds
  s_add_u32 m0, s13, 134400
  s_add_u32 s7, s9, 0
  buffer_load_dwordx4 v11, s[40:43], s7 offen lds
  s_add_u32 m0, s13, 135424
  s_add_u32 s7, s9, 0
  buffer_load_dwordx4 v20, s[40:43], s7 offen lds
  s_add_u32 s9, s18, s19
  s_add_u32 s9, s9, 1
  s_and_b32 s9, s9, 7
  s_mul_i32 s9, s9, 176128
  s_add_u32 m0, s13, 0
  s_add_u32 s7, s9, 0
  buffer_load_dwordx4 v8, s[40:43], s7 offen lds
  s_add_u32 m0, s13, 1024
  s_add_u32 s7, s9, 0
  buffer_load_dwordx4 v9, s[40:43], s7 offen lds
  s_add_u32 m0, s13, 2048
  s_add_u32 s7, s9, 0
  buffer_load_dwordx4 v10, s[40:43], s7 offen lds
  s_waitcnt vmcnt(8)
  s_waitcnt lgkmcnt(0)
  s_barrier
  s_cmp_lg_u32 s19, 0
  s_cbranch_scc1 xj8_0
  ds_read_b128 v[240:243], v36 offset:32768
  ds_read_b128 v[244:247], v37 offset:32768
  ds_read_b128 v[248:251], v38 offset:32768
  ds_read_b128 v[252:255], v39 offset:32768
  s_branch xj8
xj8_0:
  ds_read_b128 v[224:227], v36 offset:32768
  ds_read_b128 v[228:231], v37 offset:32768
  ds_read_b128 v[232:235], v38 offset:32768
  ds_read_b128 v[236:239], v39 offset:32768
xj8:
  s_add_u32 m0, s13, 3072
  s_add_u32 s7, s9, 0
  buffer_load_dwordx4 v11, s[40:43], s7 offen lds
  s_add_u32 m0, s13, 4096
  s_add_u32 s7, s9, 0
  buffer_load_dwordx4 v20, s[40:43], s7 offen lds
  v_xor_b32 v12, s12, v125
  v_cmp_ne_u32 vcc, 0, v12
  s_nop 1
  s_cbranch_vccz gr9x
  s_mov_b32 s14, 0x40000
gr9:
  buffer_load_dwordx2 v[124:125], v46, s[28:31], 0 offen sc1
  s_sub_u32 s14, s14, 1
  s_waitcnt vmcnt(0)
  s_cbranch_scc1 gr9x
  v_xor_b32 v12, s12, v125
  v_cmp_ne_u32 vcc, 0, v12
  s_nop 1
  s_cbranch_vccnz gr9
gr9x:
  v_and_b32 v12, 31, v1
  v_lshlrev_b32 v12, 2, v12
  s_lshl_b32 s64, s27, 7
  s_add_u32 s64, s64, 160128
  v_add_u32 v12, s64, v12
  ds_write_b32 v12, v124
  v_mov_b32 v19, v124
  s_waitcnt vmcnt(5)
  s_waitcnt lgkmcnt(0)
  s_barrier
  s_setprio 2
  ds_read_b64_tr_b16 v[24:25], v21 offset:0
  ds_read_b64_tr_b16 v[26:27], v21 offset:640
  ds_read_b64_tr_b16 v[28:29], v21 offset:32
  ds_read_b64_tr_b16 v[30:31], v21 offset:672
  ds_read_b64_tr_b16 v[32:33], v21 offset:64
  ds_read_b64_tr_b16 v[34:35], v21 offset:704
  ds_read_b64_tr_b16 v[36:37], v21 offset:96
  ds_read_b64_tr_b16 v[38:39], v21 offset:736
  ds_read_b64_tr_b16 v[40:41], v21 offset:128
  ds_read_b64_tr_b16 v[42:43], v21 offset:768
  s_waitcnt lgkmcnt(8)
  v_mfma_f32_32x32x16_bf16 v[48:63], v[24:27], v[128:131], 0
  ds_read_b64_tr_b16 v[44:45], v21 offset:2560
  ds_read_b64_tr_b16 v[46:47], v21 offset:3200
  s_add_u32 s9, s18, s19
  s_add_u32 s9, s9, 2
  s_and_b32 s9, s9, 7
  s_mul_i32 s9, s9, 176128
  s_add_u32 m0, s13, 20736
  s_add_u32 s7, s9, 0
  s_waitcnt lgkmcnt(8)
  v_mfma_f32_32x32x16_bf16 v[64:79], v[28:31], v[128:131], 0
  ds_read_b64_tr_b16 v[24:25], v21 offset:2592
  ds_read_b64_tr_b16 v[26:27], v21 offset:3232
  buffer_load_dwordx4 v8, s[40:43], s7 offen lds
  s_waitcnt lgkmcnt(8)
  v_mfma_f32_32x32x16_bf16 v[80:95], v[32:35], v[128:131], 0
  ds_read_b64_tr_b16 v[28:29], v21 offset:2624
  ds_read_b64_tr_b16 v[30:31], v21 offset:3264
  s_add_u32 m0, s13, 21760
  s_add_u32 s7, s9, 0
  s_waitcnt lgkmcnt(8)
  v_mfma_f32_32x32x16_bf16 v[96:111], v[36:39], v[128:131], 0
  ds_read_b64_tr_b16 v[32:33], v21 offset:2656
  ds_read_b64_tr_b16 v[34:35], v21 offset:3296
  buffer_load_dwordx4 v9, s[40:43], s7 offen lds
  s_waitcnt lgkmcnt(8)
  v_mfma_f32_32x32x16_bf16 v[112:127], v[40:43], v[128:131], 0
  ds_read_b64_tr_b16 v[36:37], v21 offset:2688
  ds_read_b64_tr_b16 v[38:39], v21 offset:3328
  s_add_u32 m0, s13, 22784
  s_add_u32 s7, s9, 0
  s_waitcnt lgkmcnt(8)
  v_mfma_f32_32x32x16_bf16 v[48:63], v[44:47], v[132:135], v[48:63]
  ds_read_b64_tr_b16 v[40:41], v21 offset:5120
  ds_read_b64_tr_b16 v[42:43], v21 offset:5760
  buffer_load_dwordx4 v10, s[40:43], s7 offen lds
  s_waitcnt lgkmcnt(8)
  v_mfma_f32_32x32x16_bf16 v[64:79], v[24:27], v[132:135], v[64:79]
  ds_read_b64_tr_b16 v[44:45], v21 offset:5152
  ds_read_b64_tr_b16 v[46:47], v21 offset:5792
  s_add_u32 m0, s13, 23808
  s_add_u32 s7, s9, 0
  s_waitcnt lgkmcnt(8)
  v_mfma_f32_32x32x16_bf16 v[80:95], v[28:31], v[132:135], v[80:95]
  ds_read_b64_tr_b16 v[24:25], v21 offset:5184
  ds_read_b64_tr_b16 v[26:27], v21 offset:5824
  buffer_load_dwordx4 v11, s[40:43], s7 offen lds
  s_waitcnt vmcnt(4)
  v_mov_b32 v12, 1
  ds_write_b32 v16, v12 offset:0
  s_waitcnt lgkmcnt(9)
  v_mfma_f32_32x32x16_bf16 v[96:111], v[32:35], v[132:135], v[96:111]
  ds_read_b64_tr_b16 v[28:29], v21 offset:5216
  ds_read_b64_tr_b16 v[30:31], v21 offset:5856
  s_add_u32 m0, s13, 24832
  s_add_u32 s7, s9, 0
  s_waitcnt lgkmcnt(9)
  v_mfma_f32_32x32x16_bf16 v[112:127], v[36:39], v[132:135], v[112:127]
  ds_read_b64_tr_b16 v[32:33], v21 offset:5248
  ds_read_b64_tr_b16 v[34:35], v21 offset:5888
  buffer_load_dwordx4 v20, s[40:43], s7 offen lds
  s_waitcnt lgkmcnt(9)
  v_mfma_f32_32x32x16_bf16 v[48:63], v[40:43], v[136:139], v[48:63]
  ds_read_b64_tr_b16 v[36:37], v21 offset:7680
  ds_read_b64_tr_b16 v[38:39], v21 offset:8320
  s_add_u32 s9, s18, s19
  s_add_u32 s9, s9, 3
  s_and_b32 s9, s9, 7
  s_mul_i32 s9, s9, 176128
  s_add_u32 m0, s13, 41472
  s_add_u32 s7, s9, 0
  s_waitcnt lgkmcnt(9)
  v_mfma_f32_32x32x16_bf16 v[64:79], v[44:47], v[136:139], v[64:79]
  ds_read_b64_tr_b16 v[40:41], v21 offset:7712
  ds_read_b64_tr_b16 v[42:43], v21 offset:8352
  buffer_load_dwordx4 v8, s[40:43], s7 offen lds
  ds_read_b32 v13, v17 offset:0
  s_waitcnt lgkmcnt(10)
  v_mfma_f32_32x32x16_bf16 v[80:95], v[24:27], v[136:139], v[80:95]
  ds_read_b64_tr_b16 v[44:45], v21 offset:7744
  ds_read_b64_tr_b16 v[46:47], v21 offset:8384
  s_add_u32 m0, s13, 42496
  s_add_u32 s7, s9, 0
  s_waitcnt lgkmcnt(9)
  v_mfma_f32_32x32x16_bf16 v[96:111], v[28:31], v[136:139], v[96:111]
  ds_read_b64_tr_b16 v[24:25], v21 offset:7776
  ds_read_b64_tr_b16 v[26:27], v21 offset:8416
  buffer_load_dwordx4 v9, s[40:43], s7 offen lds
  s_waitcnt lgkmcnt(4)
  v_cmp_gt_u32 vcc, 1, v13
  v_mfma_f32_32x32x16_bf16 v[112:127], v[32:35], v[136:139], v[112:127]
  ds_read_b64_tr_b16 v[28:29], v21 offset:7808
  ds_read_b64_tr_b16 v[30:31], v21 offset:8448
  s_cbranch_vccnz lw10
lw10x:
  v_mov_b32 v12, 1
  ds_write_b32 v16, v12 offset:1024
  s_add_u32 m0, s13, 43520
  s_add_u32 s7, s9, 0
  v_mfma_f32_32x32x16_bf16 v[48:63], v[36:39], v[140:143], v[48:63]
  ds_read_b64_tr_b16 v[32:33], v22 offset:0
  ds_read_b64_tr_b16 v[34:35], v22 offset:640
  buffer_load_dwordx4 v10, s[40:43], s7 offen lds
  v_mfma_f32_32x32x16_bf16 v[64:79], v[40:43], v[140:143], v[64:79]
  ds_read_b64_tr_b16 v[36:37], v22 offset:32
  ds_read_b64_tr_b16 v[38:39], v22 offset:672
  s_add_u32 m0, s13, 44544
  s_add_u32 s7, s9, 0
  s_waitcnt lgkmcnt(9)
  v_mfma_f32_32x32x16_bf16 v[80:95], v[44:47], v[140:143], v[80:95]
  ds_read_b64_tr_b16 v[40:41], v22 offset:64
  ds_read_b64_tr_b16 v[42:43], v22 offset:704
  buffer_load_dwordx4 v11, s[40:43], s7 offen lds
  s_waitcnt lgkmcnt(9)
  v_mfma_f32_32x32x16_bf16 v[96:111], v[24:27], v[140:143], v[96:111]
  ds_read_b64_tr_b16 v[44:45], v22 offset:96
  ds_read_b64_tr_b16 v[46:47], v22 offset:736
  s_add_u32 m0, s13, 45568
  s_add_u32 s7, s9, 0
  s_waitcnt lgkmcnt(9)
  v_mfma_f32_32x32x16_bf16 v[112:127], v[28:31], v[140:143], v[112:127]
  ds_read_b64_tr_b16 v[24:25], v22 offset:128
  ds_read_b64_tr_b16 v[26:27], v22 offset:768
  buffer_load_dwordx4 v20, s[40:43], s7 offen lds
  s_waitcnt lgkmcnt(8)
  v_mfma_f32_32x32x16_bf16 v[48:63], v[32:35], v[144:147], v[48:63]
  ds_read_b64_tr_b16 v[28:29], v22 offset:2560
  ds_read_b64_tr_b16 v[30:31], v22 offset:3200
  s_add_u32 s9, s18, s19
  s_add_u32 s9, s9, 4
  s_and_b32 s9, s9, 7
  s_mul_i32 s9, s9, 176128
  s_add_u32 m0, s13, 62208
  s_add_u32 s7, s9, 0
  s_waitcnt lgkmcnt(8)
  v_mfma_f32_32x32x16_bf16 v[64:79], v[36:39], v[144:147], v[64:79]
  ds_read_b64_tr_b16 v[32:33], v22 offset:2592
  ds_read_b64_tr_b16 v[34:35], v22 offset:3232
  buffer_load_dwordx4 v8, s[40:43], s7 offen lds
  s_waitcnt lgkmcnt(8)
  v_mfma_f32_32x32x16_bf16 v[80:95], v[40:43], v[144:147], v[80:95]
  ds_read_b64_tr_b16 v[36:37], v22 offset:2624
  ds_read_b64_tr_b16 v[38:39], v22 offset:3264
  s_add_u32 m0, s13, 63232
  s_add_u32 s7, s9, 0
  s_waitcnt lgkmcnt(8)
  v_mfma_f32_32x32x16_bf16 v[96:111], v[44:47], v[144:147], v[96:111]
  ds_read_b64_tr_b16 v[40:41], v22 offset:2656
  ds_read_b64_tr_b16 v[42:43], v22 offset:3296
  buffer_load_dwordx4 v9, s[40:43], s7 offen lds
  s_waitcnt lgkmcnt(8)
  v_mfma_f32_32x32x16_bf16 v[112:127], v[24:27], v[144:147], v[112:127]
  ds_read_b64_tr_b16 v[44:45], v22 offset:2688
  ds_read_b64_tr_b16 v[46:47], v22 offset:3328
  s_add_u32 m0, s13, 64256
  s_add_u32 s7, s9, 0
  s_waitcnt lgkmcnt(8)
  v_mfma_f32_32x32x16_bf16 v[48:63], v[28:31], v[148:151], v[48:63]
  ds_read_b64_tr_b16 v[24:25], v22 offset:5120
  ds_read_b64_tr_b16 v[26:27], v22 offset:5760
  buffer_load_dwordx4 v10, s[40:43], s7 offen lds
  s_waitcnt lgkmcnt(8)
  v_mfma_f32_32x32x16_bf16 v[64:79], v[32:35], v[148:151], v[64:79]
  ds_read_b64_tr_b16 v[28:29], v22 offset:5152
  ds_read_b64_tr_b16 v[30:31], v22 offset:5792
  ds_read_b32 v15, v17 offset:2048
  s_add_u32 m0, s13, 65280
  s_add_u32 s7, s9, 0
  s_waitcnt lgkmcnt(9)
  v_mfma_f32_32x32x16_bf16 v[80:95], v[36:39], v[148:151], v[80:95]
  ds_read_b64_tr_b16 v[32:33], v22 offset:5184
  ds_read_b64_tr_b16 v[34:35], v22 offset:5824
  buffer_load_dwordx4 v11, s[40:43], s7 offen lds
  ds_read_b32 v14, v17 offset:1024
  s_waitcnt vmcnt(9)
  v_mov_b32 v12, 2
  ds_write_b32 v16, v12 offset:0
  s_waitcnt lgkmcnt(11)
  v_mfma_f32_32x32x16_bf16 v[96:111], v[40:43], v[148:151], v[96:111]
  ds_read_b64_tr_b16 v[36:37], v22 offset:5216
  ds_read_b64_tr_b16 v[38:39], v22 offset:5856
  s_add_u32 m0, s13, 66304
  s_add_u32 s7, s9, 0
  s_waitcnt lgkmcnt(6)
  v_cmp_gt_u32 vcc, 1, v15
  v_mfma_f32_32x32x16_bf16 v[112:127], v[44:47], v[148:151], v[112:127]
  ds_read_b64_tr_b16 v[40:41], v22 offset:5248
  ds_read_b64_tr_b16 v[42:43], v22 offset:5888
  s_cbranch_vccnz lw11
lw11x:
  buffer_load_dwordx4 v20, s[40:43], s7 offen lds
  s_waitcnt lgkmcnt(5)
  v_cmp_gt_u32 vcc, 1, v14
  v_mfma_f32_32x32x16_bf16 v[48:63], v[24:27], v[152:155], v[48:63]
  ds_read_b64_tr_b16 v[44:45], v22 offset:7680
  ds_read_b64_tr_b16 v[46:47], v22 offset:8320
  s_cbranch_vccnz lw12
lw12x:
  s_add_u32 s9, s18, s19
  s_add_u32 s9, s9, 5
  s_and_b32 s9, s9, 7
  s_mul_i32 s9, s9, 176128
  s_add_u32 m0, s13, 131328
  s_add_u32 s7, s9, 0
  v_mfma_f32_32x32x16_bf16 v[64:79], v[28:31], v[152:155], v[64:79]
  ds_read_b64_tr_b16 v[24:25], v22 offset:7712
  ds_read_b64_tr_b16 v[26:27], v22 offset:8352
  buffer_load_dwordx4 v8, s[40:43], s7 offen lds
  ds_read_b32 v13, v17 offset:0
  v_mfma_f32_32x32x16_bf16 v[80:95], v[32:35], v[152:155], v[80:95]
  ds_read_b64_tr_b16 v[28:29], v22 offset:7744
  ds_read_b64_tr_b16 v[30:31], v22 offset:8384
  s_add_u32 m0, s13, 132352
  s_add_u32 s7, s9, 0
  s_waitcnt lgkmcnt(9)
  v_mfma_f32_32x32x16_bf16 v[96:111], v[36:39], v[152:155], v[96:111]
  ds_read_b64_tr_b16 v[32:33], v22 offset:7776
  ds_read_b64_tr_b16 v[34:35], v22 offset:8416
  buffer_load_dwordx4 v9, s[40:43], s7 offen lds
  s_waitcnt lgkmcnt(4)
  v_cmp_gt_u32 vcc, 2, v13
  v_mfma_f32_32x32x16_bf16 v[112:127], v[40:43], v[152:155], v[112:127]
  ds_read_b64_tr_b16 v[36:37], v22 offset:7808
  ds_read_b64_tr_b16 v[38:39], v22 offset:8448
  s_cbranch_vccnz lw13
lw13x:
  v_mov_b32 v12, 2
  ds_write_b32 v16, v12 offset:1024
  s_add_u32 m0, s13, 133376
  s_add_u32 s7, s9, 0
  v_mfma_f32_32x32x16_bf16 v[48:63], v[44:47], v[156:159], v[48:63]
  ds_read_b64_tr_b16 v[40:41], v22 offset:20736
  ds_read_b64_tr_b16 v[42:43], v22 offset:21376
  buffer_load_dwordx4 v10, s[40:43], s7 offen lds
  v_mfma_f32_32x32x16_bf16 v[64:79], v[24:27], v[156:159], v[64:79]
  ds_read_b64_tr_b16 v[44:45], v22 offset:20768
  ds_read_b64_tr_b16 v[46:47], v22 offset:21408
  s_add_u32 m0, s13, 134400
  s_add_u32 s7, s9, 0
  s_waitcnt lgkmcnt(9)
  v_mfma_f32_32x32x16_bf16 v[80:95], v[28:31], v[156:159], v[80:95]
  ds_read_b64_tr_b16 v[24:25], v22 offset:20800
  ds_read_b64_tr_b16 v[26:27], v22 offset:21440
  buffer_load_dwordx4 v11, s[40:43], s7 offen lds
  s_waitcnt lgkmcnt(9)
  v_mfma_f32_32x32x16_bf16 v[96:111], v[32:35], v[156:159], v[96:111]
  ds_read_b64_tr_b16 v[28:29], v22 offset:20832
  ds_read_b64_tr_b16 v[30:31], v22 offset:21472
  ds_read_b32 v14, v17 offset:1024
  s_add_u32 m0, s13, 135424
  s_add_u32 s7, s9, 0
  s_waitcnt lgkmcnt(10)
  v_mfma_f32_32x32x16_bf16 v[112:127], v[36:39], v[156:159], v[112:127]
  ds_read_b64_tr_b16 v[32:33], v22 offset:20864
  ds_read_b64_tr_b16 v[34:35], v22 offset:21504
  buffer_load_dwordx4 v20, s[40:43], s7 offen lds
  s_waitcnt lgkmcnt(9)
  v_mfma_f32_32x32x16_bf16 v[48:63], v[40:43], v[160:163], v[48:63]
  ds_read_b64_tr_b16 v[36:37], v22 offset:23296
  ds_read_b64_tr_b16 v[38:39], v22 offset:23936
  s_waitcnt lgkmcnt(4)
  v_cmp_gt_u32 vcc, 2, v14
  v_mfma_f32_32x32x16_bf16 v[64:79], v[44:47], v[160:163], v[64:79]
  ds_read_b64_tr_b16 v[40:41], v22 offset:23328
  ds_read_b64_tr_b16 v[42:43], v22 offset:23968
  s_cbranch_vccnz lw14
lw14x:
  s_add_u32 s9, s18, s19
  s_add_u32 s9, s9, 6
  s_and_b32 s9, s9, 7
  s_mul_i32 s9, s9, 176128
  s_add_u32 m0, s13, 0
  s_add_u32 s7, s9, 0
  v_mfma_f32_32x32x16_bf16 v[80:95], v[24:27], v[160:163], v[80:95]
  ds_read_b64_tr_b16 v[44:45], v22 offset:23360
  ds_read_b64_tr_b16 v[46:47], v22 offset:24000
  buffer_load_dwordx4 v8, s[40:43], s7 offen lds
  v_mfma_f32_32x32x16_bf16 v[96:111], v[28:31], v[160:163], v[96:111]
  ds_read_b64_tr_b16 v[24:25], v22 offset:23392
  ds_read_b64_tr_b16 v[26:27], v22 offset:24032
  s_add_u32 m0, s13, 1024
  s_add_u32 s7, s9, 0
  s_waitcnt lgkmcnt(8)
  v_mfma_f32_32x32x16_bf16 v[112:127], v[32:35], v[160:163], v[112:127]
  ds_read_b64_tr_b16 v[28:29], v22 offset:23424
  ds_read_b64_tr_b16 v[30:31], v22 offset:24064
  buffer_load_dwordx4 v9, s[40:43], s7 offen lds
  s_waitcnt lgkmcnt(8)
  v_mfma_f32_32x32x16_bf16 v[48:63], v[36:39], v[164:167], v[48:63]
  ds_read_b64_tr_b16 v[32:33], v22 offset:25856
  ds_read_b64_tr_b16 v[34:35], v22 offset:26496
  s_add_u32 m0, s13, 2048
  s_add_u32 s7, s9, 0
  s_waitcnt lgkmcnt(8)
  v_mfma_f32_32x32x16_bf16 v[64:79], v[40:43], v[164:167], v[64:79]
  ds_read_b64_tr_b16 v[36:37], v22 offset:25888
  ds_read_b64_tr_b16 v[38:39], v22 offset:26528
  buffer_load_dwordx4 v10, s[40:43], s7 offen lds
  s_waitcnt lgkmcnt(8)
  v_mfma_f32_32x32x16_bf16 v[80:95], v[44:47], v[164:167], v[80:95]
  ds_read_b64_tr_b16 v[40:41], v22 offset:25920
  ds_read_b64_tr_b16 v[42:43], v22 offset:26560
  s_waitcnt vmcnt(13)
  v_mov_b32 v12, 3
  ds_write_b32 v16, v12 offset:0
  s_add_u32 m0, s13, 3072
  s_add_u32 s7, s9, 0
  s_waitcnt lgkmcnt(9)
  v_mfma_f32_32x32x16_bf16 v[96:111], v[24:27], v[164:167], v[96:111]
  ds_read_b64_tr_b16 v[44:45], v22 offset:25952
  ds_read_b64_tr_b16 v[46:47], v22 offset:26592
  buffer_load_dwordx4 v11, s[40:43], s7 offen lds
  s_waitcnt lgkmcnt(9)
  v_mfma_f32_32x32x16_bf16 v[112:127], v[28:31], v[164:167], v[112:127]
  ds_read_b64_tr_b16 v[24:25], v22 offset:25984
  ds_read_b64_tr_b16 v[26:27], v22 offset:26624
  s_add_u32 m0, s13, 4096
  s_add_u32 s7, s9, 0
  s_waitcnt lgkmcnt(9)
  v_mfma_f32_32x32x16_bf16 v[48:63], v[32:35], v[168:171], v[48:63]
  ds_read_b64_tr_b16 v[28:29], v22 offset:28416
  ds_read_b64_tr_b16 v[30:31], v22 offset:29056
  buffer_load_dwordx4 v20, s[40:43], s7 offen lds
  s_waitcnt lgkmcnt(9)
  v_mfma_f32_32x32x16_bf16 v[64:79], v[36:39], v[168:171], v[64:79]
  ds_read_b64_tr_b16 v[32:33], v22 offset:28448
  ds_read_b64_tr_b16 v[34:35], v22 offset:29088
  ds_read_b32 v13, v17 offset:0
  s_waitcnt lgkmcnt(10)
  v_mfma_f32_32x32x16_bf16 v[80:95], v[40:43], v[168:171], v[80:95]
  ds_read_b64_tr_b16 v[36:37], v22 offset:28480
  ds_read_b64_tr_b16 v[38:39], v22 offset:29120
  s_waitcnt lgkmcnt(9)
  v_mfma_f32_32x32x16_bf16 v[96:111], v[44:47], v[168:171], v[96:111]
  ds_read_b64_tr_b16 v[40:41], v22 offset:28512
  ds_read_b64_tr_b16 v[42:43], v22 offset:29152
  s_waitcnt lgkmcnt(4)
  v_cmp_gt_u32 vcc, 3, v13
  v_mfma_f32_32x32x16_bf16 v[112:127], v[24:27], v[168:171], v[112:127]
  ds_read_b64_tr_b16 v[44:45], v22 offset:28544
  ds_read_b64_tr_b16 v[46:47], v22 offset:29184
  s_cbranch_vccnz lw15
lw15x:
  v_mov_b32 v12, 3
  ds_write_b32 v16, v12 offset:1024
  v_mfma_f32_32x32x16_bf16 v[48:63], v[28:31], v[172:175], v[48:63]
  ds_read_b64_tr_b16 v[24:25], v22 offset:41472
  ds_read_b64_tr_b16 v[26:27], v22 offset:42112
  v_mfma_f32_32x32x16_bf16 v[64:79], v[32:35], v[172:175], v[64:79]
  ds_read_b64_tr_b16 v[28:29], v22 offset:41504
  ds_read_b64_tr_b16 v[30:31], v22 offset:42144
  s_waitcnt lgkmcnt(9)
  v_mfma_f32_32x32x16_bf16 v[80:95], v[36:39], v[172:175], v[80:95]
  ds_read_b64_tr_b16 v[32:33], v22 offset:41536
  ds_read_b64_tr_b16 v[34:35], v22 offset:42176
  s_waitcnt lgkmcnt(9)
  v_mfma_f32_32x32x16_bf16 v[96:111], v[40:43], v[172:175], v[96:111]
  ds_read_b64_tr_b16 v[36:37], v22 offset:41568
  ds_read_b64_tr_b16 v[38:39], v22 offset:42208
  ds_read_b32 v14, v17 offset:1024
  s_waitcnt lgkmcnt(10)
  v_mfma_f32_32x32x16_bf16 v[112:127], v[44:47], v[172:175], v[112:127]
  ds_read_b64_tr_b16 v[40:41], v22 offset:41600
  ds_read_b64_tr_b16 v[42:43], v22 offset:42240
  s_waitcnt lgkmcnt(9)
  v_mfma_f32_32x32x16_bf16 v[48:63], v[24:27], v[176:179], v[48:63]
  ds_read_b64_tr_b16 v[44:45], v22 offset:44032
  ds_read_b64_tr_b16 v[46:47], v22 offset:44672
  s_waitcnt lgkmcnt(4)
  v_cmp_gt_u32 vcc, 3, v14
  v_mfma_f32_32x32x16_bf16 v[64:79], v[28:31], v[176:179], v[64:79]
  ds_read_b64_tr_b16 v[24:25], v22 offset:44064
  ds_read_b64_tr_b16 v[26:27], v22 offset:44704
  s_cbranch_vccnz lw16
lw16x:
  s_add_u32 s9, s18, s19
  s_add_u32 s9, s9, 7
  s_and_b32 s9, s9, 7
  s_mul_i32 s9, s9, 176128
  s_add_u32 m0, s13, 20736
  s_add_u32 s7, s9, 0
  v_mfma_f32_32x32x16_bf16 v[80:95], v[32:35], v[176:179], v[80:95]
  ds_read_b64_tr_b16 v[28:29], v22 offset:44096
  ds_read_b64_tr_b16 v[30:31], v22 offset:44736
  buffer_load_dwordx4 v8, s[40:43], s7 offen lds
  v_mfma_f32_32x32x16_bf16 v[96:111], v[36:39], v[176:179], v[96:111]
  ds_read_b64_tr_b16 v[32:33], v22 offset:44128
  ds_read_b64_tr_b16 v[34:35], v22 offset:44768
  s_add_u32 m0, s13, 21760
  s_add_u32 s7, s9, 0
  s_waitcnt lgkmcnt(8)
  v_mfma_f32_32x32x16_bf16 v[112:127], v[40:43], v[176:179], v[112:127]
  ds_read_b64_tr_b16 v[36:37], v22 offset:44160
  ds_read_b64_tr_b16 v[38:39], v22 offset:44800
  buffer_load_dwordx4 v9, s[40:43], s7 offen lds
  s_waitcnt lgkmcnt(8)
  v_mfma_f32_32x32x16_bf16 v[48:63], v[44:47], v[180:183], v[48:63]
  ds_read_b64_tr_b16 v[40:41], v22 offset:46592
  ds_read_b64_tr_b16 v[42:43], v22 offset:47232
  s_add_u32 m0, s13, 22784
  s_add_u32 s7, s9, 0
  s_waitcnt lgkmcnt(8)
  v_mfma_f32_32x32x16_bf16 v[64:79], v[24:27], v[180:183], v[64:79]
  ds_read_b64_tr_b16 v[44:45], v22 offset:46624
  ds_read_b64_tr_b16 v[46:47], v22 offset:47264
  buffer_load_dwordx4 v10, s[40:43], s7 offen lds
  s_waitcnt lgkmcnt(8)
  v_mfma_f32_32x32x16_bf16 v[80:95], v[28:31], v[180:183], v[80:95]
  ds_read_b64_tr_b16 v[24:25], v22 offset:46656
  ds_read_b64_tr_b16 v[26:27], v22 offset:47296
  s_waitcnt vmcnt(13)
  v_mov_b32 v12, 4
  ds_write_b32 v16, v12 offset:0
  s_add_u32 m0, s13, 23808
  s_add_u32 s7, s9, 0
  s_waitcnt lgkmcnt(9)
  v_mfma_f32_32x32x16_bf16 v[96:111], v[32:35], v[180:183], v[96:111]
  ds_read_b64_tr_b16 v[28:29], v22 offset:46688
  ds_read_b64_tr_b16 v[30:31], v22 offset:47328
  buffer_load_dwordx4 v11, s[40:43], s7 offen lds
  s_waitcnt lgkmcnt(9)
  v_mfma_f32_32x32x16_bf16 v[112:127], v[36:39], v[180:183], v[112:127]
  ds_read_b64_tr_b16 v[32:33], v22 offset:46720
  ds_read_b64_tr_b16 v[34:35], v22 offset:47360
  s_add_u32 m0, s13, 24832
  s_add_u32 s7, s9, 0
  s_waitcnt lgkmcnt(9)
  v_mfma_f32_32x32x16_bf16 v[48:63], v[40:43], v[184:187], v[48:63]
  ds_read_b64_tr_b16 v[36:37], v22 offset:49152
  ds_read_b64_tr_b16 v[38:39], v22 offset:49792
  buffer_load_dwordx4 v20, s[40:43], s7 offen lds
  s_waitcnt lgkmcnt(9)
  v_mfma_f32_32x32x16_bf16 v[64:79], v[44:47], v[184:187], v[64:79]
  ds_read_b64_tr_b16 v[40:41], v22 offset:49184
  ds_read_b64_tr_b16 v[42:43], v22 offset:49824
  ds_read_b32 v13, v17 offset:0
  s_waitcnt lgkmcnt(10)
  v_mfma_f32_32x32x16_bf16 v[80:95], v[24:27], v[184:187], v[80:95]
  ds_read_b64_tr_b16 v[44:45], v22 offset:49216
  ds_read_b64_tr_b16 v[46:47], v22 offset:49856
  s_waitcnt lgkmcnt(9)
  v_mfma_f32_32x32x16_bf16 v[96:111], v[28:31], v[184:187], v[96:111]
  ds_read_b64_tr_b16 v[24:25], v22 offset:49248
  ds_read_b64_tr_b16 v[26:27], v22 offset:49888
  s_waitcnt lgkmcnt(4)
  v_cmp_gt_u32 vcc, 4, v13
  v_mfma_f32_32x32x16_bf16 v[112:127], v[32:35], v[184:187], v[112:127]
  ds_read_b64_tr_b16 v[28:29], v22 offset:49280
  ds_read_b64_tr_b16 v[30:31], v22 offset:49920
  s_cbranch_vccnz lw17
lw17x:
  v_mov_b32 v12, 4
  ds_write_b32 v16, v12 offset:1024
  v_mfma_f32_32x32x16_bf16 v[48:63], v[36:39], v[188:191], v[48:63]
  ds_read_b64_tr_b16 v[32:33], v23 offset:0
  ds_read_b64_tr_b16 v[34:35], v23 offset:640
  v_mfma_f32_32x32x16_bf16 v[64:79], v[40:43], v[188:191], v[64:79]
  ds_read_b64_tr_b16 v[36:37], v23 offset:32
  ds_read_b64_tr_b16 v[38:39], v23 offset:672
  s_waitcnt lgkmcnt(9)
  v_mfma_f32_32x32x16_bf16 v[80:95], v[44:47], v[188:191], v[80:95]
  ds_read_b64_tr_b16 v[40:41], v23 offset:64
  ds_read_b64_tr_b16 v[42:43], v23 offset:704
  s_waitcnt lgkmcnt(9)
  v_mfma_f32_32x32x16_bf16 v[96:111], v[24:27], v[188:191], v[96:111]
  ds_read_b64_tr_b16 v[44:45], v23 offset:96
  ds_read_b64_tr_b16 v[46:47], v23 offset:736
  s_waitcnt lgkmcnt(9)
  v_mfma_f32_32x32x16_bf16 v[112:127], v[28:31], v[188:191], v[112:127]
  ds_read_b64_tr_b16 v[24:25], v23 offset:128
  ds_read_b64_tr_b16 v[26:27], v23 offset:768
  s_waitcnt lgkmcnt(8)
  v_mfma_f32_32x32x16_bf16 v[48:63], v[32:35], v[192:195], v[48:63]
  ds_read_b64_tr_b16 v[28:29], v23 offset:2560
  ds_read_b64_tr_b16 v[30:31], v23 offset:3200
  s_waitcnt lgkmcnt(8)
  v_mfma_f32_32x32x16_bf16 v[64:79], v[36:39], v[192:195], v[64:79]
  ds_read_b64_tr_b16 v[32:33], v23 offset:2592
  ds_read_b64_tr_b16 v[34:35], v23 offset:3232
  s_waitcnt lgkmcnt(8)
  v_mfma_f32_32x32x16_bf16 v[80:95], v[40:43], v[192:195], v[80:95]
  ds_read_b64_tr_b16 v[36:37], v23 offset:2624
  ds_read_b64_tr_b16 v[38:39], v23 offset:3264
  s_waitcnt lgkmcnt(8)
  v_mfma_f32_32x32x16_bf16 v[96:111], v[44:47], v[192:195], v[96:111]
  ds_read_b64_tr_b16 v[40:41], v23 offset:2656
  ds_read_b64_tr_b16 v[42:43], v23 offset:3296
  s_waitcnt lgkmcnt(8)
  v_mfma_f32_32x32x16_bf16 v[112:127], v[24:27], v[192:195], v[112:127]
  ds_read_b64_tr_b16 v[44:45], v23 offset:2688
  ds_read_b64_tr_b16 v[46:47], v23 offset:3328
  s_waitcnt lgkmcnt(8)
  v_mfma_f32_32x32x16_bf16 v[48:63], v[28:31], v[196:199], v[48:63]
  ds_read_b64_tr_b16 v[24:25], v23 offset:5120
  ds_read_b64_tr_b16 v[26:27], v23 offset:5760
  s_waitcnt lgkmcnt(8)
  v_mfma_f32_32x32x16_bf16 v[64:79], v[32:35], v[196:199], v[64:79]
  ds_read_b64_tr_b16 v[28:29], v23 offset:5152
  ds_read_b64_tr_b16 v[30:31], v23 offset:5792
  v_mov_b32 v143, 0
  s_waitcnt lgkmcnt(8)
  v_mfma_f32_32x32x16_bf16 v[80:95], v[36:39], v[196:199], v[80:95]
  ds_read_b64_tr_b16 v[32:33], v23 offset:5184
  ds_read_b64_tr_b16 v[34:35], v23 offset:5824
  s_waitcnt vmcnt(5)
  v_mov_b32 v12, 6
  ds_write_b32 v16, v12 offset:0
  v_mov_b32 v144, 0
  s_waitcnt lgkmcnt(9)
  v_mfma_f32_32x32x16_bf16 v[96:111], v[40:43], v[196:199], v[96:111]
  ds_read_b64_tr_b16 v[36:37], v23 offset:5216
  ds_read_b64_tr_b16 v[38:39], v23 offset:5856
  v_mov_b32 v145, 0
  s_waitcnt lgkmcnt(9)
  v_mfma_f32_32x32x16_bf16 v[112:127], v[44:47], v[196:199], v[112:127]
  ds_read_b64_tr_b16 v[40:41], v23 offset:5248
  ds_read_b64_tr_b16 v[42:43], v23 offset:5888
  v_lshlrev_b32 v146, 16, v19
  s_waitcnt lgkmcnt(9)
  v_mfma_f32_32x32x16_bf16 v[48:63], v[24:27], v[200:203], v[48:63]
  ds_read_b64_tr_b16 v[44:45], v23 offset:7680
  ds_read_b64_tr_b16 v[46:47], v23 offset:8320
  v_rcp_f32 v147, v146
  s_waitcnt lgkmcnt(9)
  v_mfma_f32_32x32x16_bf16 v[64:79], v[28:31], v[200:203], v[64:79]
  ds_read_b64_tr_b16 v[24:25], v23 offset:7712
  ds_read_b64_tr_b16 v[26:27], v23 offset:8352
  ds_read_b32 v13, v17 offset:0
  v_perm_b32 v142, v19, v19, s15
  s_waitcnt lgkmcnt(10)
  v_mfma_f32_32x32x16_bf16 v[80:95], v[32:35], v[200:203], v[80:95]
  ds_read_b64_tr_b16 v[28:29], v23 offset:7744
  ds_read_b64_tr_b16 v[30:31], v23 offset:8384
  v_mul_f32 v147, 0xbfb8aa3b, v147
  s_waitcnt lgkmcnt(9)
  v_mfma_f32_32x32x16_bf16 v[96:111], v[36:39], v[200:203], v[96:111]
  ds_read_b64_tr_b16 v[32:33], v23 offset:7776
  ds_read_b64_tr_b16 v[34:35], v23 offset:8416
  v_lshlrev_b32 v148, 2, v1
  s_waitcnt lgkmcnt(4)
  v_cmp_gt_u32 vcc, 6, v13
  v_mfma_f32_32x32x16_bf16 v[112:127], v[40:43], v[200:203], v[112:127]
  ds_read_b64_tr_b16 v[36:37], v23 offset:7808
  ds_read_b64_tr_b16 v[38:39], v23 offset:8448
  s_cbranch_vccnz lw18
lw18x:
  v_mov_b32 v12, 5
  ds_write_b32 v16, v12 offset:1024
  v_add_u32 v148, 158080, v148
  v_mfma_f32_32x32x16_bf16 v[48:63], v[44:47], v[204:207], v[48:63]
  ds_read_b64_tr_b16 v[40:41], v21 offset:0
  ds_read_b64_tr_b16 v[42:43], v21 offset:640
  s_waitcnt vmcnt(0)
  v_mov_b32 v12, 7
  ds_write_b32 v16, v12 offset:0
  s_lshl_b32 s66, s26, 17
  v_mfma_f32_32x32x16_bf16 v[64:79], v[24:27], v[204:207], v[64:79]
  ds_read_b64_tr_b16 v[44:45], v21 offset:2560
  ds_read_b64_tr_b16 v[46:47], v21 offset:3200
  s_waitcnt lgkmcnt(10)
  v_mfma_f32_32x32x16_bf16 v[80:95], v[28:31], v[204:207], v[80:95]
  ds_read_b64_tr_b16 v[24:25], v21 offset:5120
  ds_read_b64_tr_b16 v[26:27], v21 offset:5760
  s_waitcnt lgkmcnt(10)
  v_mfma_f32_32x32x16_bf16 v[96:111], v[32:35], v[204:207], v[96:111]
  ds_read_b64_tr_b16 v[28:29], v21 offset:7680
  ds_read_b64_tr_b16 v[30:31], v21 offset:8320
  s_waitcnt lgkmcnt(10)
  v_mfma_f32_32x32x16_bf16 v[112:127], v[36:39], v[204:207], v[112:127]
  ds_read_b64_tr_b16 v[32:33], v22 offset:0
  ds_read_b64_tr_b16 v[34:35], v22 offset:640
  ds_read_b32 v13, v17 offset:0
  s_waitcnt lgkmcnt(10)
  v_mfma_f32_32x32x16_bf16 v[48:63], v[40:43], v[208:211], v[48:63]
  ds_read_b64_tr_b16 v[36:37], v22 offset:2560
  ds_read_b64_tr_b16 v[38:39], v22 offset:3200
  s_waitcnt lgkmcnt(9)
  v_mfma_f32_32x32x16_bf16 v[48:63], v[44:47], v[212:215], v[48:63]
  ds_read_b64_tr_b16 v[40:41], v22 offset:5120
  ds_read_b64_tr_b16 v[42:43], v22 offset:5760
  s_waitcnt lgkmcnt(4)
  v_cmp_gt_u32 vcc, 7, v13
  v_mfma_f32_32x32x16_bf16 v[48:63], v[24:27], v[216:219], v[48:63]
  ds_read_b64_tr_b16 v[44:45], v22 offset:7680
  ds_read_b64_tr_b16 v[46:47], v22 offset:8320
  s_cbranch_vccnz lw19
lw19x:
  ds_read_b32 v15, v17 offset:2048
  v_mfma_f32_32x32x16_bf16 v[48:63], v[28:31], v[220:223], v[48:63]
  ds_read_b64_tr_b16 v[24:25], v22 offset:20736
  ds_read_b64_tr_b16 v[26:27], v22 offset:21376
  v_mfma_f32_32x32x16_bf16 v[48:63], v[32:35], v[224:227], v[48:63]
  ds_read_b64_tr_b16 v[28:29], v22 offset:23296
  ds_read_b64_tr_b16 v[30:31], v22 offset:23936
  s_waitcnt lgkmcnt(9)
  v_mfma_f32_32x32x16_bf16 v[48:63], v[36:39], v[228:231], v[48:63]
  ds_read_b64_tr_b16 v[32:33], v22 offset:25856
  ds_read_b64_tr_b16 v[34:35], v22 offset:26496
  s_waitcnt lgkmcnt(6)
  v_cmp_gt_u32 vcc, 2, v15
  v_mfma_f32_32x32x16_bf16 v[48:63], v[40:43], v[232:235], v[48:63]
  ds_read_b64_tr_b16 v[36:37], v22 offset:28416
  ds_read_b64_tr_b16 v[38:39], v22 offset:29056
  s_cbranch_vccnz lw20
lw20x:
  ds_read_b32 v128, v148 offset:0
  ds_read_b32 v130, v148 offset:256
  ds_read_b32 v132, v148 offset:512
  ds_read_b32 v134, v148 offset:768
  ds_read_b32 v136, v148 offset:1024
  v_mfma_f32_32x32x16_bf16 v[48:63], v[44:47], v[236:239], v[48:63]
  ds_read_b64_tr_b16 v[40:41], v21 offset:32
  ds_read_b64_tr_b16 v[42:43], v21 offset:672
  s_waitcnt lgkmcnt(13)
  v_mfma_f32_32x32x16_bf16 v[48:63], v[24:27], v[240:243], v[48:63]
  ds_read_b64_tr_b16 v[44:45], v21 offset:2592
  ds_read_b64_tr_b16 v[46:47], v21 offset:3232
  s_waitcnt lgkmcnt(13)
  v_mfma_f32_32x32x16_bf16 v[48:63], v[28:31], v[244:247], v[48:63]
  ds_read_b64_tr_b16 v[24:25], v21 offset:5152
  ds_read_b64_tr_b16 v[26:27], v21 offset:5792
  s_waitcnt lgkmcnt(13)
  v_mfma_f32_32x32x16_bf16 v[48:63], v[32:35], v[248:251], v[48:63]
  ds_read_b64_tr_b16 v[28:29], v21 offset:7712
  ds_read_b64_tr_b16 v[30:31], v21 offset:8352
  s_waitcnt lgkmcnt(13)
  v_mfma_f32_32x32x16_bf16 v[48:63], v[36:39], v[252:255], v[48:63]
  ds_read_b64_tr_b16 v[32:33], v22 offset:32
  ds_read_b64_tr_b16 v[34:35], v22 offset:672
  s_setprio 3
  s_waitcnt lgkmcnt(13)
  v_mfma_f32_32x32x16_bf16 v[48:63], v[128:131], v[142:145], v[48:63]
  s_waitcnt lgkmcnt(8)
  v_mfma_f32_32x32x16_bf16 v[64:79], v[40:43], v[208:211], v[64:79]
  ds_read_b64_tr_b16 v[36:37], v22 offset:2592
  ds_read_b64_tr_b16 v[38:39], v22 offset:3232
  s_waitcnt lgkmcnt(8)
  v_mfma_f32_32x32x16_bf16 v[64:79], v[44:47], v[212:215], v[64:79]
  ds_read_b64_tr_b16 v[40:41], v22 offset:5152
  ds_read_b64_tr_b16 v[42:43], v22 offset:5792
  s_waitcnt lgkmcnt(8)
  v_mfma_f32_32x32x16_bf16 v[64:79], v[24:27], v[216:219], v[64:79]
  ds_read_b64_tr_b16 v[44:45], v22 offset:7712
  ds_read_b64_tr_b16 v[46:47], v22 offset:8352
  v_mul_f32 v160, v147, v48
  v_mul_f32 v161, v147, v49
  v_mul_f32 v162, v147, v50
  v_mul_f32 v163, v147, v51
  v_mul_f32 v164, v147, v52
  v_mul_f32 v165, v147, v53
  s_waitcnt lgkmcnt(8)
  v_mfma_f32_32x32x16_bf16 v[64:79], v[28:31], v[220:223], v[64:79]
  ds_read_b64_tr_b16 v[24:25], v22 offset:20768
  ds_read_b64_tr_b16 v[26:27], v22 offset:21408
  v_mul_f32 v166, v147, v54
  v_mul_f32 v167, v147, v55
  v_exp_f32 v160, v160
  v_exp_f32 v161, v161
  s_waitcnt lgkmcnt(8)
  v_mfma_f32_32x32x16_bf16 v[64:79], v[32:35], v[224:227], v[64:79]
  ds_read_b64_tr_b16 v[28:29], v22 offset:23328
  ds_read_b64_tr_b16 v[30:31], v22 offset:23968
  v_exp_f32 v162, v162
  v_exp_f32 v163, v163
  s_waitcnt lgkmcnt(8)
  v_mfma_f32_32x32x16_bf16 v[64:79], v[36:39], v[228:231], v[64:79]
  ds_read_b64_tr_b16 v[32:33], v22 offset:25888
  ds_read_b64_tr_b16 v[34:35], v22 offset:26528
  v_exp_f32 v164, v164
  v_exp_f32 v165, v165
  v_exp_f32 v166, v166
  s_waitcnt lgkmcnt(8)
  v_mfma_f32_32x32x16_bf16 v[64:79], v[40:43], v[232:235], v[64:79]
  ds_read_b64_tr_b16 v[36:37], v22 offset:28448
  ds_read_b64_tr_b16 v[38:39], v22 offset:29088
  v_exp_f32 v167, v167
  v_fma_f32 v160, v160, v146, v146
  v_fma_f32 v161, v161, v146, v146
  s_waitcnt lgkmcnt(8)
  v_mfma_f32_32x32x16_bf16 v[64:79], v[44:47], v[236:239], v[64:79]
  ds_read_b64_tr_b16 v[40:41], v21 offset:64
  ds_read_b64_tr_b16 v[42:43], v21 offset:704
  v_fma_f32 v162, v162, v146, v146
  v_fma_f32 v163, v163, v146, v146
  v_fma_f32 v164, v164, v146, v146
  v_fma_f32 v165, v165, v146, v146
  v_fma_f32 v166, v166, v146, v146
  s_waitcnt lgkmcnt(8)
  v_mfma_f32_32x32x16_bf16 v[64:79], v[24:27], v[240:243], v[64:79]
  ds_read_b64_tr_b16 v[44:45], v21 offset:2624
  ds_read_b64_tr_b16 v[46:47], v21 offset:3264
  v_fma_f32 v167, v167, v146, v146
  v_rcp_f32 v160, v160
  v_rcp_f32 v161, v161
  v_rcp_f32 v162, v162
  s_waitcnt lgkmcnt(8)
  v_mfma_f32_32x32x16_bf16 v[64:79], v[28:31], v[244:247], v[64:79]
  ds_read_b64_tr_b16 v[24:25], v21 offset:5184
  ds_read_b64_tr_b16 v[26:27], v21 offset:5824
  v_rcp_f32 v163, v163
  v_rcp_f32 v164, v164
  s_waitcnt lgkmcnt(8)
  v_mfma_f32_32x32x16_bf16 v[64:79], v[32:35], v[248:251], v[64:79]
  ds_read_b64_tr_b16 v[28:29], v21 offset:7744
  ds_read_b64_tr_b16 v[30:31], v21 offset:8384
  v_rcp_f32 v165, v165
  v_rcp_f32 v166, v166
  v_rcp_f32 v167, v167
  s_waitcnt lgkmcnt(8)
  v_mfma_f32_32x32x16_bf16 v[64:79], v[36:39], v[252:255], v[64:79]
  ds_read_b64_tr_b16 v[32:33], v22 offset:64
  ds_read_b64_tr_b16 v[34:35], v22 offset:704
  v_mul_f32 v160, v160, v56
  v_mul_f32 v161, v161, v57
  v_mul_f32 v162, v162, v58
  v_mul_f32 v163, v163, v59
  v_mfma_f32_32x32x16_bf16 v[64:79], v[130:133], v[142:145], v[64:79]
  s_waitcnt lgkmcnt(8)
  v_mfma_f32_32x32x16_bf16 v[80:95], v[40:43], v[208:211], v[80:95]
  ds_read_b64_tr_b16 v[36:37], v22 offset:2624
  ds_read_b64_tr_b16 v[38:39], v22 offset:3264
  v_mul_f32 v164, v164, v60
  v_mul_f32 v165, v165, v61
  v_mul_f32 v166, v166, v62
  v_mul_f32 v167, v167, v63
  v_cvt_pk_bf16_f32 v48, v160, v161
  s_waitcnt lgkmcnt(8)
  v_mfma_f32_32x32x16_bf16 v[80:95], v[44:47], v[212:215], v[80:95]
  ds_read_b64_tr_b16 v[40:41], v22 offset:5184
  ds_read_b64_tr_b16 v[42:43], v22 offset:5824
  v_cvt_pk_bf16_f32 v49, v162, v163
  v_cvt_pk_bf16_f32 v50, v164, v165
  v_cvt_pk_bf16_f32 v51, v166, v167
  s_add_u32 s67, s66, 0
  buffer_store_dwordx4 v[48:51], v18, s[32:35], s67 offen offset:0 sc1
  s_waitcnt lgkmcnt(8)
  v_mfma_f32_32x32x16_bf16 v[80:95], v[24:27], v[216:219], v[80:95]
  ds_read_b64_tr_b16 v[44:45], v22 offset:7744
  ds_read_b64_tr_b16 v[46:47], v22 offset:8384
  v_mul_f32 v168, v147, v64
  v_mul_f32 v169, v147, v65
  v_mul_f32 v170, v147, v66
  v_mul_f32 v171, v147, v67
  v_mul_f32 v172, v147, v68
  v_mul_f32 v173, v147, v69
  s_waitcnt lgkmcnt(8)
  v_mfma_f32_32x32x16_bf16 v[80:95], v[28:31], v[220:223], v[80:95]
  ds_read_b64_tr_b16 v[24:25], v22 offset:20800
  ds_read_b64_tr_b16 v[26:27], v22 offset:21440
  v_mul_f32 v174, v147, v70
  v_mul_f32 v175, v147, v71
  v_exp_f32 v168, v168
  v_exp_f32 v169, v169
  s_waitcnt lgkmcnt(8)
  v_mfma_f32_32x32x16_bf16 v[80:95], v[32:35], v[224:227], v[80:95]
  ds_read_b64_tr_b16 v[28:29], v22 offset:23360
  ds_read_b64_tr_b16 v[30:31], v22 offset:24000
  v_exp_f32 v170, v170
  v_exp_f32 v171, v171
  s_waitcnt lgkmcnt(8)
  v_mfma_f32_32x32x16_bf16 v[80:95], v[36:39], v[228:231], v[80:95]
  ds_read_b64_tr_b16 v[32:33], v22 offset:25920
  ds_read_b64_tr_b16 v[34:35], v22 offset:26560
  v_exp_f32 v172, v172
  v_exp_f32 v173, v173
  v_exp_f32 v174, v174
  s_waitcnt lgkmcnt(8)
  v_mfma_f32_32x32x16_bf16 v[80:95], v[40:43], v[232:235], v[80:95]
  ds_read_b64_tr_b16 v[36:37], v22 offset:28480
  ds_read_b64_tr_b16 v[38:39], v22 offset:29120
  v_exp_f32 v175, v175
  v_fma_f32 v168, v168, v146, v146
  v_fma_f32 v169, v169, v146, v146
  s_waitcnt lgkmcnt(8)
  v_mfma_f32_32x32x16_bf16 v[80:95], v[44:47], v[236:239], v[80:95]
  ds_read_b64_tr_b16 v[40:41], v21 offset:96
  ds_read_b64_tr_b16 v[42:43], v21 offset:736
  v_fma_f32 v170, v170, v146, v146
  v_fma_f32 v171, v171, v146, v146
  v_fma_f32 v172, v172, v146, v146
  v_fma_f32 v173, v173, v146, v146
  v_fma_f32 v174, v174, v146, v146
  s_waitcnt lgkmcnt(8)
  v_mfma_f32_32x32x16_bf16 v[80:95], v[24:27], v[240:243], v[80:95]
  ds_read_b64_tr_b16 v[44:45], v21 offset:2656
  ds_read_b64_tr_b16 v[46:47], v21 offset:3296
  v_fma_f32 v175, v175, v146, v146
  v_rcp_f32 v168, v168
  v_rcp_f32 v169, v169
  v_rcp_f32 v170, v170
  s_waitcnt lgkmcnt(8)
  v_mfma_f32_32x32x16_bf16 v[80:95], v[28:31], v[244:247], v[80:95]
  ds_read_b64_tr_b16 v[24:25], v21 offset:5216
  ds_read_b64_tr_b16 v[26:27], v21 offset:5856
  v_rcp_f32 v171, v171
  v_rcp_f32 v172, v172
  s_waitcnt lgkmcnt(8)
  v_mfma_f32_32x32x16_bf16 v[80:95], v[32:35], v[248:251], v[80:95]
  ds_read_b64_tr_b16 v[28:29], v21 offset:7776
  ds_read_b64_tr_b16 v[30:31], v21 offset:8416
  v_rcp_f32 v173, v173
  v_rcp_f32 v174, v174
  v_rcp_f32 v175, v175
  s_waitcnt lgkmcnt(8)
  v_mfma_f32_32x32x16_bf16 v[80:95], v[36:39], v[252:255], v[80:95]
  ds_read_b64_tr_b16 v[32:33], v22 offset:96
  ds_read_b64_tr_b16 v[34:35], v22 offset:736
  v_mul_f32 v168, v168, v72
  v_mul_f32 v169, v169, v73
  v_mul_f32 v170, v170, v74
  v_mul_f32 v171, v171, v75
  v_mfma_f32_32x32x16_bf16 v[80:95], v[132:135], v[142:145], v[80:95]
  s_waitcnt lgkmcnt(8)
  v_mfma_f32_32x32x16_bf16 v[96:111], v[40:43], v[208:211], v[96:111]
  ds_read_b64_tr_b16 v[36:37], v22 offset:2656
  ds_read_b64_tr_b16 v[38:39], v22 offset:3296
  v_mul_f32 v172, v172, v76
  v_mul_f32 v173, v173, v77
  v_mul_f32 v174, v174, v78
  v_mul_f32 v175, v175, v79
  v_cvt_pk_bf16_f32 v64, v168, v169
  s_waitcnt lgkmcnt(8)
  v_mfma_f32_32x32x16_bf16 v[96:111], v[44:47], v[212:215], v[96:111]
  ds_read_b64_tr_b16 v[40:41], v22 offset:5216
  ds_read_b64_tr_b16 v[42:43], v22 offset:5856
  v_cvt_pk_bf16_f32 v65, v170, v171
  v_cvt_pk_bf16_f32 v66, v172, v173
  v_cvt_pk_bf16_f32 v67, v174, v175
  s_add_u32 s67, s66, 131072
  buffer_store_dwordx4 v[64:67], v18, s[32:35], s67 offen offset:0 sc1
  s_waitcnt lgkmcnt(8)
  v_mfma_f32_32x32x16_bf16 v[96:111], v[24:27], v[216:219], v[96:111]
  ds_read_b64_tr_b16 v[44:45], v22 offset:7776
  ds_read_b64_tr_b16 v[46:47], v22 offset:8416
  v_mul_f32 v160, v147, v80
  v_mul_f32 v161, v147, v81
  v_mul_f32 v162, v147, v82
  v_mul_f32 v163, v147, v83
  v_mul_f32 v164, v147, v84
  v_mul_f32 v165, v147, v85
  s_waitcnt lgkmcnt(8)
  v_mfma_f32_32x32x16_bf16 v[96:111], v[28:31], v[220:223], v[96:111]
  ds_read_b64_tr_b16 v[24:25], v22 offset:20832
  ds_read_b64_tr_b16 v[26:27], v22 offset:21472
  v_mul_f32 v166, v147, v86
  v_mul_f32 v167, v147, v87
  v_exp_f32 v160, v160
  v_exp_f32 v161, v161
  s_waitcnt lgkmcnt(8)
  v_mfma_f32_32x32x16_bf16 v[96:111], v[32:35], v[224:227], v[96:111]
  ds_read_b64_tr_b16 v[28:29], v22 offset:23392
  ds_read_b64_tr_b16 v[30:31], v22 offset:24032
  v_exp_f32 v162, v162
  v_exp_f32 v163, v163
  s_waitcnt lgkmcnt(8)
  v_mfma_f32_32x32x16_bf16 v[96:111], v[36:39], v[228:231], v[96:111]
  ds_read_b64_tr_b16 v[32:33], v22 offset:25952
  ds_read_b64_tr_b16 v[34:35], v22 offset:26592
  v_exp_f32 v164, v164
  v_exp_f32 v165, v165
  v_exp_f32 v166, v166
  s_waitcnt lgkmcnt(8)
  v_mfma_f32_32x32x16_bf16 v[96:111], v[40:43], v[232:235], v[96:111]
  ds_read_b64_tr_b16 v[36:37], v22 offset:28512
  ds_read_b64_tr_b16 v[38:39], v22 offset:29152
  v_exp_f32 v167, v167
  v_fma_f32 v160, v160, v146, v146
  v_fma_f32 v161, v161, v146, v146
  s_waitcnt lgkmcnt(8)
  v_mfma_f32_32x32x16_bf16 v[96:111], v[44:47], v[236:239], v[96:111]
  ds_read_b64_tr_b16 v[40:41], v21 offset:128
  ds_read_b64_tr_b16 v[42:43], v21 offset:768
  v_fma_f32 v162, v162, v146, v146
  v_fma_f32 v163, v163, v146, v146
  v_fma_f32 v164, v164, v146, v146
  v_fma_f32 v165, v165, v146, v146
  v_fma_f32 v166, v166, v146, v146
  s_waitcnt lgkmcnt(8)
  v_mfma_f32_32x32x16_bf16 v[96:111], v[24:27], v[240:243], v[96:111]
  ds_read_b64_tr_b16 v[44:45], v21 offset:2688
  ds_read_b64_tr_b16 v[46:47], v21 offset:3328
  v_fma_f32 v167, v167, v146, v146
  v_rcp_f32 v160, v160
  v_rcp_f32 v161, v161
  v_rcp_f32 v162, v162
  s_waitcnt lgkmcnt(8)
  v_mfma_f32_32x32x16_bf16 v[96:111], v[28:31], v[244:247], v[96:111]
  ds_read_b64_tr_b16 v[24:25], v21 offset:5248
  ds_read_b64_tr_b16 v[26:27], v21 offset:5888
  v_rcp_f32 v163, v163
  v_rcp_f32 v164, v164
  s_waitcnt lgkmcnt(8)
  v_mfma_f32_32x32x16_bf16 v[96:111], v[32:35], v[248:251], v[96:111]
  ds_read_b64_tr_b16 v[28:29], v21 offset:7808
  ds_read_b64_tr_b16 v[30:31], v21 offset:8448
  v_rcp_f32 v165, v165
  v_rcp_f32 v166, v166
  v_rcp_f32 v167, v167
  s_waitcnt lgkmcnt(8)
  v_mfma_f32_32x32x16_bf16 v[96:111], v[36:39], v[252:255], v[96:111]
  ds_read_b64_tr_b16 v[32:33], v22 offset:128
  ds_read_b64_tr_b16 v[34:35], v22 offset:768
  v_mul_f32 v160, v160, v88
  v_mul_f32 v161, v161, v89
  v_mul_f32 v162, v162, v90
  v_mul_f32 v163, v163, v91
  v_mfma_f32_32x32x16_bf16 v[96:111], v[134:137], v[142:145], v[96:111]
  s_waitcnt lgkmcnt(8)
  v_mfma_f32_32x32x16_bf16 v[112:127], v[40:43], v[208:211], v[112:127]
  ds_read_b64_tr_b16 v[36:37], v22 offset:2688
  ds_read_b64_tr_b16 v[38:39], v22 offset:3328
  v_mul_f32 v164, v164, v92
  v_mul_f32 v165, v165, v93
  v_mul_f32 v166, v166, v94
  v_mul_f32 v167, v167, v95
  v_cvt_pk_bf16_f32 v80, v160, v161
  s_waitcnt lgkmcnt(8)
  v_mfma_f32_32x32x16_bf16 v[112:127], v[44:47], v[212:215], v[112:127]
  ds_read_b64_tr_b16 v[40:41], v22 offset:5248
  ds_read_b64_tr_b16 v[42:43], v22 offset:5888
  v_cvt_pk_bf16_f32 v81, v162, v163
  v_cvt_pk_bf16_f32 v82, v164, v165
  v_cvt_pk_bf16_f32 v83, v166, v167
  s_add_u32 s67, s66, 262144
  buffer_store_dwordx4 v[80:83], v18, s[32:35], s67 offen offset:0 sc1
  s_waitcnt lgkmcnt(8)
  v_mfma_f32_32x32x16_bf16 v[112:127], v[24:27], v[216:219], v[112:127]
  ds_read_b64_tr_b16 v[44:45], v22 offset:7808
  ds_read_b64_tr_b16 v[46:47], v22 offset:8448
  v_mul_f32 v168, v147, v96
  v_mul_f32 v169, v147, v97
  v_mul_f32 v170, v147, v98
  v_mul_f32 v171, v147, v99
  v_mul_f32 v172, v147, v100
  v_mul_f32 v173, v147, v101
  s_waitcnt lgkmcnt(8)
  v_mfma_f32_32x32x16_bf16 v[112:127], v[28:31], v[220:223], v[112:127]
  ds_read_b64_tr_b16 v[24:25], v22 offset:20864
  ds_read_b64_tr_b16 v[26:27], v22 offset:21504
  v_mul_f32 v174, v147, v102
  v_mul_f32 v175, v147, v103
  v_exp_f32 v168, v168
  v_exp_f32 v169, v169
  s_waitcnt lgkmcnt(8)
  v_mfma_f32_32x32x16_bf16 v[112:127], v[32:35], v[224:227], v[112:127]
  ds_read_b64_tr_b16 v[28:29], v22 offset:23424
  ds_read_b64_tr_b16 v[30:31], v22 offset:24064
  v_exp_f32 v170, v170
  v_exp_f32 v171, v171
  s_waitcnt lgkmcnt(8)
  v_mfma_f32_32x32x16_bf16 v[112:127], v[36:39], v[228:231], v[112:127]
  ds_read_b64_tr_b16 v[32:33], v22 offset:25984
  ds_read_b64_tr_b16 v[34:35], v22 offset:26624
  v_exp_f32 v172, v172
  v_exp_f32 v173, v173
  v_exp_f32 v174, v174
  s_waitcnt lgkmcnt(8)
  v_mfma_f32_32x32x16_bf16 v[112:127], v[40:43], v[232:235], v[112:127]
  ds_read_b64_tr_b16 v[36:37], v22 offset:28544
  ds_read_b64_tr_b16 v[38:39], v22 offset:29184
  v_mov_b32 v12, 8
  ds_write_b32 v16, v12 offset:1024
  v_exp_f32 v175, v175
  v_fma_f32 v168, v168, v146, v146
  v_fma_f32 v169, v169, v146, v146
  s_waitcnt lgkmcnt(9)
  v_mfma_f32_32x32x16_bf16 v[112:127], v[44:47], v[236:239], v[112:127]
  v_fma_f32 v170, v170, v146, v146
  v_fma_f32 v171, v171, v146, v146
  v_fma_f32 v172, v172, v146, v146
  v_fma_f32 v173, v173, v146, v146
  v_fma_f32 v174, v174, v146, v146
  s_waitcnt lgkmcnt(7)
  v_mfma_f32_32x32x16_bf16 v[112:127], v[24:27], v[240:243], v[112:127]
  v_fma_f32 v175, v175, v146, v146
  v_rcp_f32 v168, v168
  v_rcp_f32 v169, v169
  v_rcp_f32 v170, v170
  s_waitcnt lgkmcnt(5)
  v_mfma_f32_32x32x16_bf16 v[112:127], v[28:31], v[244:247], v[112:127]
  v_rcp_f32 v171, v171
  v_rcp_f32 v172, v172
  s_waitcnt lgkmcnt(3)
  v_mfma_f32_32x32x16_bf16 v[112:127], v[32:35], v[248:251], v[112:127]
  ds_read_b32 v14, v17 offset:1024
  v_rcp_f32 v173, v173
  v_rcp_f32 v174, v174
  v_rcp_f32 v175, v175
  s_waitcnt lgkmcnt(2)
  v_mfma_f32_32x32x16_bf16 v[112:127], v[36:39], v[252:255], v[112:127]
  v_mul_f32 v168, v168, v104
  v_mul_f32 v169, v169, v105
  v_mul_f32 v170, v170, v106
  v_mul_f32 v171, v171, v107
  v_mfma_f32_32x32x16_bf16 v[112:127], v[136:139], v[142:145], v[112:127]
  v_mul_f32 v172, v172, v108
  v_mul_f32 v173, v173, v109
  v_mul_f32 v174, v174, v110
  v_mul_f32 v175, v175, v111
  v_cvt_pk_bf16_f32 v96, v168, v169
  v_cvt_pk_bf16_f32 v97, v170, v171
  v_cvt_pk_bf16_f32 v98, v172, v173
  v_cvt_pk_bf16_f32 v99, v174, v175
  s_add_u32 s67, s66, 393216
  buffer_store_dwordx4 v[96:99], v18, s[32:35], s67 offen offset:0 sc1
  s_nop 1
  v_mul_f32 v160, v147, v112
  v_mul_f32 v161, v147, v113
  v_mul_f32 v162, v147, v114
  v_mul_f32 v163, v147, v115
  v_mul_f32 v164, v147, v116
  v_mul_f32 v165, v147, v117
  v_mul_f32 v166, v147, v118
  v_mul_f32 v167, v147, v119
  v_exp_f32 v160, v160
  v_exp_f32 v161, v161
  v_exp_f32 v162, v162
  v_exp_f32 v163, v163
  v_exp_f32 v164, v164
  v_exp_f32 v165, v165
  v_exp_f32 v166, v166
  v_exp_f32 v167, v167
  v_fma_f32 v160, v160, v146, v146
  v_fma_f32 v161, v161, v146, v146
  v_fma_f32 v162, v162, v146, v146
  v_fma_f32 v163, v163, v146, v146
  v_fma_f32 v164, v164, v146, v146
  v_fma_f32 v165, v165, v146, v146
  v_fma_f32 v166, v166, v146, v146
  v_fma_f32 v167, v167, v146, v146
  v_rcp_f32 v160, v160
  v_rcp_f32 v161, v161
  v_rcp_f32 v162, v162
  v_rcp_f32 v163, v163
  v_rcp_f32 v164, v164
  v_rcp_f32 v165, v165
  v_rcp_f32 v166, v166
  v_rcp_f32 v167, v167
  v_mul_f32 v160, v160, v120
  v_mul_f32 v161, v161, v121
  v_mul_f32 v162, v162, v122
  v_mul_f32 v163, v163, v123
  v_mul_f32 v164, v164, v124
  v_mul_f32 v165, v165, v125
  v_mul_f32 v166, v166, v126
  v_mul_f32 v167, v167, v127
  v_cvt_pk_bf16_f32 v112, v160, v161
  v_cvt_pk_bf16_f32 v113, v162, v163
  v_cvt_pk_bf16_f32 v114, v164, v165
  v_cvt_pk_bf16_f32 v115, v166, v167
  s_add_u32 s67, s66, 524288
  buffer_store_dwordx4 v[112:115], v18, s[32:35], s67 offen offset:0 sc1
  v_mov_b32 v149, s12
  s_waitcnt vmcnt(2)
  s_mov_b64 exec, 1
  buffer_store_dword v149, off, s[28:31], s69 offset:0 sc1
  s_mov_b64 exec, -1
  s_waitcnt lgkmcnt(0)
  v_cmp_gt_u32 vcc, 8, v14
  s_nop 1
  s_cbranch_vccnz lw21
lw21x:
  s_add_u32 m0, s6, 0
  s_add_u32 s7, s44, 49152
  buffer_load_dwordx4 v2, s[48:51], s7 offen lds
  s_add_u32 m0, s6, 1024
  s_add_u32 s7, s44, 57344
  buffer_load_dwordx4 v2, s[48:51], s7 offen lds
  s_add_u32 m0, s6, 8192
  s_add_u32 s7, s45, 49152
  buffer_load_dwordx4 v2, s[48:51], s7 offen lds
  s_add_u32 m0, s6, 9216
  s_add_u32 s7, s45, 57344
  buffer_load_dwordx4 v2, s[48:51], s7 offen lds
  s_add_u32 m0, s6, 16384
  s_add_u32 s7, s46, 49152
  buffer_load_dwordx4 v2, s[48:51], s7 offen lds
  s_add_u32 m0, s6, 17408
  s_add_u32 s7, s46, 57344
  buffer_load_dwordx4 v2, s[48:51], s7 offen lds
  s_add_u32 m0, s6, 24576
  s_add_u32 s7, s47, 49152
  buffer_load_dwordx4 v2, s[48:51], s7 offen lds
  s_add_u32 m0, s6, 25600
  s_add_u32 s7, s47, 57344
  buffer_load_dwordx4 v2, s[48:51], s7 offen lds
  v_add_u32 v20, 131328, v4
  v_add_u32 v21, 131328, v5
  v_mov_b32 v14, s12
  s_waitcnt vmcnt(9)
  s_mov_b64 exec, 1
  buffer_store_dword v14, off, s[28:31], s69 offset:1024 sc1
  s_mov_b64 exec, -1
  s_setprio 0
  s_add_u32 m0, s6, 32768
  s_add_u32 s7, s44, 65536
  buffer_load_dwordx4 v2, s[48:51], s7 offen lds
  s_add_u32 m0, s6, 33792
  s_add_u32 s7, s44, 73728
  buffer_load_dwordx4 v2, s[48:51], s7 offen lds
  s_add_u32 m0, s6, 40960
  s_add_u32 s7, s45, 65536
  buffer_load_dwordx4 v2, s[48:51], s7 offen lds
  s_add_u32 m0, s6, 41984
  s_add_u32 s7, s45, 73728
  buffer_load_dwordx4 v2, s[48:51], s7 offen lds
  s_add_u32 m0, s6, 49152
  s_add_u32 s7, s46, 65536
  buffer_load_dwordx4 v2, s[48:51], s7 offen lds
  s_add_u32 m0, s6, 50176
  s_add_u32 s7, s46, 73728
  buffer_load_dwordx4 v2, s[48:51], s7 offen lds
  s_add_u32 m0, s6, 131328
  s_add_u32 s7, s47, 65536
  buffer_load_dwordx4 v2, s[48:51], s7 offen lds
  s_add_u32 m0, s6, 132352
  s_add_u32 s7, s47, 73728
  buffer_load_dwordx4 v2, s[48:51], s7 offen lds
  s_add_u32 m0, s6, 139520
  s_add_u32 s7, s44, 81920
  buffer_load_dwordx4 v2, s[48:51], s7 offen lds
  s_add_u32 m0, s6, 140544
  s_add_u32 s7, s44, 90112
  buffer_load_dwordx4 v2, s[48:51], s7 offen lds
  s_add_u32 m0, s6, 147712
  s_add_u32 s7, s45, 81920
  buffer_load_dwordx4 v2, s[48:51], s7 offen lds
  s_add_u32 m0, s6, 148736
  s_add_u32 s7, s45, 90112
  buffer_load_dwordx4 v2, s[48:51], s7 offen lds
  s_load_dword s36, s[70:71], s68 offset:1024 glc
  s_load_dword s37, s[70:71], s68 offset:1152 glc
  s_load_dword s38, s[70:71], s68 offset:1280 glc
  s_load_dword s39, s[70:71], s68 offset:1408 glc
  s_load_dword s40, s[70:71], s68 offset:1536 glc
  s_load_dword s41, s[70:71], s68 offset:1664 glc
  s_load_dword s42, s[70:71], s68 offset:1792 glc
  s_load_dword s43, s[70:71], s68 offset:1920 glc
  s_waitcnt lgkmcnt(0)
  s_xor_b64 s[36:37], s[36:37], s[100:101]
  s_xor_b64 s[38:39], s[38:39], s[100:101]
  s_xor_b64 s[40:41], s[40:41], s[100:101]
  s_xor_b64 s[42:43], s[42:43], s[100:101]
  s_or_b64 s[36:37], s[36:37], s[38:39]
  s_or_b64 s[36:37], s[36:37], s[40:41]
  s_or_b64 s[36:37], s[36:37], s[42:43]
  s_cbranch_scc1 sf22
sf22x:
  s_lshl3_add_u32 s64, s44, 0x60000
  buffer_load_dwordx4 v[176:179], v3, s[32:35], s64 offen offset:0 sc1
  buffer_load_dwordx4 v[180:183], v3, s[32:35], s64 offen offset:2048 sc1
  s_lshl3_add_u32 s64, s45, 0x60000
  buffer_load_dwordx4 v[184:187], v3, s[32:35], s64 offen offset:0 sc1
  buffer_load_dwordx4 v[188:191], v3, s[32:35], s64 offen offset:2048 sc1
  s_lshl3_add_u32 s64, s46, 0x60000
  buffer_load_dwordx4 v[192:195], v3, s[32:35], s64 offen offset:0 sc1
  buffer_load_dwordx4 v[196:199], v3, s[32:35], s64 offen offset:2048 sc1
  s_lshl3_add_u32 s64, s47, 0x60000
  buffer_load_dwordx4 v[200:203], v3, s[32:35], s64 offen offset:0 sc1
  buffer_load_dwordx4 v[204:207], v3, s[32:35], s64 offen offset:2048 sc1
  s_lshl3_add_u32 s64, s44, 0x80000
  buffer_load_dwordx4 v[208:211], v3, s[32:35], s64 offen offset:0 sc1
  buffer_load_dwordx4 v[212:215], v3, s[32:35], s64 offen offset:2048 sc1
  s_lshl3_add_u32 s64, s45, 0x80000
  buffer_load_dwordx4 v[216:219], v3, s[32:35], s64 offen offset:0 sc1
  buffer_load_dwordx4 v[220:223], v3, s[32:35], s64 offen offset:2048 sc1
  s_lshl3_add_u32 s64, s46, 0x80000
  buffer_load_dwordx4 v[224:227], v3, s[32:35], s64 offen offset:0 sc1
  buffer_load_dwordx4 v[228:231], v3, s[32:35], s64 offen offset:2048 sc1
  s_lshl3_add_u32 s64, s47, 0x80000
  buffer_load_dwordx4 v[232:235], v3, s[32:35], s64 offen offset:0 sc1
  buffer_load_dwordx4 v[236:239], v3, s[32:35], s64 offen offset:2048 sc1
  s_lshl3_add_u32 s64, s44, 0xa0000
  buffer_load_dwordx4 v[240:243], v3, s[32:35], s64 offen offset:0 sc1
  buffer_load_dwordx4 v[244:247], v3, s[32:35], s64 offen offset:2048 sc1
  s_lshl3_add_u32 s64, s45, 0xa0000
  buffer_load_dwordx4 v[248:251], v3, s[32:35], s64 offen offset:0 sc1
  buffer_load_dwordx4 v[252:255], v3, s[32:35], s64 offen offset:2048 sc1
  buffer_load_dwordx4 v[8:11], v6, s[56:59], 0 offen
  s_waitcnt vmcnt(40)
  ds_read_b64_tr_b16 v[96:97], v4 offset:0
  ds_read_b64_tr_b16 v[98:99], v4 offset:1024
  ds_read_b64_tr_b16 v[100:101], v5 offset:0
  ds_read_b64_tr_b16 v[102:103], v5 offset:1024
  s_waitcnt vmcnt(38)
  ds_read_b64_tr_b16 v[104:105], v4 offset:8192
  ds_read_b64_tr_b16 v[106:107], v4 offset:9216
  ds_read_b64_tr_b16 v[108:109], v5 offset:8192
  ds_read_b64_tr_b16 v[110:111], v5 offset:9216
  s_waitcnt vmcnt(36)
  ds_read_b64_tr_b16 v[112:113], v4 offset:16384
  ds_read_b64_tr_b16 v[114:115], v4 offset:17408
  ds_read_b64_tr_b16 v[116:117], v5 offset:16384
  ds_read_b64_tr_b16 v[118:119], v5 offset:17408
  s_waitcnt vmcnt(34)
  ds_read_b64_tr_b16 v[120:121], v4 offset:24576
  ds_read_b64_tr_b16 v[122:123], v4 offset:25600
  ds_read_b64_tr_b16 v[124:125], v5 offset:24576
  ds_read_b64_tr_b16 v[126:127], v5 offset:25600
  s_waitcnt vmcnt(31)
  ds_read_b64_tr_b16 v[128:129], v4 offset:32768
  ds_read_b64_tr_b16 v[130:131], v4 offset:33792
  ds_read_b64_tr_b16 v[132:133], v5 offset:32768
  ds_read_b64_tr_b16 v[134:135], v5 offset:33792
  s_waitcnt vmcnt(29)
  ds_read_b64_tr_b16 v[136:137], v4 offset:40960
  ds_read_b64_tr_b16 v[138:139], v4 offset:41984
  ds_read_b64_tr_b16 v[140:141], v5 offset:40960
  ds_read_b64_tr_b16 v[142:143], v5 offset:41984
  s_waitcnt vmcnt(27)
  ds_read_b64_tr_b16 v[144:145], v4 offset:49152
  ds_read_b64_tr_b16 v[146:147], v4 offset:50176
  ds_read_b64_tr_b16 v[148:149], v5 offset:49152
  ds_read_b64_tr_b16 v[150:151], v5 offset:50176
  s_waitcnt vmcnt(25)
  ds_read_b64_tr_b16 v[152:153], v20 offset:0
  ds_read_b64_tr_b16 v[154:155], v20 offset:1024
  ds_read_b64_tr_b16 v[156:157], v21 offset:0
  ds_read_b64_tr_b16 v[158:159], v21 offset:1024
  s_waitcnt vmcnt(23)
  ds_read_b64_tr_b16 v[160:161], v20 offset:8192
  ds_read_b64_tr_b16 v[162:163], v20 offset:9216
  ds_read_b64_tr_b16 v[164:165], v21 offset:8192
  ds_read_b64_tr_b16 v[166:167], v21 offset:9216
  s_waitcnt vmcnt(21)
  ds_read_b64_tr_b16 v[168:169], v20 offset:16384
  ds_read_b64_tr_b16 v[170:171], v20 offset:17408
  ds_read_b64_tr_b16 v[172:173], v21 offset:16384
  ds_read_b64_tr_b16 v[174:175], v21 offset:17408
  s_waitcnt vmcnt(20) lgkmcnt(15)
  v_mfma_f32_32x32x16_bf16 v[32:47], v[96:99], v[176:179], 0
  v_mfma_f32_32x32x16_bf16 v[48:63], v[100:103], v[176:179], 0
  s_waitcnt vmcnt(19)
  v_mfma_f32_32x32x16_bf16 v[80:95], v[100:103], v[180:183], 0
  v_mfma_f32_32x32x16_bf16 v[64:79], v[96:99], v[180:183], 0
  s_waitcnt vmcnt(18)
  v_mfma_f32_32x32x16_bf16 v[32:47], v[104:107], v[184:187], v[32:47]
  v_mfma_f32_32x32x16_bf16 v[48:63], v[108:111], v[184:187], v[48:63]
  s_waitcnt vmcnt(17)
  v_mfma_f32_32x32x16_bf16 v[80:95], v[108:111], v[188:191], v[80:95]
  v_mfma_f32_32x32x16_bf16 v[64:79], v[104:107], v[188:191], v[64:79]
  s_waitcnt vmcnt(16)
  v_mfma_f32_32x32x16_bf16 v[32:47], v[112:115], v[192:195], v[32:47]
  v_mfma_f32_32x32x16_bf16 v[48:63], v[116:119], v[192:195], v[48:63]
  s_waitcnt vmcnt(15)
  v_mfma_f32_32x32x16_bf16 v[80:95], v[116:119], v[196:199], v[80:95]
  v_mfma_f32_32x32x16_bf16 v[64:79], v[112:115], v[196:199], v[64:79]
  s_waitcnt vmcnt(14)
  v_mfma_f32_32x32x16_bf16 v[32:47], v[120:123], v[200:203], v[32:47]
  v_mfma_f32_32x32x16_bf16 v[48:63], v[124:127], v[200:203], v[48:63]
  s_waitcnt vmcnt(13)
  v_mfma_f32_32x32x16_bf16 v[80:95], v[124:127], v[204:207], v[80:95]
  v_mfma_f32_32x32x16_bf16 v[64:79], v[120:123], v[204:207], v[64:79]
  s_waitcnt vmcnt(12)
  v_mfma_f32_32x32x16_bf16 v[32:47], v[128:131], v[208:211], v[32:47]
  v_mfma_f32_32x32x16_bf16 v[48:63], v[132:135], v[208:211], v[48:63]
  s_waitcnt vmcnt(11)
  v_mfma_f32_32x32x16_bf16 v[80:95], v[132:135], v[212:215], v[80:95]
  v_mfma_f32_32x32x16_bf16 v[64:79], v[128:131], v[212:215], v[64:79]
  s_waitcnt vmcnt(10)
  v_mfma_f32_32x32x16_bf16 v[32:47], v[136:139], v[216:219], v[32:47]
  v_mfma_f32_32x32x16_bf16 v[48:63], v[140:143], v[216:219], v[48:63]
  s_waitcnt vmcnt(9)
  v_mfma_f32_32x32x16_bf16 v[80:95], v[140:143], v[220:223], v[80:95]
  v_mfma_f32_32x32x16_bf16 v[64:79], v[136:139], v[220:223], v[64:79]
  s_waitcnt vmcnt(8) lgkmcnt(14)
  v_mfma_f32_32x32x16_bf16 v[32:47], v[144:147], v[224:227], v[32:47]
  s_waitcnt lgkmcnt(12)
  v_mfma_f32_32x32x16_bf16 v[48:63], v[148:151], v[224:227], v[48:63]
  s_waitcnt vmcnt(7)
  v_mfma_f32_32x32x16_bf16 v[80:95], v[148:151], v[228:231], v[80:95]
  v_mfma_f32_32x32x16_bf16 v[64:79], v[144:147], v[228:231], v[64:79]
  s_waitcnt vmcnt(6) lgkmcnt(10)
  v_mfma_f32_32x32x16_bf16 v[32:47], v[152:155], v[232:235], v[32:47]
  s_waitcnt lgkmcnt(8)
  v_mfma_f32_32x32x16_bf16 v[48:63], v[156:159], v[232:235], v[48:63]
  s_waitcnt vmcnt(5)
  v_mfma_f32_32x32x16_bf16 v[80:95], v[156:159], v[236:239], v[80:95]
  v_mfma_f32_32x32x16_bf16 v[64:79], v[152:155], v[236:239], v[64:79]
  s_waitcnt vmcnt(4) lgkmcnt(6)
  v_mfma_f32_32x32x16_bf16 v[32:47], v[160:163], v[240:243], v[32:47]
  s_waitcnt lgkmcnt(4)
  v_mfma_f32_32x32x16_bf16 v[48:63], v[164:167], v[240:243], v[48:63]
  s_waitcnt vmcnt(3)
  v_mfma_f32_32x32x16_bf16 v[80:95], v[164:167], v[244:247], v[80:95]
  v_mfma_f32_32x32x16_bf16 v[64:79], v[160:163], v[244:247], v[64:79]
  s_waitcnt vmcnt(2) lgkmcnt(2)
  v_mfma_f32_32x32x16_bf16 v[32:47], v[168:171], v[248:251], v[32:47]
  s_waitcnt lgkmcnt(0)
  v_mfma_f32_32x32x16_bf16 v[48:63], v[172:175], v[248:251], v[48:63]
  s_waitcnt vmcnt(1)
  v_mfma_f32_32x32x16_bf16 v[80:95], v[172:175], v[252:255], v[80:95]
  v_mfma_f32_32x32x16_bf16 v[64:79], v[168:171], v[252:255], v[64:79]
  s_waitcnt vmcnt(0)
  s_branch parallel_sum__linear_kernel_hedgehog__glu_gated_glu__prompt_kernel_tail
lw10:
  s_mov_b32 s14, 0x40000
lw10l:
  ds_read_b32 v13, v17 offset:0
  s_sub_u32 s14, s14, 1
  s_waitcnt lgkmcnt(0)
  s_cbranch_scc1 lw10x
  v_cmp_gt_u32 vcc, 1, v13
  s_nop 1
  s_cbranch_vccnz lw10l
  s_branch lw10x
lw11:
  s_mov_b32 s14, 0x40000
lw11l:
  ds_read_b32 v15, v17 offset:2048
  s_sub_u32 s14, s14, 1
  s_waitcnt lgkmcnt(0)
  s_cbranch_scc1 lw11x
  v_cmp_gt_u32 vcc, 1, v15
  s_nop 1
  s_cbranch_vccnz lw11l
  s_branch lw11x
lw12:
  s_mov_b32 s14, 0x40000
lw12l:
  ds_read_b32 v14, v17 offset:1024
  s_sub_u32 s14, s14, 1
  s_waitcnt lgkmcnt(0)
  s_cbranch_scc1 lw12x
  v_cmp_gt_u32 vcc, 1, v14
  s_nop 1
  s_cbranch_vccnz lw12l
  s_branch lw12x
lw13:
  s_mov_b32 s14, 0x40000
lw13l:
  ds_read_b32 v13, v17 offset:0
  s_sub_u32 s14, s14, 1
  s_waitcnt lgkmcnt(0)
  s_cbranch_scc1 lw13x
  v_cmp_gt_u32 vcc, 2, v13
  s_nop 1
  s_cbranch_vccnz lw13l
  s_branch lw13x
lw14:
  s_mov_b32 s14, 0x40000
lw14l:
  ds_read_b32 v14, v17 offset:1024
  s_sub_u32 s14, s14, 1
  s_waitcnt lgkmcnt(0)
  s_cbranch_scc1 lw14x
  v_cmp_gt_u32 vcc, 2, v14
  s_nop 1
  s_cbranch_vccnz lw14l
  s_branch lw14x
lw15:
  s_mov_b32 s14, 0x40000
lw15l:
  ds_read_b32 v13, v17 offset:0
  s_sub_u32 s14, s14, 1
  s_waitcnt lgkmcnt(0)
  s_cbranch_scc1 lw15x
  v_cmp_gt_u32 vcc, 3, v13
  s_nop 1
  s_cbranch_vccnz lw15l
  s_branch lw15x
lw16:
  s_mov_b32 s14, 0x40000
lw16l:
  ds_read_b32 v14, v17 offset:1024
  s_sub_u32 s14, s14, 1
  s_waitcnt lgkmcnt(0)
  s_cbranch_scc1 lw16x
  v_cmp_gt_u32 vcc, 3, v14
  s_nop 1
  s_cbranch_vccnz lw16l
  s_branch lw16x
lw17:
  s_mov_b32 s14, 0x40000
lw17l:
  ds_read_b32 v13, v17 offset:0
  s_sub_u32 s14, s14, 1
  s_waitcnt lgkmcnt(0)
  s_cbranch_scc1 lw17x
  v_cmp_gt_u32 vcc, 4, v13
  s_nop 1
  s_cbranch_vccnz lw17l
  s_branch lw17x
lw18:
  s_mov_b32 s14, 0x40000
lw18l:
  ds_read_b32 v13, v17 offset:0
  s_sub_u32 s14, s14, 1
  s_waitcnt lgkmcnt(0)
  s_cbranch_scc1 lw18x
  v_cmp_gt_u32 vcc, 6, v13
  s_nop 1
  s_cbranch_vccnz lw18l
  s_branch lw18x
lw19:
  s_mov_b32 s14, 0x40000
lw19l:
  ds_read_b32 v13, v17 offset:0
  s_sub_u32 s14, s14, 1
  s_waitcnt lgkmcnt(0)
  s_cbranch_scc1 lw19x
  v_cmp_gt_u32 vcc, 7, v13
  s_nop 1
  s_cbranch_vccnz lw19l
  s_branch lw19x
lw20:
  s_mov_b32 s14, 0x40000
lw20l:
  ds_read_b32 v15, v17 offset:2048
  s_sub_u32 s14, s14, 1
  s_waitcnt lgkmcnt(0)
  s_cbranch_scc1 lw20x
  v_cmp_gt_u32 vcc, 2, v15
  s_nop 1
  s_cbranch_vccnz lw20l
  s_branch lw20x
lw21:
  s_mov_b32 s14, 0x40000
lw21l:
  ds_read_b32 v14, v17 offset:1024
  s_sub_u32 s14, s14, 1
  s_waitcnt lgkmcnt(0)
  s_cbranch_scc1 lw21x
  v_cmp_gt_u32 vcc, 8, v14
  s_nop 1
  s_cbranch_vccnz lw21l
  s_branch lw21x
sf22:
  s_mov_b32 s14, 0x40000
sf22l:
  s_load_dword s36, s[70:71], s68 offset:1024 glc
  s_load_dword s37, s[70:71], s68 offset:1152 glc
  s_load_dword s38, s[70:71], s68 offset:1280 glc
  s_load_dword s39, s[70:71], s68 offset:1408 glc
  s_load_dword s40, s[70:71], s68 offset:1536 glc
  s_load_dword s41, s[70:71], s68 offset:1664 glc
  s_load_dword s42, s[70:71], s68 offset:1792 glc
  s_load_dword s43, s[70:71], s68 offset:1920 glc
  s_sub_u32 s14, s14, 1
  s_waitcnt lgkmcnt(0)
  s_cbranch_scc1 sf22x
  s_xor_b64 s[36:37], s[36:37], s[100:101]
  s_xor_b64 s[38:39], s[38:39], s[100:101]
  s_xor_b64 s[40:41], s[40:41], s[100:101]
  s_xor_b64 s[42:43], s[42:43], s[100:101]
  s_or_b64 s[36:37], s[36:37], s[38:39]
  s_or_b64 s[36:37], s[36:37], s[40:41]
  s_or_b64 s[36:37], s[36:37], s[42:43]
  s_cbranch_scc1 sf22l
  s_branch sf22x
.fill (16384 - (. - parallel_sum__linear_kernel_hedgehog__glu_gated_glu__prompt_kernel))/4, 4, 0xBF810000
parallel_sum__linear_kernel_hedgehog__glu_gated_glu__prompt_kernel_b3:
  s_waitcnt vmcnt(12)
  s_waitcnt lgkmcnt(0)
  s_barrier
  s_cmp_lg_u32 s19, 0
  s_cbranch_scc1 xj23_0
  ds_read_b128 v[128:131], v32 offset:49216
  ds_read_b128 v[132:135], v33 offset:49216
  ds_read_b128 v[136:139], v34 offset:49216
  ds_read_b128 v[140:143], v35 offset:49216
  s_branch xj23
xj23_0:
  ds_read_b128 v[240:243], v32 offset:49216
  ds_read_b128 v[244:247], v33 offset:49216
  ds_read_b128 v[248:251], v34 offset:49216
  ds_read_b128 v[252:255], v35 offset:49216
xj23:
  s_add_u32 s9, s18, 3
  s_and_b32 s9, s9, 7
  s_lshl_b32 s8, s9, 7
  s_mul_i32 s9, s9, 196608
  s_add_u32 m0, s10, 0
  s_add_u32 s7, s8, 0
  buffer_load_dwordx4 v24, s[56:59], s7 offen lds
  s_add_u32 m0, s10, 4096
  s_add_u32 s7, s8, 32768
  buffer_load_dwordx4 v24, s[56:59], s7 offen lds
  s_add_u32 m0, s10, 8192
  s_add_u32 s7, s8, 65536
  buffer_load_dwordx4 v24, s[56:59], s7 offen lds
  s_add_u32 m0, s10, 12288
  s_add_u32 s7, s8, 98304
  buffer_load_dwordx4 v24, s[56:59], s7 offen lds
  s_add_u32 m0, s10, 16384
  s_add_u32 s7, s9, 0
  buffer_load_dwordx4 v25, s[36:39], s7 offen lds
  s_add_u32 m0, s10, 20480
  s_add_u32 s7, s9, 98304
  buffer_load_dwordx4 v25, s[36:39], s7 offen lds
  s_waitcnt vmcnt(12)
  s_waitcnt lgkmcnt(0)
  s_barrier
  s_cmp_lg_u32 s19, 0
  s_cbranch_scc1 xj24_0
  ds_read_b128 v[144:147], v36 offset:0
  ds_read_b128 v[148:151], v37 offset:0
  ds_read_b128 v[152:155], v38 offset:0
  ds_read_b128 v[156:159], v39 offset:0
  s_branch xj24
xj24_0:
  ds_read_b128 v[128:131], v36 offset:0
  ds_read_b128 v[132:135], v37 offset:0
  ds_read_b128 v[136:139], v38 offset:0
  ds_read_b128 v[140:143], v39 offset:0
xj24:
  s_add_u32 s9, s18, 4
  s_and_b32 s9, s9, 7
  s_lshl_b32 s8, s9, 7
  s_mul_i32 s9, s9, 196608
  s_add_u32 m0, s10, 24608
  s_add_u32 s7, s8, 0
  buffer_load_dwordx4 v24, s[56:59], s7 offen lds
  s_mul_i32 s64, s23, 88064
  s_lshl_b32 s65, s26, 5
  s_add_u32 s64, s64, s65
  v_add_u32 v12, 0, v1
  v_mul_u32_u24 v13, 5462, v12
  v_lshrrev_b32 v13, 16, v13
  v_mul_u32_u24 v13, 2560, v13
  v_lshl_add_u32 v13, v12, 4, v13
  s_add_u32 m0, s10, 28704
  s_add_u32 s7, s8, 32768
  buffer_load_dwordx4 v24, s[56:59], s7 offen lds
  v_add_u32 v2, s64, v13
  v_add_u32 v12, 64, v1
  v_mul_u32_u24 v13, 5462, v12
  v_lshrrev_b32 v13, 16, v13
  v_mul_u32_u24 v13, 2560, v13
  v_lshl_add_u32 v13, v12, 4, v13
  v_add_u32 v3, s64, v13
  v_add_u32 v12, 128, v1
  s_add_u32 m0, s10, 32800
  s_add_u32 s7, s8, 65536
  buffer_load_dwordx4 v24, s[56:59], s7 offen lds
  v_mul_u32_u24 v13, 5462, v12
  v_lshrrev_b32 v13, 16, v13
  v_mul_u32_u24 v13, 2560, v13
  v_lshl_add_u32 v13, v12, 4, v13
  v_add_u32 v20, s64, v13
  s_mul_i32 s13, s24, 12320
  s_mul_i32 s64, s23, 6144
  s_add_u32 s13, s13, s64
  s_add_u32 m0, s10, 36896
  s_add_u32 s7, s8, 98304
  buffer_load_dwordx4 v24, s[56:59], s7 offen lds
  s_cmp_eq_u32 s24, 0
  s_cselect_b32 s40, s40, s42
  s_cselect_b32 s41, s41, s43
  s_mov_b32 s42, 0x158000
  s_mov_b32 s43, 0x20000
  s_mul_i32 s44, s27, 360448
  s_add_u32 s45, s44, 262144
  s_min_u32 s45, s45, 1310720
  s_add_u32 m0, s10, 40992
  s_add_u32 s7, s9, 0
  buffer_load_dwordx4 v25, s[36:39], s7 offen lds
  s_add_u32 s46, s44, 98304
  s_sub_u32 s47, s45, 81920
  s_mov_b32 s100, s12
  s_mov_b32 s101, s12
  s_lshl2_add_u32 s68, s4, s27
  s_lshl_b32 s68, s68, 12
  s_add_u32 s68, s68, 0xb80000
  s_lshl1_add_u32 s64, s21, s24
  s_add_u32 m0, s10, 45088
  s_add_u32 s7, s9, 98304
  buffer_load_dwordx4 v25, s[36:39], s7 offen lds
  s_lshr_b32 s65, s25, 2
  s_lshl2_add_u32 s64, s64, s65
  s_lshl_b32 s64, s64, 5
  s_and_b32 s65, s25, 3
  s_lshl1_add_u32 s65, s65, s23
  s_add_u32 s64, s64, s65
  s_lshl_b32 s64, s64, 7
  s_add_u32 s69, s64, 0xb80000
  s_waitcnt vmcnt(12)
  s_waitcnt lgkmcnt(0)
  s_barrier
  s_cmp_lg_u32 s19, 0
  s_cbranch_scc1 xj25_0
  ds_read_b128 v[160:163], v36 offset:24608
  ds_read_b128 v[164:167], v37 offset:24608
  ds_read_b128 v[168:171], v38 offset:24608
  ds_read_b128 v[172:175], v39 offset:24608
  s_branch xj25
xj25_0:
  ds_read_b128 v[144:147], v36 offset:24608
  ds_read_b128 v[148:151], v37 offset:24608
  ds_read_b128 v[152:155], v38 offset:24608
  ds_read_b128 v[156:159], v39 offset:24608
xj25:
  s_add_u32 s9, s18, 5
  s_and_b32 s9, s9, 7
  s_lshl_b32 s8, s9, 7
  s_mul_i32 s9, s9, 196608
  s_add_u32 m0, s10, 49216
  s_add_u32 s7, s8, 0
  buffer_load_dwordx4 v24, s[56:59], s7 offen lds
  s_add_u32 m0, s10, 53312
  s_add_u32 s7, s8, 32768
  buffer_load_dwordx4 v24, s[56:59], s7 offen lds
  s_add_u32 m0, s10, 57408
  s_add_u32 s7, s8, 65536
  buffer_load_dwordx4 v24, s[56:59], s7 offen lds
  s_add_u32 m0, s10, 61504
  s_add_u32 s7, s8, 98304
  buffer_load_dwordx4 v24, s[56:59], s7 offen lds
  s_add_u32 m0, s10, 65600
  s_add_u32 s7, s9, 0
  buffer_load_dwordx4 v25, s[36:39], s7 offen lds
  s_add_u32 m0, s10, 69696
  s_add_u32 s7, s9, 98304
  buffer_load_dwordx4 v25, s[36:39], s7 offen lds
  s_waitcnt vmcnt(12)
  s_waitcnt lgkmcnt(0)
  s_barrier
  s_cmp_lg_u32 s19, 0
  s_cbranch_scc1 xj26_0
  ds_read_b128 v[176:179], v32 offset:0
  ds_read_b128 v[180:183], v33 offset:0
  ds_read_b128 v[184:187], v34 offset:0
  ds_read_b128 v[188:191], v35 offset:0
  s_branch xj26
xj26_0:
  ds_read_b128 v[160:163], v32 offset:0
  ds_read_b128 v[164:167], v33 offset:0
  ds_read_b128 v[168:171], v34 offset:0
  ds_read_b128 v[172:175], v35 offset:0
xj26:
  s_add_u32 s9, s18, 6
  s_and_b32 s9, s9, 7
  s_lshl_b32 s8, s9, 7
  s_mul_i32 s9, s9, 196608
  s_add_u32 m0, s10, 73824
  s_add_u32 s7, s8, 0
  buffer_load_dwordx4 v24, s[56:59], s7 offen lds
  s_add_u32 m0, s10, 77920
  s_add_u32 s7, s8, 32768
  buffer_load_dwordx4 v24, s[56:59], s7 offen lds
  s_add_u32 m0, s10, 82016
  s_add_u32 s7, s8, 65536
  buffer_load_dwordx4 v24, s[56:59], s7 offen lds
  s_add_u32 m0, s10, 86112
  s_add_u32 s7, s8, 98304
  buffer_load_dwordx4 v24, s[56:59], s7 offen lds
  s_add_u32 m0, s10, 90208
  s_add_u32 s7, s9, 0
  buffer_load_dwordx4 v25, s[36:39], s7 offen lds
  s_add_u32 m0, s10, 94304
  s_add_u32 s7, s9, 98304
  buffer_load_dwordx4 v25, s[36:39], s7 offen lds
  s_waitcnt vmcnt(12)
  s_waitcnt lgkmcnt(0)
  s_barrier
  s_cmp_lg_u32 s19, 0
  s_cbranch_scc1 xj27_0
  ds_read_b128 v[192:195], v32 offset:24608
  ds_read_b128 v[196:199], v33 offset:24608
  ds_read_b128 v[200:203], v34 offset:24608
  ds_read_b128 v[204:207], v35 offset:24608
  s_branch xj27
xj27_0:
  ds_read_b128 v[176:179], v32 offset:24608
  ds_read_b128 v[180:183], v33 offset:24608
  ds_read_b128 v[184:187], v34 offset:24608
  ds_read_b128 v[188:191], v35 offset:24608
xj27:
  s_add_u32 s9, s18, 7
  s_and_b32 s9, s9, 7
  s_lshl_b32 s8, s9, 7
  s_mul_i32 s9, s9, 196608
  s_add_u32 m0, s10, 98432
  s_add_u32 s7, s8, 0
  buffer_load_dwordx4 v24, s[56:59], s7 offen lds
  s_add_u32 m0, s10, 102528
  s_add_u32 s7, s8, 32768
  buffer_load_dwordx4 v24, s[56:59], s7 offen lds
  s_add_u32 m0, s10, 106624
  s_add_u32 s7, s8, 65536
  buffer_load_dwordx4 v24, s[56:59], s7 offen lds
  s_add_u32 m0, s10, 110720
  s_add_u32 s7, s8, 98304
  buffer_load_dwordx4 v24, s[56:59], s7 offen lds
  s_add_u32 m0, s10, 114816
  s_add_u32 s7, s9, 0
  buffer_load_dwordx4 v25, s[36:39], s7 offen lds
  s_add_u32 m0, s10, 118912
  s_add_u32 s7, s9, 98304
  buffer_load_dwordx4 v25, s[36:39], s7 offen lds
  s_waitcnt vmcnt(12)
  s_waitcnt lgkmcnt(0)
  s_barrier
  s_cmp_lg_u32 s19, 0
  s_cbranch_scc1 xj28_0
  ds_read_b128 v[208:211], v32 offset:49216
  ds_read_b128 v[212:215], v33 offset:49216
  ds_read_b128 v[216:219], v34 offset:49216
  ds_read_b128 v[220:223], v35 offset:49216
  s_branch xj28
xj28_0:
  ds_read_b128 v[192:195], v32 offset:49216
  ds_read_b128 v[196:199], v33 offset:49216
  ds_read_b128 v[200:203], v34 offset:49216
  ds_read_b128 v[204:207], v35 offset:49216
xj28:
  buffer_load_dwordx2 v[124:125], v46, s[28:31], 0 offen sc1
  s_add_u32 s9, s18, s19
  s_add_u32 s9, s9, 0
  s_and_b32 s9, s9, 7
  s_mul_i32 s9, s9, 176128
  s_add_u32 m0, s13, 131328
  s_add_u32 s7, s9, 0
  buffer_load_dwordx4 v2, s[40:43], s7 offen lds
  s_add_u32 m0, s13, 132352
  s_add_u32 s7, s9, 0
  buffer_load_dwordx4 v3, s[40:43], s7 offen lds
  s_add_u32 m0, s13, 133376
  s_add_u32 s7, s9, 0
  buffer_load_dwordx4 v20, s[40:43], s7 offen lds
  s_add_u32 m0, s13, 134400
  s_add_u32 s7, s9, 44032
  buffer_load_dwordx4 v2, s[40:43], s7 offen lds
  s_add_u32 m0, s13, 135424
  s_add_u32 s7, s9, 44032
  buffer_load_dwordx4 v3, s[40:43], s7 offen lds
  s_add_u32 m0, s13, 136448
  s_add_u32 s7, s9, 44032
  buffer_load_dwordx4 v20, s[40:43], s7 offen lds
  s_waitcnt vmcnt(13)
  s_waitcnt lgkmcnt(0)
  s_barrier
  s_cmp_lg_u32 s19, 0
  s_cbranch_scc1 xj29_0
  ds_read_b128 v[224:227], v36 offset:0
  ds_read_b128 v[228:231], v37 offset:0
  ds_read_b128 v[232:235], v38 offset:0
  ds_read_b128 v[236:239], v39 offset:0
  s_branch xj29
xj29_0:
  ds_read_b128 v[208:211], v36 offset:0
  ds_read_b128 v[212:215], v37 offset:0
  ds_read_b128 v[216:219], v38 offset:0
  ds_read_b128 v[220:223], v39 offset:0
xj29:
  s_add_u32 s9, s18, s19
  s_add_u32 s9, s9, 1
  s_and_b32 s9, s9, 7
  s_mul_i32 s9, s9, 176128
  s_add_u32 m0, s13, 0
  s_add_u32 s7, s9, 0
  buffer_load_dwordx4 v2, s[40:43], s7 offen lds
  s_add_u32 m0, s13, 1024
  s_add_u32 s7, s9, 0
  buffer_load_dwordx4 v3, s[40:43], s7 offen lds
  s_add_u32 m0, s13, 2048
  s_add_u32 s7, s9, 0
  buffer_load_dwordx4 v20, s[40:43], s7 offen lds
  s_add_u32 m0, s13, 3072
  s_add_u32 s7, s9, 44032
  buffer_load_dwordx4 v2, s[40:43], s7 offen lds
  s_add_u32 m0, s13, 4096
  s_add_u32 s7, s9, 44032
  buffer_load_dwordx4 v3, s[40:43], s7 offen lds
  s_add_u32 m0, s13, 5120
  s_add_u32 s7, s9, 44032
  buffer_load_dwordx4 v20, s[40:43], s7 offen lds
  s_waitcnt vmcnt(13)
  s_waitcnt lgkmcnt(0)
  s_barrier
  s_cmp_lg_u32 s19, 0
  s_cbranch_scc1 xj30_0
  ds_read_b128 v[240:243], v36 offset:24608
  ds_read_b128 v[244:247], v37 offset:24608
  ds_read_b128 v[248:251], v38 offset:24608
  ds_read_b128 v[252:255], v39 offset:24608
  s_branch xj30
xj30_0:
  ds_read_b128 v[224:227], v36 offset:24608
  ds_read_b128 v[228:231], v37 offset:24608
  ds_read_b128 v[232:235], v38 offset:24608
  ds_read_b128 v[236:239], v39 offset:24608
xj30:
  s_waitcnt vmcnt(12)
  v_xor_b32 v12, s12, v125
  v_cmp_ne_u32 vcc, 0, v12
  s_nop 1
  s_cbranch_vccz gr31x
  s_mov_b32 s14, 0x40000
gr31:
  buffer_load_dwordx2 v[124:125], v46, s[28:31], 0 offen sc1
  s_sub_u32 s14, s14, 1
  s_waitcnt vmcnt(0)
  s_cbranch_scc1 gr31x
  v_xor_b32 v12, s12, v125
  v_cmp_ne_u32 vcc, 0, v12
  s_nop 1
  s_cbranch_vccnz gr31
gr31x:
  v_and_b32 v12, 31, v1
  v_lshlrev_b32 v12, 2, v12
  s_lshl_b32 s64, s27, 7
  s_add_u32 s64, s64, 160128
  v_add_u32 v12, s64, v12
  ds_write_b32 v12, v124
  v_mov_b32 v19, v124
  s_waitcnt vmcnt(6)
  s_waitcnt lgkmcnt(0)
  s_barrier
  s_setprio 2
  ds_read_b64_tr_b16 v[4:5], v21 offset:0
  ds_read_b64_tr_b16 v[6:7], v21 offset:768
  ds_read_b64_tr_b16 v[8:9], v21 offset:32
  ds_read_b64_tr_b16 v[10:11], v21 offset:800
  ds_read_b64_tr_b16 v[24:25], v21 offset:64
  ds_read_b64_tr_b16 v[26:27], v21 offset:832
  ds_read_b64_tr_b16 v[28:29], v21 offset:96
  ds_read_b64_tr_b16 v[30:31], v21 offset:864
  s_waitcnt lgkmcnt(6)
  v_mfma_f32_32x32x16_bf16 v[32:47], v[4:7], v[128:131], 0
  s_add_u32 s9, s18, s19
  s_add_u32 s9, s9, 2
  s_and_b32 s9, s9, 7
  s_mul_i32 s9, s9, 176128
  s_add_u32 m0, s13, 24608
  s_add_u32 s7, s9, 0
  s_waitcnt lgkmcnt(4)
  v_mfma_f32_32x32x16_bf16 v[48:63], v[8:11], v[128:131], 0
  ds_read_b64_tr_b16 v[4:5], v21 offset:128
  ds_read_b64_tr_b16 v[6:7], v21 offset:896
  buffer_load_dwordx4 v2, s[40:43], s7 offen lds
  s_waitcnt lgkmcnt(4)
  v_mfma_f32_32x32x16_bf16 v[64:79], v[24:27], v[128:131], 0
  ds_read_b64_tr_b16 v[8:9], v21 offset:160
  ds_read_b64_tr_b16 v[10:11], v21 offset:928
  s_add_u32 m0, s13, 25632
  s_add_u32 s7, s9, 0
  s_waitcnt lgkmcnt(4)
  v_mfma_f32_32x32x16_bf16 v[80:95], v[28:31], v[128:131], 0
  ds_read_b64_tr_b16 v[24:25], v21 offset:3072
  ds_read_b64_tr_b16 v[26:27], v21 offset:3840
  buffer_load_dwordx4 v3, s[40:43], s7 offen lds
  s_waitcnt lgkmcnt(4)
  v_mfma_f32_32x32x16_bf16 v[96:111], v[4:7], v[128:131], 0
  ds_read_b64_tr_b16 v[28:29], v21 offset:3104
  ds_read_b64_tr_b16 v[30:31], v21 offset:3872
  s_add_u32 m0, s13, 26656
  s_add_u32 s7, s9, 0
  s_waitcnt lgkmcnt(4)
  v_mfma_f32_32x32x16_bf16 v[112:127], v[8:11], v[128:131], 0
  ds_read_b64_tr_b16 v[4:5], v21 offset:3136
  ds_read_b64_tr_b16 v[6:7], v21 offset:3904
  buffer_load_dwordx4 v20, s[40:43], s7 offen lds
  s_waitcnt lgkmcnt(4)
  v_mfma_f32_32x32x16_bf16 v[32:47], v[24:27], v[132:135], v[32:47]
  ds_read_b64_tr_b16 v[8:9], v21 offset:3168
  ds_read_b64_tr_b16 v[10:11], v21 offset:3936
  ds_read_b64_tr_b16 v[128:129], v21 offset:3200
  ds_read_b64_tr_b16 v[130:131], v21 offset:3968
  s_add_u32 m0, s13, 27680
  s_add_u32 s7, s9, 44032
  s_waitcnt lgkmcnt(6)
  v_mfma_f32_32x32x16_bf16 v[48:63], v[28:31], v[132:135], v[48:63]
  ds_read_b64_tr_b16 v[24:25], v21 offset:3232
  ds_read_b64_tr_b16 v[26:27], v21 offset:4000
  buffer_load_dwordx4 v2, s[40:43], s7 offen lds
  s_waitcnt lgkmcnt(6)
  v_mfma_f32_32x32x16_bf16 v[64:79], v[4:7], v[132:135], v[64:79]
  ds_read_b64_tr_b16 v[28:29], v21 offset:6144
  ds_read_b64_tr_b16 v[30:31], v21 offset:6912
  s_add_u32 m0, s13, 28704
  s_add_u32 s7, s9, 44032
  s_waitcnt lgkmcnt(6)
  v_mfma_f32_32x32x16_bf16 v[80:95], v[8:11], v[132:135], v[80:95]
  ds_read_b64_tr_b16 v[4:5], v21 offset:6176
  ds_read_b64_tr_b16 v[6:7], v21 offset:6944
  buffer_load_dwordx4 v3, s[40:43], s7 offen lds
  s_waitcnt lgkmcnt(6)
  v_mfma_f32_32x32x16_bf16 v[96:111], v[128:131], v[132:135], v[96:111]
  ds_read_b64_tr_b16 v[8:9], v21 offset:6208
  ds_read_b64_tr_b16 v[10:11], v21 offset:6976
  s_add_u32 m0, s13, 29728
  s_add_u32 s7, s9, 44032
  s_waitcnt lgkmcnt(6)
  v_mfma_f32_32x32x16_bf16 v[112:127], v[24:27], v[132:135], v[112:127]
  ds_read_b64_tr_b16 v[128:129], v21 offset:6240
  ds_read_b64_tr_b16 v[130:131], v21 offset:7008
  buffer_load_dwordx4 v20, s[40:43], s7 offen lds
  s_waitcnt vmcnt(6)
  v_mov_b32 v12, 1
  ds_write_b32 v16, v12 offset:0
  s_waitcnt lgkmcnt(7)
  v_mfma_f32_32x32x16_bf16 v[32:47], v[28:31], v[136:139], v[32:47]
  ds_read_b64_tr_b16 v[24:25], v21 offset:6272
  ds_read_b64_tr_b16 v[26:27], v21 offset:7040
  ds_read_b64_tr_b16 v[132:133], v21 offset:6304
  ds_read_b64_tr_b16 v[134:135], v21 offset:7072
  s_add_u32 s9, s18, s19
  s_add_u32 s9, s9, 3
  s_and_b32 s9, s9, 7
  s_mul_i32 s9, s9, 176128
  s_add_u32 m0, s13, 49216
  s_add_u32 s7, s9, 0
  s_waitcnt lgkmcnt(9)
  v_mfma_f32_32x32x16_bf16 v[48:63], v[4:7], v[136:139], v[48:63]
  ds_read_b64_tr_b16 v[28:29], v21 offset:9216
  ds_read_b64_tr_b16 v[30:31], v21 offset:9984
  buffer_load_dwordx4 v2, s[40:43], s7 offen lds
  s_waitcnt lgkmcnt(9)
  v_mfma_f32_32x32x16_bf16 v[64:79], v[8:11], v[136:139], v[64:79]
  ds_read_b64_tr_b16 v[4:5], v21 offset:9248
  ds_read_b64_tr_b16 v[6:7], v21 offset:10016
  s_add_u32 m0, s13, 50240
  s_add_u32 s7, s9, 0
  s_waitcnt lgkmcnt(9)
  v_mfma_f32_32x32x16_bf16 v[80:95], v[128:131], v[136:139], v[80:95]
  ds_read_b64_tr_b16 v[8:9], v21 offset:9280
  ds_read_b64_tr_b16 v[10:11], v21 offset:10048
  buffer_load_dwordx4 v3, s[40:43], s7 offen lds
  ds_read_b32 v13, v17 offset:0
  s_waitcnt lgkmcnt(9)
  v_mfma_f32_32x32x16_bf16 v[96:111], v[24:27], v[136:139], v[96:111]
  ds_read_b64_tr_b16 v[128:129], v21 offset:9312
  ds_read_b64_tr_b16 v[130:131], v21 offset:10080
  s_add_u32 m0, s13, 51264
  s_add_u32 s7, s9, 0
  s_waitcnt lgkmcnt(9)
  v_mfma_f32_32x32x16_bf16 v[112:127], v[132:135], v[136:139], v[112:127]
  ds_read_b64_tr_b16 v[24:25], v21 offset:9344
  ds_read_b64_tr_b16 v[26:27], v21 offset:10112
  buffer_load_dwordx4 v20, s[40:43], s7 offen lds
  s_waitcnt lgkmcnt(4)
  v_cmp_gt_u32 vcc, 1, v13
  v_mfma_f32_32x32x16_bf16 v[32:47], v[28:31], v[140:143], v[32:47]
  ds_read_b64_tr_b16 v[132:133], v21 offset:9376
  ds_read_b64_tr_b16 v[134:135], v21 offset:10144
  s_cbranch_vccnz lw32
lw32x:
  v_mov_b32 v12, 1
  ds_write_b32 v16, v12 offset:1024
  s_add_u32 m0, s13, 52288
  s_add_u32 s7, s9, 44032
  v_mfma_f32_32x32x16_bf16 v[48:63], v[4:7], v[140:143], v[48:63]
  ds_read_b64_tr_b16 v[136:137], v22 offset:0
  ds_read_b64_tr_b16 v[138:139], v22 offset:768
  buffer_load_dwordx4 v2, s[40:43], s7 offen lds
  v_mfma_f32_32x32x16_bf16 v[64:79], v[8:11], v[140:143], v[64:79]
  ds_read_b64_tr_b16 v[28:29], v22 offset:32
  ds_read_b64_tr_b16 v[30:31], v22 offset:800
  s_add_u32 m0, s13, 53312
  s_add_u32 s7, s9, 44032
  s_waitcnt lgkmcnt(9)
  v_mfma_f32_32x32x16_bf16 v[80:95], v[128:131], v[140:143], v[80:95]
  ds_read_b64_tr_b16 v[4:5], v22 offset:64
  ds_read_b64_tr_b16 v[6:7], v22 offset:832
  buffer_load_dwordx4 v3, s[40:43], s7 offen lds
  s_waitcnt lgkmcnt(9)
  v_mfma_f32_32x32x16_bf16 v[96:111], v[24:27], v[140:143], v[96:111]
  ds_read_b64_tr_b16 v[8:9], v22 offset:96
  ds_read_b64_tr_b16 v[10:11], v22 offset:864
  s_add_u32 m0, s13, 54336
  s_add_u32 s7, s9, 44032
  s_waitcnt lgkmcnt(9)
  v_mfma_f32_32x32x16_bf16 v[112:127], v[132:135], v[140:143], v[112:127]
  ds_read_b64_tr_b16 v[128:129], v22 offset:128
  ds_read_b64_tr_b16 v[130:131], v22 offset:896
  buffer_load_dwordx4 v20, s[40:43], s7 offen lds
  s_waitcnt lgkmcnt(8)
  v_mfma_f32_32x32x16_bf16 v[32:47], v[136:139], v[144:147], v[32:47]
  ds_read_b64_tr_b16 v[24:25], v22 offset:160
  ds_read_b64_tr_b16 v[26:27], v22 offset:928
  s_add_u32 s9, s18, s19
  s_add_u32 s9, s9, 4
  s_and_b32 s9, s9, 7
  s_mul_i32 s9, s9, 176128
  s_add_u32 m0, s13, 73824
  s_add_u32 s7, s9, 0
  s_waitcnt lgkmcnt(8)
  v_mfma_f32_32x32x16_bf16 v[48:63], v[28:31], v[144:147], v[48:63]
  ds_read_b64_tr_b16 v[132:133], v22 offset:3072
  ds_read_b64_tr_b16 v[134:135], v22 offset:3840
  buffer_load_dwordx4 v2, s[40:43], s7 offen lds
  s_waitcnt lgkmcnt(8)
  v_mfma_f32_32x32x16_bf16 v[64:79], v[4:7], v[144:147], v[64:79]
  ds_read_b64_tr_b16 v[140:141], v22 offset:3104
  ds_read_b64_tr_b16 v[142:143], v22 offset:3872
  s_add_u32 m0, s13, 74848
  s_add_u32 s7, s9, 0
  s_waitcnt lgkmcnt(8)
  v_mfma_f32_32x32x16_bf16 v[80:95], v[8:11], v[144:147], v[80:95]
  ds_read_b64_tr_b16 v[136:137], v22 offset:3136
  ds_read_b64_tr_b16 v[138:139], v22 offset:3904
  buffer_load_dwordx4 v3, s[40:43], s7 offen lds
  s_waitcnt lgkmcnt(8)
  v_mfma_f32_32x32x16_bf16 v[96:111], v[128:131], v[144:147], v[96:111]
  ds_read_b64_tr_b16 v[28:29], v22 offset:3168
  ds_read_b64_tr_b16 v[30:31], v22 offset:3936
  s_add_u32 m0, s13, 75872
  s_add_u32 s7, s9, 0
  s_waitcnt lgkmcnt(8)
  v_mfma_f32_32x32x16_bf16 v[112:127], v[24:27], v[144:147], v[112:127]
  ds_read_b64_tr_b16 v[4:5], v22 offset:3200
  ds_read_b64_tr_b16 v[6:7], v22 offset:3968
  buffer_load_dwordx4 v20, s[40:43], s7 offen lds
  s_waitcnt lgkmcnt(8)
  v_mfma_f32_32x32x16_bf16 v[32:47], v[132:135], v[148:151], v[32:47]
  ds_read_b64_tr_b16 v[8:9], v22 offset:3232
  ds_read_b64_tr_b16 v[10:11], v22 offset:4000
  s_add_u32 m0, s13, 76896
  s_add_u32 s7, s9, 44032
  s_waitcnt lgkmcnt(8)
  v_mfma_f32_32x32x16_bf16 v[48:63], v[140:143], v[148:151], v[48:63]
  ds_read_b64_tr_b16 v[128:129], v22 offset:6144
  ds_read_b64_tr_b16 v[130:131], v22 offset:6912
  buffer_load_dwordx4 v2, s[40:43], s7 offen lds
  s_waitcnt lgkmcnt(8)
  v_mfma_f32_32x32x16_bf16 v[64:79], v[136:139], v[148:151], v[64:79]
  ds_read_b64_tr_b16 v[24:25], v22 offset:6176
  ds_read_b64_tr_b16 v[26:27], v22 offset:6944
  ds_read_b32 v15, v17 offset:2048
  s_add_u32 m0, s13, 77920
  s_add_u32 s7, s9, 44032
  s_waitcnt lgkmcnt(9)
  v_mfma_f32_32x32x16_bf16 v[80:95], v[28:31], v[148:151], v[80:95]
  ds_read_b64_tr_b16 v[144:145], v22 offset:6208
  ds_read_b64_tr_b16 v[146:147], v22 offset:6976
  buffer_load_dwordx4 v3, s[40:43], s7 offen lds
  ds_read_b32 v14, v17 offset:1024
  s_waitcnt lgkmcnt(10)
  v_mfma_f32_32x32x16_bf16 v[96:111], v[4:7], v[148:151], v[96:111]
  ds_read_b64_tr_b16 v[132:133], v22 offset:6240
  ds_read_b64_tr_b16 v[134:135], v22 offset:7008
  s_add_u32 m0, s13, 78944
  s_add_u32 s7, s9, 44032
  s_waitcnt lgkmcnt(5)
  v_cmp_gt_u32 vcc, 1, v15
  v_mfma_f32_32x32x16_bf16 v[112:127], v[8:11], v[148:151], v[112:127]
  ds_read_b64_tr_b16 v[140:141], v22 offset:6272
  ds_read_b64_tr_b16 v[142:143], v22 offset:7040
  s_cbranch_vccnz lw33
lw33x:
  buffer_load_dwordx4 v20, s[40:43], s7 offen lds
  s_waitcnt vmcnt(12)
  v_mov_b32 v12, 2
  ds_write_b32 v16, v12 offset:0
  s_waitcnt lgkmcnt(5)
  v_cmp_gt_u32 vcc, 1, v14
  v_mfma_f32_32x32x16_bf16 v[32:47], v[128:131], v[152:155], v[32:47]
  ds_read_b64_tr_b16 v[136:137], v22 offset:6304
  ds_read_b64_tr_b16 v[138:139], v22 offset:7072
  s_cbranch_vccnz lw34
lw34x:
  s_add_u32 s9, s18, s19
  s_add_u32 s9, s9, 5
  s_and_b32 s9, s9, 7
  s_mul_i32 s9, s9, 176128
  s_add_u32 m0, s13, 131328
  s_add_u32 s7, s9, 0
  v_mfma_f32_32x32x16_bf16 v[48:63], v[24:27], v[152:155], v[48:63]
  ds_read_b64_tr_b16 v[28:29], v22 offset:9216
  ds_read_b64_tr_b16 v[30:31], v22 offset:9984
  buffer_load_dwordx4 v2, s[40:43], s7 offen lds
  v_mfma_f32_32x32x16_bf16 v[64:79], v[144:147], v[152:155], v[64:79]
  ds_read_b64_tr_b16 v[4:5], v22 offset:9248
  ds_read_b64_tr_b16 v[6:7], v22 offset:10016
  s_add_u32 m0, s13, 132352
  s_add_u32 s7, s9, 0
  s_waitcnt lgkmcnt(9)
  v_mfma_f32_32x32x16_bf16 v[80:95], v[132:135], v[152:155], v[80:95]
  ds_read_b64_tr_b16 v[8:9], v22 offset:9280
  ds_read_b64_tr_b16 v[10:11], v22 offset:10048
  buffer_load_dwordx4 v3, s[40:43], s7 offen lds
  ds_read_b32 v13, v17 offset:0
  s_waitcnt lgkmcnt(10)
  v_mfma_f32_32x32x16_bf16 v[96:111], v[140:143], v[152:155], v[96:111]
  ds_read_b64_tr_b16 v[148:149], v22 offset:9312
  ds_read_b64_tr_b16 v[150:151], v22 offset:10080
  s_add_u32 m0, s13, 133376
  s_add_u32 s7, s9, 0
  s_waitcnt lgkmcnt(9)
  v_mfma_f32_32x32x16_bf16 v[112:127], v[136:139], v[152:155], v[112:127]
  ds_read_b64_tr_b16 v[128:129], v22 offset:9344
  ds_read_b64_tr_b16 v[130:131], v22 offset:10112
  buffer_load_dwordx4 v20, s[40:43], s7 offen lds
  s_waitcnt lgkmcnt(4)
  v_cmp_gt_u32 vcc, 2, v13
  v_mfma_f32_32x32x16_bf16 v[32:47], v[28:31], v[156:159], v[32:47]
  ds_read_b64_tr_b16 v[144:145], v22 offset:9376
  ds_read_b64_tr_b16 v[146:147], v22 offset:10144
  s_cbranch_vccnz lw35
lw35x:
  v_mov_b32 v12, 2
  ds_write_b32 v16, v12 offset:1024
  s_add_u32 m0, s13, 134400
  s_add_u32 s7, s9, 44032
  v_mfma_f32_32x32x16_bf16 v[48:63], v[4:7], v[156:159], v[48:63]
  ds_read_b64_tr_b16 v[132:133], v22 offset:24608
  ds_read_b64_tr_b16 v[134:135], v22 offset:25376
  buffer_load_dwordx4 v2, s[40:43], s7 offen lds
  v_mfma_f32_32x32x16_bf16 v[64:79], v[8:11], v[156:159], v[64:79]
  ds_read_b64_tr_b16 v[140:141], v22 offset:24640
  ds_read_b64_tr_b16 v[142:143], v22 offset:25408
  s_add_u32 m0, s13, 135424
  s_add_u32 s7, s9, 44032
  s_waitcnt lgkmcnt(9)
  v_mfma_f32_32x32x16_bf16 v[80:95], v[148:151], v[156:159], v[80:95]
  ds_read_b64_tr_b16 v[136:137], v22 offset:24672
  ds_read_b64_tr_b16 v[138:139], v22 offset:25440
  buffer_load_dwordx4 v3, s[40:43], s7 offen lds
  s_waitcnt lgkmcnt(9)
  v_mfma_f32_32x32x16_bf16 v[96:111], v[128:131], v[156:159], v[96:111]
  ds_read_b64_tr_b16 v[148:149], v22 offset:24704
  ds_read_b64_tr_b16 v[150:151], v22 offset:25472
  ds_read_b32 v14, v17 offset:1024
  s_add_u32 m0, s13, 136448
  s_add_u32 s7, s9, 44032
  s_waitcnt lgkmcnt(10)
  v_mfma_f32_32x32x16_bf16 v[112:127], v[144:147], v[156:159], v[112:127]
  ds_read_b64_tr_b16 v[128:129], v22 offset:24736
  ds_read_b64_tr_b16 v[130:131], v22 offset:25504
  buffer_load_dwordx4 v20, s[40:43], s7 offen lds
  s_waitcnt lgkmcnt(9)
  v_mfma_f32_32x32x16_bf16 v[32:47], v[132:135], v[160:163], v[32:47]
  ds_read_b64_tr_b16 v[144:145], v22 offset:24768
  ds_read_b64_tr_b16 v[146:147], v22 offset:25536
  s_waitcnt lgkmcnt(4)
  v_cmp_gt_u32 vcc, 2, v14
  v_mfma_f32_32x32x16_bf16 v[48:63], v[140:143], v[160:163], v[48:63]
  ds_read_b64_tr_b16 v[132:133], v22 offset:27680
  ds_read_b64_tr_b16 v[134:135], v22 offset:28448
  s_cbranch_vccnz lw36
lw36x:
  s_add_u32 s9, s18, s19
  s_add_u32 s9, s9, 6
  s_and_b32 s9, s9, 7
  s_mul_i32 s9, s9, 176128
  s_add_u32 m0, s13, 0
  s_add_u32 s7, s9, 0
  v_mfma_f32_32x32x16_bf16 v[64:79], v[136:139], v[160:163], v[64:79]
  ds_read_b64_tr_b16 v[140:141], v22 offset:27712
  ds_read_b64_tr_b16 v[142:143], v22 offset:28480
  buffer_load_dwordx4 v2, s[40:43], s7 offen lds
  v_mfma_f32_32x32x16_bf16 v[80:95], v[148:151], v[160:163], v[80:95]
  ds_read_b64_tr_b16 v[136:137], v22 offset:27744
  ds_read_b64_tr_b16 v[138:139], v22 offset:28512
  s_add_u32 m0, s13, 1024
  s_add_u32 s7, s9, 0
  s_waitcnt lgkmcnt(8)
  v_mfma_f32_32x32x16_bf16 v[96:111], v[128:131], v[160:163], v[96:111]
  ds_read_b64_tr_b16 v[148:149], v22 offset:27776
  ds_read_b64_tr_b16 v[150:151], v22 offset:28544
  buffer_load_dwordx4 v3, s[40:43], s7 offen lds
  s_waitcnt lgkmcnt(8)
  v_mfma_f32_32x32x16_bf16 v[112:127], v[144:147], v[160:163], v[112:127]
  ds_read_b64_tr_b16 v[128:129], v22 offset:27808
  ds_read_b64_tr_b16 v[130:131], v22 offset:28576
  s_add_u32 m0, s13, 2048
  s_add_u32 s7, s9, 0
  s_waitcnt lgkmcnt(8)
  v_mfma_f32_32x32x16_bf16 v[32:47], v[132:135], v[164:167], v[32:47]
  ds_read_b64_tr_b16 v[144:145], v22 offset:27840
  ds_read_b64_tr_b16 v[146:147], v22 offset:28608
  buffer_load_dwordx4 v20, s[40:43], s7 offen lds
  s_waitcnt lgkmcnt(8)
  v_mfma_f32_32x32x16_bf16 v[48:63], v[140:143], v[164:167], v[48:63]
  ds_read_b64_tr_b16 v[132:133], v22 offset:30752
  ds_read_b64_tr_b16 v[134:135], v22 offset:31520
  s_add_u32 m0, s13, 3072
  s_add_u32 s7, s9, 44032
  s_waitcnt lgkmcnt(8)
  v_mfma_f32_32x32x16_bf16 v[64:79], v[136:139], v[164:167], v[64:79]
  ds_read_b64_tr_b16 v[140:141], v22 offset:30784
  ds_read_b64_tr_b16 v[142:143], v22 offset:31552
  buffer_load_dwordx4 v2, s[40:43], s7 offen lds
  s_waitcnt lgkmcnt(8)
  v_mfma_f32_32x32x16_bf16 v[80:95], v[148:151], v[164:167], v[80:95]
  ds_read_b64_tr_b16 v[136:137], v22 offset:30816
  ds_read_b64_tr_b16 v[138:139], v22 offset:31584
  s_add_u32 m0, s13, 4096
  s_add_u32 s7, s9, 44032
  s_waitcnt lgkmcnt(8)
  v_mfma_f32_32x32x16_bf16 v[96:111], v[128:131], v[164:167], v[96:111]
  ds_read_b64_tr_b16 v[148:149], v22 offset:30848
  ds_read_b64_tr_b16 v[150:151], v22 offset:31616
  buffer_load_dwordx4 v3, s[40:43], s7 offen lds
  s_waitcnt lgkmcnt(8)
  v_mfma_f32_32x32x16_bf16 v[112:127], v[144:147], v[164:167], v[112:127]
  ds_read_b64_tr_b16 v[128:129], v22 offset:30880
  ds_read_b64_tr_b16 v[130:131], v22 offset:31648
  s_waitcnt vmcnt(17)
  v_mov_b32 v12, 3
  ds_write_b32 v16, v12 offset:0
  s_add_u32 m0, s13, 5120
  s_add_u32 s7, s9, 44032
  s_waitcnt lgkmcnt(9)
  v_mfma_f32_32x32x16_bf16 v[32:47], v[132:135], v[168:171], v[32:47]
  ds_read_b64_tr_b16 v[144:145], v22 offset:30912
  ds_read_b64_tr_b16 v[146:147], v22 offset:31680
  buffer_load_dwordx4 v20, s[40:43], s7 offen lds
  s_waitcnt lgkmcnt(9)
  v_mfma_f32_32x32x16_bf16 v[48:63], v[140:143], v[168:171], v[48:63]
  ds_read_b64_tr_b16 v[132:133], v22 offset:33824
  ds_read_b64_tr_b16 v[134:135], v22 offset:34592
  s_waitcnt lgkmcnt(9)
  v_mfma_f32_32x32x16_bf16 v[64:79], v[136:139], v[168:171], v[64:79]
  ds_read_b64_tr_b16 v[140:141], v22 offset:33856
  ds_read_b64_tr_b16 v[142:143], v22 offset:34624
  s_waitcnt lgkmcnt(9)
  v_mfma_f32_32x32x16_bf16 v[80:95], v[148:151], v[168:171], v[80:95]
  ds_read_b64_tr_b16 v[136:137], v22 offset:33888
  ds_read_b64_tr_b16 v[138:139], v22 offset:34656
  ds_read_b32 v13, v17 offset:0
  s_waitcnt lgkmcnt(10)
  v_mfma_f32_32x32x16_bf16 v[96:111], v[128:131], v[168:171], v[96:111]
  ds_read_b64_tr_b16 v[148:149], v22 offset:33920
  ds_read_b64_tr_b16 v[150:151], v22 offset:34688
  s_waitcnt lgkmcnt(9)
  v_mfma_f32_32x32x16_bf16 v[112:127], v[144:147], v[168:171], v[112:127]
  ds_read_b64_tr_b16 v[128:129], v22 offset:33952
  ds_read_b64_tr_b16 v[130:131], v22 offset:34720
  s_waitcnt lgkmcnt(4)
  v_cmp_gt_u32 vcc, 3, v13
  v_mfma_f32_32x32x16_bf16 v[32:47], v[132:135], v[172:175], v[32:47]
  ds_read_b64_tr_b16 v[144:145], v22 offset:33984
  ds_read_b64_tr_b16 v[146:147], v22 offset:34752
  s_cbranch_vccnz lw37
lw37x:
  v_mov_b32 v12, 3
  ds_write_b32 v16, v12 offset:1024
  v_mfma_f32_32x32x16_bf16 v[48:63], v[140:143], v[172:175], v[48:63]
  ds_read_b64_tr_b16 v[132:133], v22 offset:49216
  ds_read_b64_tr_b16 v[134:135], v22 offset:49984
  v_mfma_f32_32x32x16_bf16 v[64:79], v[136:139], v[172:175], v[64:79]
  ds_read_b64_tr_b16 v[140:141], v22 offset:49248
  ds_read_b64_tr_b16 v[142:143], v22 offset:50016
  s_waitcnt lgkmcnt(9)
  v_mfma_f32_32x32x16_bf16 v[80:95], v[148:151], v[172:175], v[80:95]
  ds_read_b64_tr_b16 v[136:137], v22 offset:49280
  ds_read_b64_tr_b16 v[138:139], v22 offset:50048
  s_waitcnt lgkmcnt(9)
  v_mfma_f32_32x32x16_bf16 v[96:111], v[128:131], v[172:175], v[96:111]
  ds_read_b64_tr_b16 v[148:149], v22 offset:49312
  ds_read_b64_tr_b16 v[150:151], v22 offset:50080
  ds_read_b32 v14, v17 offset:1024
  s_waitcnt lgkmcnt(10)
  v_mfma_f32_32x32x16_bf16 v[112:127], v[144:147], v[172:175], v[112:127]
  ds_read_b64_tr_b16 v[128:129], v22 offset:49344
  ds_read_b64_tr_b16 v[130:131], v22 offset:50112
  s_waitcnt lgkmcnt(9)
  v_mfma_f32_32x32x16_bf16 v[32:47], v[132:135], v[176:179], v[32:47]
  ds_read_b64_tr_b16 v[144:145], v22 offset:49376
  ds_read_b64_tr_b16 v[146:147], v22 offset:50144
  s_waitcnt lgkmcnt(4)
  v_cmp_gt_u32 vcc, 3, v14
  v_mfma_f32_32x32x16_bf16 v[48:63], v[140:143], v[176:179], v[48:63]
  ds_read_b64_tr_b16 v[132:133], v22 offset:52288
  ds_read_b64_tr_b16 v[134:135], v22 offset:53056
  s_cbranch_vccnz lw38
lw38x:
  s_add_u32 s9, s18, s19
  s_add_u32 s9, s9, 7
  s_and_b32 s9, s9, 7
  s_mul_i32 s9, s9, 176128
  s_add_u32 m0, s13, 24608
  s_add_u32 s7, s9, 0
  v_mfma_f32_32x32x16_bf16 v[64:79], v[136:139], v[176:179], v[64:79]
  ds_read_b64_tr_b16 v[140:141], v22 offset:52320
  ds_read_b64_tr_b16 v[142:143], v22 offset:53088
  buffer_load_dwordx4 v2, s[40:43], s7 offen lds
  v_mfma_f32_32x32x16_bf16 v[80:95], v[148:151], v[176:179], v[80:95]
  ds_read_b64_tr_b16 v[136:137], v22 offset:52352
  ds_read_b64_tr_b16 v[138:139], v22 offset:53120
  s_add_u32 m0, s13, 25632
  s_add_u32 s7, s9, 0
  s_waitcnt lgkmcnt(8)
  v_mfma_f32_32x32x16_bf16 v[96:111], v[128:131], v[176:179], v[96:111]
  ds_read_b64_tr_b16 v[148:149], v22 offset:52384
  ds_read_b64_tr_b16 v[150:151], v22 offset:53152
  buffer_load_dwordx4 v3, s[40:43], s7 offen lds
  s_waitcnt lgkmcnt(8)
  v_mfma_f32_32x32x16_bf16 v[112:127], v[144:147], v[176:179], v[112:127]
  ds_read_b64_tr_b16 v[128:129], v22 offset:52416
  ds_read_b64_tr_b16 v[130:131], v22 offset:53184
  s_add_u32 m0, s13, 26656
  s_add_u32 s7, s9, 0
  s_waitcnt lgkmcnt(8)
  v_mfma_f32_32x32x16_bf16 v[32:47], v[132:135], v[180:183], v[32:47]
  ds_read_b64_tr_b16 v[144:145], v22 offset:52448
  ds_read_b64_tr_b16 v[146:147], v22 offset:53216
  buffer_load_dwordx4 v20, s[40:43], s7 offen lds
  s_waitcnt lgkmcnt(8)
  v_mfma_f32_32x32x16_bf16 v[48:63], v[140:143], v[180:183], v[48:63]
  ds_read_b64_tr_b16 v[132:133], v22 offset:55360
  ds_read_b64_tr_b16 v[134:135], v22 offset:56128
  s_add_u32 m0, s13, 27680
  s_add_u32 s7, s9, 44032
  s_waitcnt lgkmcnt(8)
  v_mfma_f32_32x32x16_bf16 v[64:79], v[136:139], v[180:183], v[64:79]
  ds_read_b64_tr_b16 v[140:141], v22 offset:55392
  ds_read_b64_tr_b16 v[142:143], v22 offset:56160
  buffer_load_dwordx4 v2, s[40:43], s7 offen lds
  s_waitcnt lgkmcnt(8)
  v_mfma_f32_32x32x16_bf16 v[80:95], v[148:151], v[180:183], v[80:95]
  ds_read_b64_tr_b16 v[136:137], v22 offset:55424
  ds_read_b64_tr_b16 v[138:139], v22 offset:56192
  s_add_u32 m0, s13, 28704
  s_add_u32 s7, s9, 44032
  s_waitcnt lgkmcnt(8)
  v_mfma_f32_32x32x16_bf16 v[96:111], v[128:131], v[180:183], v[96:111]
  ds_read_b64_tr_b16 v[148:149], v22 offset:55456
  ds_read_b64_tr_b16 v[150:151], v22 offset:56224
  buffer_load_dwordx4 v3, s[40:43], s7 offen lds
  s_waitcnt lgkmcnt(8)
  v_mfma_f32_32x32x16_bf16 v[112:127], v[144:147], v[180:183], v[112:127]
  ds_read_b64_tr_b16 v[128:129], v22 offset:55488
  ds_read_b64_tr_b16 v[130:131], v22 offset:56256
  s_waitcnt vmcnt(17)
  v_mov_b32 v12, 4
  ds_write_b32 v16, v12 offset:0
  s_add_u32 m0, s13, 29728
  s_add_u32 s7, s9, 44032
  s_waitcnt lgkmcnt(9)
  v_mfma_f32_32x32x16_bf16 v[32:47], v[132:135], v[184:187], v[32:47]
  ds_read_b64_tr_b16 v[144:145], v22 offset:55520
  ds_read_b64_tr_b16 v[146:147], v22 offset:56288
  buffer_load_dwordx4 v20, s[40:43], s7 offen lds
  s_waitcnt lgkmcnt(9)
  v_mfma_f32_32x32x16_bf16 v[48:63], v[140:143], v[184:187], v[48:63]
  ds_read_b64_tr_b16 v[132:133], v22 offset:58432
  ds_read_b64_tr_b16 v[134:135], v22 offset:59200
  s_waitcnt lgkmcnt(9)
  v_mfma_f32_32x32x16_bf16 v[64:79], v[136:139], v[184:187], v[64:79]
  ds_read_b64_tr_b16 v[140:141], v22 offset:58464
  ds_read_b64_tr_b16 v[142:143], v22 offset:59232
  s_lshl_b32 s6, s27, 11
  v_lshrrev_b32 v152, 3, v1
  s_waitcnt lgkmcnt(9)
  v_mfma_f32_32x32x16_bf16 v[80:95], v[148:151], v[184:187], v[80:95]
  ds_read_b64_tr_b16 v[136:137], v22 offset:58496
  ds_read_b64_tr_b16 v[138:139], v22 offset:59264
  ds_read_b32 v13, v17 offset:0
  v_and_b32 v153, 7, v1
  v_lshlrev_b32 v2, 1, v152
  s_waitcnt lgkmcnt(10)
  v_mfma_f32_32x32x16_bf16 v[96:111], v[128:131], v[184:187], v[96:111]
  ds_read_b64_tr_b16 v[148:149], v22 offset:58528
  ds_read_b64_tr_b16 v[150:151], v22 offset:59296
  v_and_b32 v2, 4, v2
  v_xor_b32 v2, v2, v153
  s_waitcnt lgkmcnt(9)
  v_mfma_f32_32x32x16_bf16 v[112:127], v[144:147], v[184:187], v[112:127]
  ds_read_b64_tr_b16 v[128:129], v22 offset:58560
  ds_read_b64_tr_b16 v[130:131], v22 offset:59328
  v_lshlrev_b32 v2, 4, v2
  v_lshl_add_u32 v2, v152, 10, v2
  s_waitcnt lgkmcnt(4)
  v_cmp_gt_u32 vcc, 4, v13
  v_mfma_f32_32x32x16_bf16 v[32:47], v[132:135], v[188:191], v[32:47]
  ds_read_b64_tr_b16 v[144:145], v22 offset:58592
  ds_read_b64_tr_b16 v[146:147], v22 offset:59360
  s_cbranch_vccnz lw39
lw39x:
  v_mov_b32 v12, 4
  ds_write_b32 v16, v12 offset:1024
  s_lshl_b32 s64, s5, 7
  v_add_u32 v2, s64, v2
  v_mfma_f32_32x32x16_bf16 v[48:63], v[140:143], v[188:191], v[48:63]
  ds_read_b64_tr_b16 v[132:133], v23 offset:0
  ds_read_b64_tr_b16 v[134:135], v23 offset:768
  v_mfma_f32_32x32x16_bf16 v[64:79], v[136:139], v[188:191], v[64:79]
  ds_read_b64_tr_b16 v[140:141], v23 offset:32
  ds_read_b64_tr_b16 v[142:143], v23 offset:800
  s_waitcnt lgkmcnt(9)
  v_mfma_f32_32x32x16_bf16 v[80:95], v[148:151], v[188:191], v[80:95]
  ds_read_b64_tr_b16 v[136:137], v23 offset:64
  ds_read_b64_tr_b16 v[138:139], v23 offset:832
  s_waitcnt lgkmcnt(9)
  v_mfma_f32_32x32x16_bf16 v[96:111], v[128:131], v[188:191], v[96:111]
  ds_read_b64_tr_b16 v[148:149], v23 offset:96
  ds_read_b64_tr_b16 v[150:151], v23 offset:864
  s_waitcnt lgkmcnt(9)
  v_mfma_f32_32x32x16_bf16 v[112:127], v[144:147], v[188:191], v[112:127]
  ds_read_b64_tr_b16 v[128:129], v23 offset:128
  ds_read_b64_tr_b16 v[130:131], v23 offset:896
  s_waitcnt lgkmcnt(8)
  v_mfma_f32_32x32x16_bf16 v[32:47], v[132:135], v[192:195], v[32:47]
  ds_read_b64_tr_b16 v[144:145], v23 offset:160
  ds_read_b64_tr_b16 v[146:147], v23 offset:928
  s_waitcnt lgkmcnt(8)
  v_mfma_f32_32x32x16_bf16 v[48:63], v[140:143], v[192:195], v[48:63]
  ds_read_b64_tr_b16 v[132:133], v23 offset:3072
  ds_read_b64_tr_b16 v[134:135], v23 offset:3840
  s_waitcnt lgkmcnt(8)
  v_mfma_f32_32x32x16_bf16 v[64:79], v[136:139], v[192:195], v[64:79]
  ds_read_b64_tr_b16 v[140:141], v23 offset:3104
  ds_read_b64_tr_b16 v[142:143], v23 offset:3872
  s_waitcnt lgkmcnt(8)
  v_mfma_f32_32x32x16_bf16 v[80:95], v[148:151], v[192:195], v[80:95]
  ds_read_b64_tr_b16 v[136:137], v23 offset:3136
  ds_read_b64_tr_b16 v[138:139], v23 offset:3904
  s_waitcnt lgkmcnt(8)
  v_mfma_f32_32x32x16_bf16 v[96:111], v[128:131], v[192:195], v[96:111]
  ds_read_b64_tr_b16 v[148:149], v23 offset:3168
  ds_read_b64_tr_b16 v[150:151], v23 offset:3936
  s_waitcnt lgkmcnt(8)
  v_mfma_f32_32x32x16_bf16 v[112:127], v[144:147], v[192:195], v[112:127]
  ds_read_b64_tr_b16 v[128:129], v23 offset:3200
  ds_read_b64_tr_b16 v[130:131], v23 offset:3968
  s_waitcnt lgkmcnt(8)
  v_mfma_f32_32x32x16_bf16 v[32:47], v[132:135], v[196:199], v[32:47]
  ds_read_b64_tr_b16 v[144:145], v23 offset:3232
  ds_read_b64_tr_b16 v[146:147], v23 offset:4000
  s_waitcnt lgkmcnt(8)
  v_mfma_f32_32x32x16_bf16 v[48:63], v[140:143], v[196:199], v[48:63]
  ds_read_b64_tr_b16 v[132:133], v23 offset:6144
  ds_read_b64_tr_b16 v[134:135], v23 offset:6912
  s_waitcnt lgkmcnt(8)
  v_mfma_f32_32x32x16_bf16 v[64:79], v[136:139], v[196:199], v[64:79]
  ds_read_b64_tr_b16 v[140:141], v23 offset:6176
  ds_read_b64_tr_b16 v[142:143], v23 offset:6944
  s_waitcnt lgkmcnt(8)
  v_mfma_f32_32x32x16_bf16 v[80:95], v[148:151], v[196:199], v[80:95]
  ds_read_b64_tr_b16 v[136:137], v23 offset:6208
  ds_read_b64_tr_b16 v[138:139], v23 offset:6976
  s_waitcnt lgkmcnt(8)
  v_mfma_f32_32x32x16_bf16 v[96:111], v[128:131], v[196:199], v[96:111]
  ds_read_b64_tr_b16 v[148:149], v23 offset:6240
  ds_read_b64_tr_b16 v[150:151], v23 offset:7008
  v_mov_b32 v175, 0
  s_waitcnt lgkmcnt(8)
  v_mfma_f32_32x32x16_bf16 v[112:127], v[144:147], v[196:199], v[112:127]
  ds_read_b64_tr_b16 v[128:129], v23 offset:6272
  ds_read_b64_tr_b16 v[130:131], v23 offset:7040
  s_waitcnt vmcnt(6)
  v_mov_b32 v12, 6
  ds_write_b32 v16, v12 offset:0
  v_mov_b32 v176, 0
  s_waitcnt lgkmcnt(9)
  v_mfma_f32_32x32x16_bf16 v[32:47], v[132:135], v[200:203], v[32:47]
  ds_read_b64_tr_b16 v[144:145], v23 offset:6304
  ds_read_b64_tr_b16 v[146:147], v23 offset:7072
  v_mov_b32 v177, 0
  s_waitcnt lgkmcnt(9)
  v_mfma_f32_32x32x16_bf16 v[48:63], v[140:143], v[200:203], v[48:63]
  ds_read_b64_tr_b16 v[132:133], v23 offset:9216
  ds_read_b64_tr_b16 v[134:135], v23 offset:9984
  v_lshlrev_b32 v178, 16, v19
  s_waitcnt lgkmcnt(9)
  v_mfma_f32_32x32x16_bf16 v[64:79], v[136:139], v[200:203], v[64:79]
  ds_read_b64_tr_b16 v[140:141], v23 offset:9248
  ds_read_b64_tr_b16 v[142:143], v23 offset:10016
  v_rcp_f32 v179, v178
  s_waitcnt lgkmcnt(9)
  v_mfma_f32_32x32x16_bf16 v[80:95], v[148:151], v[200:203], v[80:95]
  ds_read_b64_tr_b16 v[136:137], v23 offset:9280
  ds_read_b64_tr_b16 v[138:139], v23 offset:10048
  ds_read_b32 v13, v17 offset:0
  v_perm_b32 v174, v19, v19, s15
  s_waitcnt lgkmcnt(10)
  v_mfma_f32_32x32x16_bf16 v[96:111], v[128:131], v[200:203], v[96:111]
  ds_read_b64_tr_b16 v[148:149], v23 offset:9312
  ds_read_b64_tr_b16 v[150:151], v23 offset:10080
  v_mul_f32 v179, 0xbfb8aa3b, v179
  s_waitcnt lgkmcnt(9)
  v_mfma_f32_32x32x16_bf16 v[112:127], v[144:147], v[200:203], v[112:127]
  ds_read_b64_tr_b16 v[128:129], v23 offset:9344
  ds_read_b64_tr_b16 v[130:131], v23 offset:10112
  v_lshlrev_b32 v180, 2, v1
  s_waitcnt lgkmcnt(4)
  v_cmp_gt_u32 vcc, 6, v13
  v_mfma_f32_32x32x16_bf16 v[32:47], v[132:135], v[204:207], v[32:47]
  ds_read_b64_tr_b16 v[144:145], v23 offset:9376
  ds_read_b64_tr_b16 v[146:147], v23 offset:10144
  s_cbranch_vccnz lw40
lw40x:
  v_mov_b32 v12, 5
  ds_write_b32 v16, v12 offset:1024
  v_add_u32 v180, 158080, v180
  v_mfma_f32_32x32x16_bf16 v[48:63], v[140:143], v[204:207], v[48:63]
  ds_read_b64_tr_b16 v[132:133], v21 offset:0
  ds_read_b64_tr_b16 v[134:135], v21 offset:768
  s_waitcnt vmcnt(0)
  v_mov_b32 v12, 7
  ds_write_b32 v16, v12 offset:0
  s_lshl_b32 s66, s26, 17
  v_mfma_f32_32x32x16_bf16 v[64:79], v[136:139], v[204:207], v[64:79]
  ds_read_b64_tr_b16 v[140:141], v21 offset:3072
  ds_read_b64_tr_b16 v[142:143], v21 offset:3840
  s_waitcnt lgkmcnt(10)
  v_mfma_f32_32x32x16_bf16 v[80:95], v[148:151], v[204:207], v[80:95]
  ds_read_b64_tr_b16 v[136:137], v21 offset:6144
  ds_read_b64_tr_b16 v[138:139], v21 offset:6912
  s_waitcnt lgkmcnt(10)
  v_mfma_f32_32x32x16_bf16 v[96:111], v[128:131], v[204:207], v[96:111]
  ds_read_b64_tr_b16 v[148:149], v21 offset:9216
  ds_read_b64_tr_b16 v[150:151], v21 offset:9984
  s_waitcnt lgkmcnt(10)
  v_mfma_f32_32x32x16_bf16 v[112:127], v[144:147], v[204:207], v[112:127]
  ds_read_b64_tr_b16 v[128:129], v22 offset:0
  ds_read_b64_tr_b16 v[130:131], v22 offset:768
  ds_read_b32 v13, v17 offset:0
  s_waitcnt lgkmcnt(10)
  v_mfma_f32_32x32x16_bf16 v[32:47], v[132:135], v[208:211], v[32:47]
  ds_read_b64_tr_b16 v[144:145], v22 offset:3072
  ds_read_b64_tr_b16 v[146:147], v22 offset:3840
  s_waitcnt lgkmcnt(9)
  v_mfma_f32_32x32x16_bf16 v[32:47], v[140:143], v[212:215], v[32:47]
  ds_read_b64_tr_b16 v[132:133], v22 offset:6144
  ds_read_b64_tr_b16 v[134:135], v22 offset:6912
  s_waitcnt lgkmcnt(4)
  v_cmp_gt_u32 vcc, 7, v13
  v_mfma_f32_32x32x16_bf16 v[32:47], v[136:139], v[216:219], v[32:47]
  ds_read_b64_tr_b16 v[140:141], v22 offset:9216
  ds_read_b64_tr_b16 v[142:143], v22 offset:9984
  s_cbranch_vccnz lw41
lw41x:
  ds_read_b32 v15, v17 offset:2048
  v_mfma_f32_32x32x16_bf16 v[32:47], v[148:151], v[220:223], v[32:47]
  ds_read_b64_tr_b16 v[136:137], v22 offset:24608
  ds_read_b64_tr_b16 v[138:139], v22 offset:25376
  v_mfma_f32_32x32x16_bf16 v[32:47], v[128:131], v[224:227], v[32:47]
  ds_read_b64_tr_b16 v[148:149], v22 offset:27680
  ds_read_b64_tr_b16 v[150:151], v22 offset:28448
  s_waitcnt lgkmcnt(9)
  v_mfma_f32_32x32x16_bf16 v[32:47], v[144:147], v[228:231], v[32:47]
  ds_read_b64_tr_b16 v[128:129], v22 offset:30752
  ds_read_b64_tr_b16 v[130:131], v22 offset:31520
  s_waitcnt lgkmcnt(6)
  v_cmp_gt_u32 vcc, 2, v15
  v_mfma_f32_32x32x16_bf16 v[32:47], v[132:135], v[232:235], v[32:47]
  ds_read_b64_tr_b16 v[144:145], v22 offset:33824
  ds_read_b64_tr_b16 v[146:147], v22 offset:34592
  s_cbranch_vccnz lw42
lw42x:
  ds_read_b32 v160, v180 offset:0
  ds_read_b32 v162, v180 offset:256
  ds_read_b32 v164, v180 offset:512
  ds_read_b32 v166, v180 offset:768
  ds_read_b32 v168, v180 offset:1024
  ds_read_b32 v170, v180 offset:1280
  v_mfma_f32_32x32x16_bf16 v[32:47], v[140:143], v[236:239], v[32:47]
  ds_read_b64_tr_b16 v[132:133], v21 offset:32
  ds_read_b64_tr_b16 v[134:135], v21 offset:800
  s_waitcnt lgkmcnt(14)
  v_mfma_f32_32x32x16_bf16 v[32:47], v[136:139], v[240:243], v[32:47]
  ds_read_b64_tr_b16 v[140:141], v21 offset:3104
  ds_read_b64_tr_b16 v[142:143], v21 offset:3872
  s_waitcnt lgkmcnt(14)
  v_mfma_f32_32x32x16_bf16 v[32:47], v[148:151], v[244:247], v[32:47]
  ds_read_b64_tr_b16 v[136:137], v21 offset:6176
  ds_read_b64_tr_b16 v[138:139], v21 offset:6944
  s_waitcnt lgkmcnt(14)
  v_mfma_f32_32x32x16_bf16 v[32:47], v[128:131], v[248:251], v[32:47]
  ds_read_b64_tr_b16 v[148:149], v21 offset:9248
  ds_read_b64_tr_b16 v[150:151], v21 offset:10016
  s_waitcnt lgkmcnt(14)
  v_mfma_f32_32x32x16_bf16 v[32:47], v[144:147], v[252:255], v[32:47]
  ds_read_b64_tr_b16 v[128:129], v22 offset:32
  ds_read_b64_tr_b16 v[130:131], v22 offset:800
  s_setprio 3
  s_waitcnt lgkmcnt(14)
  v_mfma_f32_32x32x16_bf16 v[32:47], v[160:163], v[174:177], v[32:47]
  s_waitcnt lgkmcnt(8)
  v_mfma_f32_32x32x16_bf16 v[48:63], v[132:135], v[208:211], v[48:63]
  ds_read_b64_tr_b16 v[144:145], v22 offset:3104
  ds_read_b64_tr_b16 v[146:147], v22 offset:3872
  s_waitcnt lgkmcnt(8)
  v_mfma_f32_32x32x16_bf16 v[48:63], v[140:143], v[212:215], v[48:63]
  ds_read_b64_tr_b16 v[132:133], v22 offset:6176
  ds_read_b64_tr_b16 v[134:135], v22 offset:6944
  s_waitcnt lgkmcnt(8)
  v_mfma_f32_32x32x16_bf16 v[48:63], v[136:139], v[216:219], v[48:63]
  ds_read_b64_tr_b16 v[140:141], v22 offset:9248
  ds_read_b64_tr_b16 v[142:143], v22 offset:10016
  v_mul_f32 v184, v179, v32
  v_mul_f32 v185, v179, v33
  v_mul_f32 v186, v179, v34
  v_mul_f32 v187, v179, v35
  v_mul_f32 v188, v179, v36
  v_mul_f32 v189, v179, v37
  s_waitcnt lgkmcnt(8)
  v_mfma_f32_32x32x16_bf16 v[48:63], v[148:151], v[220:223], v[48:63]
  ds_read_b64_tr_b16 v[136:137], v22 offset:24640
  ds_read_b64_tr_b16 v[138:139], v22 offset:25408
  v_mul_f32 v190, v179, v38
  v_mul_f32 v191, v179, v39
  v_exp_f32 v184, v184
  v_exp_f32 v185, v185
  s_waitcnt lgkmcnt(8)
  v_mfma_f32_32x32x16_bf16 v[48:63], v[128:131], v[224:227], v[48:63]
  ds_read_b64_tr_b16 v[148:149], v22 offset:27712
  ds_read_b64_tr_b16 v[150:151], v22 offset:28480
  v_exp_f32 v186, v186
  v_exp_f32 v187, v187
  s_waitcnt lgkmcnt(8)
  v_mfma_f32_32x32x16_bf16 v[48:63], v[144:147], v[228:231], v[48:63]
  ds_read_b64_tr_b16 v[128:129], v22 offset:30784
  ds_read_b64_tr_b16 v[130:131], v22 offset:31552
  v_exp_f32 v188, v188
  v_exp_f32 v189, v189
  v_exp_f32 v190, v190
  s_waitcnt lgkmcnt(8)
  v_mfma_f32_32x32x16_bf16 v[48:63], v[132:135], v[232:235], v[48:63]
  ds_read_b64_tr_b16 v[144:145], v22 offset:33856
  ds_read_b64_tr_b16 v[146:147], v22 offset:34624
  v_exp_f32 v191, v191
  v_fma_f32 v184, v184, v178, v178
  v_fma_f32 v185, v185, v178, v178
  s_waitcnt lgkmcnt(8)
  v_mfma_f32_32x32x16_bf16 v[48:63], v[140:143], v[236:239], v[48:63]
  ds_read_b64_tr_b16 v[132:133], v21 offset:64
  ds_read_b64_tr_b16 v[134:135], v21 offset:832
  v_fma_f32 v186, v186, v178, v178
  v_fma_f32 v187, v187, v178, v178
  v_fma_f32 v188, v188, v178, v178
  v_fma_f32 v189, v189, v178, v178
  v_fma_f32 v190, v190, v178, v178
  s_waitcnt lgkmcnt(8)
  v_mfma_f32_32x32x16_bf16 v[48:63], v[136:139], v[240:243], v[48:63]
  ds_read_b64_tr_b16 v[140:141], v21 offset:3136
  ds_read_b64_tr_b16 v[142:143], v21 offset:3904
  v_fma_f32 v191, v191, v178, v178
  v_rcp_f32 v184, v184
  v_rcp_f32 v185, v185
  v_rcp_f32 v186, v186
  s_waitcnt lgkmcnt(8)
  v_mfma_f32_32x32x16_bf16 v[48:63], v[148:151], v[244:247], v[48:63]
  ds_read_b64_tr_b16 v[136:137], v21 offset:6208
  ds_read_b64_tr_b16 v[138:139], v21 offset:6976
  v_rcp_f32 v187, v187
  v_rcp_f32 v188, v188
  s_waitcnt lgkmcnt(8)
  v_mfma_f32_32x32x16_bf16 v[48:63], v[128:131], v[248:251], v[48:63]
  ds_read_b64_tr_b16 v[148:149], v21 offset:9280
  ds_read_b64_tr_b16 v[150:151], v21 offset:10048
  v_rcp_f32 v189, v189
  v_rcp_f32 v190, v190
  v_rcp_f32 v191, v191
  s_waitcnt lgkmcnt(8)
  v_mfma_f32_32x32x16_bf16 v[48:63], v[144:147], v[252:255], v[48:63]
  ds_read_b64_tr_b16 v[128:129], v22 offset:64
  ds_read_b64_tr_b16 v[130:131], v22 offset:832
  v_mul_f32 v184, v184, v40
  v_mul_f32 v185, v185, v41
  v_mul_f32 v186, v186, v42
  v_mul_f32 v187, v187, v43
  v_mfma_f32_32x32x16_bf16 v[48:63], v[162:165], v[174:177], v[48:63]
  s_waitcnt lgkmcnt(8)
  v_mfma_f32_32x32x16_bf16 v[64:79], v[132:135], v[208:211], v[64:79]
  ds_read_b64_tr_b16 v[144:145], v22 offset:3136
  ds_read_b64_tr_b16 v[146:147], v22 offset:3904
  v_mul_f32 v188, v188, v44
  v_mul_f32 v189, v189, v45
  v_mul_f32 v190, v190, v46
  v_mul_f32 v191, v191, v47
  v_cvt_pk_bf16_f32 v32, v184, v185
  s_waitcnt lgkmcnt(8)
  v_mfma_f32_32x32x16_bf16 v[64:79], v[140:143], v[212:215], v[64:79]
  ds_read_b64_tr_b16 v[132:133], v22 offset:6208
  ds_read_b64_tr_b16 v[134:135], v22 offset:6976
  v_cvt_pk_bf16_f32 v33, v186, v187
  v_cvt_pk_bf16_f32 v34, v188, v189
  v_cvt_pk_bf16_f32 v35, v190, v191
  s_add_u32 s67, s66, 0
  buffer_store_dwordx4 v[32:35], v18, s[32:35], s67 offen offset:0 sc1
  s_waitcnt lgkmcnt(8)
  v_mfma_f32_32x32x16_bf16 v[64:79], v[136:139], v[216:219], v[64:79]
  ds_read_b64_tr_b16 v[140:141], v22 offset:9280
  ds_read_b64_tr_b16 v[142:143], v22 offset:10048
  v_mul_f32 v192, v179, v48
  v_mul_f32 v193, v179, v49
  v_mul_f32 v194, v179, v50
  v_mul_f32 v195, v179, v51
  v_mul_f32 v196, v179, v52
  v_mul_f32 v197, v179, v53
  s_waitcnt lgkmcnt(8)
  v_mfma_f32_32x32x16_bf16 v[64:79], v[148:151], v[220:223], v[64:79]
  ds_read_b64_tr_b16 v[136:137], v22 offset:24672
  ds_read_b64_tr_b16 v[138:139], v22 offset:25440
  v_mul_f32 v198, v179, v54
  v_mul_f32 v199, v179, v55
  v_exp_f32 v192, v192
  v_exp_f32 v193, v193
  s_waitcnt lgkmcnt(8)
  v_mfma_f32_32x32x16_bf16 v[64:79], v[128:131], v[224:227], v[64:79]
  ds_read_b64_tr_b16 v[148:149], v22 offset:27744
  ds_read_b64_tr_b16 v[150:151], v22 offset:28512
  v_exp_f32 v194, v194
  v_exp_f32 v195, v195
  s_waitcnt lgkmcnt(8)
  v_mfma_f32_32x32x16_bf16 v[64:79], v[144:147], v[228:231], v[64:79]
  ds_read_b64_tr_b16 v[128:129], v22 offset:30816
  ds_read_b64_tr_b16 v[130:131], v22 offset:31584
  v_exp_f32 v196, v196
  v_exp_f32 v197, v197
  v_exp_f32 v198, v198
  s_waitcnt lgkmcnt(8)
  v_mfma_f32_32x32x16_bf16 v[64:79], v[132:135], v[232:235], v[64:79]
  ds_read_b64_tr_b16 v[144:145], v22 offset:33888
  ds_read_b64_tr_b16 v[146:147], v22 offset:34656
  v_exp_f32 v199, v199
  v_fma_f32 v192, v192, v178, v178
  v_fma_f32 v193, v193, v178, v178
  s_waitcnt lgkmcnt(8)
  v_mfma_f32_32x32x16_bf16 v[64:79], v[140:143], v[236:239], v[64:79]
  ds_read_b64_tr_b16 v[132:133], v21 offset:96
  ds_read_b64_tr_b16 v[134:135], v21 offset:864
  v_fma_f32 v194, v194, v178, v178
  v_fma_f32 v195, v195, v178, v178
  v_fma_f32 v196, v196, v178, v178
  v_fma_f32 v197, v197, v178, v178
  v_fma_f32 v198, v198, v178, v178
  s_waitcnt lgkmcnt(8)
  v_mfma_f32_32x32x16_bf16 v[64:79], v[136:139], v[240:243], v[64:79]
  ds_read_b64_tr_b16 v[140:141], v21 offset:3168
  ds_read_b64_tr_b16 v[142:143], v21 offset:3936
  v_fma_f32 v199, v199, v178, v178
  v_rcp_f32 v192, v192
  v_rcp_f32 v193, v193
  v_rcp_f32 v194, v194
  s_waitcnt lgkmcnt(8)
  v_mfma_f32_32x32x16_bf16 v[64:79], v[148:151], v[244:247], v[64:79]
  ds_read_b64_tr_b16 v[136:137], v21 offset:6240
  ds_read_b64_tr_b16 v[138:139], v21 offset:7008
  v_rcp_f32 v195, v195
  v_rcp_f32 v196, v196
  s_waitcnt lgkmcnt(8)
  v_mfma_f32_32x32x16_bf16 v[64:79], v[128:131], v[248:251], v[64:79]
  ds_read_b64_tr_b16 v[148:149], v21 offset:9312
  ds_read_b64_tr_b16 v[150:151], v21 offset:10080
  v_rcp_f32 v197, v197
  v_rcp_f32 v198, v198
  v_rcp_f32 v199, v199
  s_waitcnt lgkmcnt(8)
  v_mfma_f32_32x32x16_bf16 v[64:79], v[144:147], v[252:255], v[64:79]
  ds_read_b64_tr_b16 v[128:129], v22 offset:96
  ds_read_b64_tr_b16 v[130:131], v22 offset:864
  v_mul_f32 v192, v192, v56
  v_mul_f32 v193, v193, v57
  v_mul_f32 v194, v194, v58
  v_mul_f32 v195, v195, v59
  v_mfma_f32_32x32x16_bf16 v[64:79], v[164:167], v[174:177], v[64:79]
  s_waitcnt lgkmcnt(8)
  v_mfma_f32_32x32x16_bf16 v[80:95], v[132:135], v[208:211], v[80:95]
  ds_read_b64_tr_b16 v[144:145], v22 offset:3168
  ds_read_b64_tr_b16 v[146:147], v22 offset:3936
  v_mul_f32 v196, v196, v60
  v_mul_f32 v197, v197, v61
  v_mul_f32 v198, v198, v62
  v_mul_f32 v199, v199, v63
  v_cvt_pk_bf16_f32 v48, v192, v193
  s_waitcnt lgkmcnt(8)
  v_mfma_f32_32x32x16_bf16 v[80:95], v[140:143], v[212:215], v[80:95]
  ds_read_b64_tr_b16 v[132:133], v22 offset:6240
  ds_read_b64_tr_b16 v[134:135], v22 offset:7008
  v_cvt_pk_bf16_f32 v49, v194, v195
  v_cvt_pk_bf16_f32 v50, v196, v197
  v_cvt_pk_bf16_f32 v51, v198, v199
  s_add_u32 s67, s66, 131072
  buffer_store_dwordx4 v[48:51], v18, s[32:35], s67 offen offset:0 sc1
  s_waitcnt lgkmcnt(8)
  v_mfma_f32_32x32x16_bf16 v[80:95], v[136:139], v[216:219], v[80:95]
  ds_read_b64_tr_b16 v[140:141], v22 offset:9312
  ds_read_b64_tr_b16 v[142:143], v22 offset:10080
  v_mul_f32 v184, v179, v64
  v_mul_f32 v185, v179, v65
  v_mul_f32 v186, v179, v66
  v_mul_f32 v187, v179, v67
  v_mul_f32 v188, v179, v68
  v_mul_f32 v189, v179, v69
  s_waitcnt lgkmcnt(8)
  v_mfma_f32_32x32x16_bf16 v[80:95], v[148:151], v[220:223], v[80:95]
  ds_read_b64_tr_b16 v[136:137], v22 offset:24704
  ds_read_b64_tr_b16 v[138:139], v22 offset:25472
  v_mul_f32 v190, v179, v70
  v_mul_f32 v191, v179, v71
  v_exp_f32 v184, v184
  v_exp_f32 v185, v185
  s_waitcnt lgkmcnt(8)
  v_mfma_f32_32x32x16_bf16 v[80:95], v[128:131], v[224:227], v[80:95]
  ds_read_b64_tr_b16 v[148:149], v22 offset:27776
  ds_read_b64_tr_b16 v[150:151], v22 offset:28544
  v_exp_f32 v186, v186
  v_exp_f32 v187, v187
  s_waitcnt lgkmcnt(8)
  v_mfma_f32_32x32x16_bf16 v[80:95], v[144:147], v[228:231], v[80:95]
  ds_read_b64_tr_b16 v[128:129], v22 offset:30848
  ds_read_b64_tr_b16 v[130:131], v22 offset:31616
  v_exp_f32 v188, v188
  v_exp_f32 v189, v189
  v_exp_f32 v190, v190
  s_waitcnt lgkmcnt(8)
  v_mfma_f32_32x32x16_bf16 v[80:95], v[132:135], v[232:235], v[80:95]
  ds_read_b64_tr_b16 v[144:145], v22 offset:33920
  ds_read_b64_tr_b16 v[146:147], v22 offset:34688
  v_exp_f32 v191, v191
  v_fma_f32 v184, v184, v178, v178
  v_fma_f32 v185, v185, v178, v178
  s_waitcnt lgkmcnt(8)
  v_mfma_f32_32x32x16_bf16 v[80:95], v[140:143], v[236:239], v[80:95]
  ds_read_b64_tr_b16 v[132:133], v21 offset:128
  ds_read_b64_tr_b16 v[134:135], v21 offset:896
  v_fma_f32 v186, v186, v178, v178
  v_fma_f32 v187, v187, v178, v178
  v_fma_f32 v188, v188, v178, v178
  v_fma_f32 v189, v189, v178, v178
  v_fma_f32 v190, v190, v178, v178
  s_waitcnt lgkmcnt(8)
  v_mfma_f32_32x32x16_bf16 v[80:95], v[136:139], v[240:243], v[80:95]
  ds_read_b64_tr_b16 v[140:141], v21 offset:3200
  ds_read_b64_tr_b16 v[142:143], v21 offset:3968
  v_fma_f32 v191, v191, v178, v178
  v_rcp_f32 v184, v184
  v_rcp_f32 v185, v185
  v_rcp_f32 v186, v186
  s_waitcnt lgkmcnt(8)
  v_mfma_f32_32x32x16_bf16 v[80:95], v[148:151], v[244:247], v[80:95]
  ds_read_b64_tr_b16 v[136:137], v21 offset:6272
  ds_read_b64_tr_b16 v[138:139], v21 offset:7040
  v_rcp_f32 v187, v187
  v_rcp_f32 v188, v188
  s_waitcnt lgkmcnt(8)
  v_mfma_f32_32x32x16_bf16 v[80:95], v[128:131], v[248:251], v[80:95]
  ds_read_b64_tr_b16 v[148:149], v21 offset:9344
  ds_read_b64_tr_b16 v[150:151], v21 offset:10112
  v_rcp_f32 v189, v189
  v_rcp_f32 v190, v190
  v_rcp_f32 v191, v191
  s_waitcnt lgkmcnt(8)
  v_mfma_f32_32x32x16_bf16 v[80:95], v[144:147], v[252:255], v[80:95]
  ds_read_b64_tr_b16 v[128:129], v22 offset:128
  ds_read_b64_tr_b16 v[130:131], v22 offset:896
  v_mul_f32 v184, v184, v72
  v_mul_f32 v185, v185, v73
  v_mul_f32 v186, v186, v74
  v_mul_f32 v187, v187, v75
  v_mfma_f32_32x32x16_bf16 v[80:95], v[166:169], v[174:177], v[80:95]
  s_waitcnt lgkmcnt(8)
  v_mfma_f32_32x32x16_bf16 v[96:111], v[132:135], v[208:211], v[96:111]
  ds_read_b64_tr_b16 v[144:145], v22 offset:3200
  ds_read_b64_tr_b16 v[146:147], v22 offset:3968
  v_mul_f32 v188, v188, v76
  v_mul_f32 v189, v189, v77
  v_mul_f32 v190, v190, v78
  v_mul_f32 v191, v191, v79
  v_cvt_pk_bf16_f32 v64, v184, v185
  s_waitcnt lgkmcnt(8)
  v_mfma_f32_32x32x16_bf16 v[96:111], v[140:143], v[212:215], v[96:111]
  ds_read_b64_tr_b16 v[132:133], v22 offset:6272
  ds_read_b64_tr_b16 v[134:135], v22 offset:7040
  v_cvt_pk_bf16_f32 v65, v186, v187
  v_cvt_pk_bf16_f32 v66, v188, v189
  v_cvt_pk_bf16_f32 v67, v190, v191
  s_add_u32 s67, s66, 262144
  buffer_store_dwordx4 v[64:67], v18, s[32:35], s67 offen offset:0 sc1
  s_waitcnt lgkmcnt(8)
  v_mfma_f32_32x32x16_bf16 v[96:111], v[136:139], v[216:219], v[96:111]
  ds_read_b64_tr_b16 v[140:141], v22 offset:9344
  ds_read_b64_tr_b16 v[142:143], v22 offset:10112
  v_mul_f32 v192, v179, v80
  v_mul_f32 v193, v179, v81
  v_mul_f32 v194, v179, v82
  v_mul_f32 v195, v179, v83
  v_mul_f32 v196, v179, v84
  v_mul_f32 v197, v179, v85
  s_waitcnt lgkmcnt(8)
  v_mfma_f32_32x32x16_bf16 v[96:111], v[148:151], v[220:223], v[96:111]
  ds_read_b64_tr_b16 v[136:137], v22 offset:24736
  ds_read_b64_tr_b16 v[138:139], v22 offset:25504
  v_mul_f32 v198, v179, v86
  v_mul_f32 v199, v179, v87
  v_exp_f32 v192, v192
  v_exp_f32 v193, v193
  s_waitcnt lgkmcnt(8)
  v_mfma_f32_32x32x16_bf16 v[96:111], v[128:131], v[224:227], v[96:111]
  ds_read_b64_tr_b16 v[148:149], v22 offset:27808
  ds_read_b64_tr_b16 v[150:151], v22 offset:28576
  v_exp_f32 v194, v194
  v_exp_f32 v195, v195
  s_waitcnt lgkmcnt(8)
  v_mfma_f32_32x32x16_bf16 v[96:111], v[144:147], v[228:231], v[96:111]
  ds_read_b64_tr_b16 v[128:129], v22 offset:30880
  ds_read_b64_tr_b16 v[130:131], v22 offset:31648
  v_exp_f32 v196, v196
  v_exp_f32 v197, v197
  v_exp_f32 v198, v198
  s_waitcnt lgkmcnt(8)
  v_mfma_f32_32x32x16_bf16 v[96:111], v[132:135], v[232:235], v[96:111]
  ds_read_b64_tr_b16 v[144:145], v22 offset:33952
  ds_read_b64_tr_b16 v[146:147], v22 offset:34720
  v_exp_f32 v199, v199
  v_fma_f32 v192, v192, v178, v178
  v_fma_f32 v193, v193, v178, v178
  s_waitcnt lgkmcnt(8)
  v_mfma_f32_32x32x16_bf16 v[96:111], v[140:143], v[236:239], v[96:111]
  ds_read_b64_tr_b16 v[132:133], v21 offset:160
  ds_read_b64_tr_b16 v[134:135], v21 offset:928
  v_fma_f32 v194, v194, v178, v178
  v_fma_f32 v195, v195, v178, v178
  v_fma_f32 v196, v196, v178, v178
  v_fma_f32 v197, v197, v178, v178
  v_fma_f32 v198, v198, v178, v178
  s_waitcnt lgkmcnt(8)
  v_mfma_f32_32x32x16_bf16 v[96:111], v[136:139], v[240:243], v[96:111]
  ds_read_b64_tr_b16 v[140:141], v21 offset:3232
  ds_read_b64_tr_b16 v[142:143], v21 offset:4000
  v_fma_f32 v199, v199, v178, v178
  v_rcp_f32 v192, v192
  v_rcp_f32 v193, v193
  v_rcp_f32 v194, v194
  s_waitcnt lgkmcnt(8)
  v_mfma_f32_32x32x16_bf16 v[96:111], v[148:151], v[244:247], v[96:111]
  ds_read_b64_tr_b16 v[136:137], v21 offset:6304
  ds_read_b64_tr_b16 v[138:139], v21 offset:7072
  v_rcp_f32 v195, v195
  v_rcp_f32 v196, v196
  s_waitcnt lgkmcnt(8)
  v_mfma_f32_32x32x16_bf16 v[96:111], v[128:131], v[248:251], v[96:111]
  ds_read_b64_tr_b16 v[148:149], v21 offset:9376
  ds_read_b64_tr_b16 v[150:151], v21 offset:10144
  v_rcp_f32 v197, v197
  v_rcp_f32 v198, v198
  v_rcp_f32 v199, v199
  s_waitcnt lgkmcnt(8)
  v_mfma_f32_32x32x16_bf16 v[96:111], v[144:147], v[252:255], v[96:111]
  ds_read_b64_tr_b16 v[128:129], v22 offset:160
  ds_read_b64_tr_b16 v[130:131], v22 offset:928
  v_mul_f32 v192, v192, v88
  v_mul_f32 v193, v193, v89
  v_mul_f32 v194, v194, v90
  v_mul_f32 v195, v195, v91
  v_mfma_f32_32x32x16_bf16 v[96:111], v[168:171], v[174:177], v[96:111]
  s_waitcnt lgkmcnt(8)
  v_mfma_f32_32x32x16_bf16 v[112:127], v[132:135], v[208:211], v[112:127]
  ds_read_b64_tr_b16 v[144:145], v22 offset:3232
  ds_read_b64_tr_b16 v[146:147], v22 offset:4000
  v_mul_f32 v196, v196, v92
  v_mul_f32 v197, v197, v93
  v_mul_f32 v198, v198, v94
  v_mul_f32 v199, v199, v95
  v_cvt_pk_bf16_f32 v80, v192, v193
  s_waitcnt lgkmcnt(8)
  v_mfma_f32_32x32x16_bf16 v[112:127], v[140:143], v[212:215], v[112:127]
  ds_read_b64_tr_b16 v[132:133], v22 offset:6304
  ds_read_b64_tr_b16 v[134:135], v22 offset:7072
  v_cvt_pk_bf16_f32 v81, v194, v195
  v_cvt_pk_bf16_f32 v82, v196, v197
  v_cvt_pk_bf16_f32 v83, v198, v199
  s_add_u32 s67, s66, 393216
  buffer_store_dwordx4 v[80:83], v18, s[32:35], s67 offen offset:0 sc1
  s_waitcnt lgkmcnt(8)
  v_mfma_f32_32x32x16_bf16 v[112:127], v[136:139], v[216:219], v[112:127]
  ds_read_b64_tr_b16 v[140:141], v22 offset:9376
  ds_read_b64_tr_b16 v[142:143], v22 offset:10144
  v_mul_f32 v184, v179, v96
  v_mul_f32 v185, v179, v97
  v_mul_f32 v186, v179, v98
  v_mul_f32 v187, v179, v99
  v_mul_f32 v188, v179, v100
  v_mul_f32 v189, v179, v101
  s_waitcnt lgkmcnt(8)
  v_mfma_f32_32x32x16_bf16 v[112:127], v[148:151], v[220:223], v[112:127]
  ds_read_b64_tr_b16 v[136:137], v22 offset:24768
  ds_read_b64_tr_b16 v[138:139], v22 offset:25536
  v_mul_f32 v190, v179, v102
  v_mul_f32 v191, v179, v103
  v_exp_f32 v184, v184
  v_exp_f32 v185, v185
  s_waitcnt lgkmcnt(8)
  v_mfma_f32_32x32x16_bf16 v[112:127], v[128:131], v[224:227], v[112:127]
  ds_read_b64_tr_b16 v[148:149], v22 offset:27840
  ds_read_b64_tr_b16 v[150:151], v22 offset:28608
  v_exp_f32 v186, v186
  v_exp_f32 v187, v187
  s_waitcnt lgkmcnt(8)
  v_mfma_f32_32x32x16_bf16 v[112:127], v[144:147], v[228:231], v[112:127]
  ds_read_b64_tr_b16 v[128:129], v22 offset:30912
  ds_read_b64_tr_b16 v[130:131], v22 offset:31680
  v_exp_f32 v188, v188
  v_exp_f32 v189, v189
  v_exp_f32 v190, v190
  s_waitcnt lgkmcnt(8)
  v_mfma_f32_32x32x16_bf16 v[112:127], v[132:135], v[232:235], v[112:127]
  ds_read_b64_tr_b16 v[144:145], v22 offset:33984
  ds_read_b64_tr_b16 v[146:147], v22 offset:34752
  v_mov_b32 v12, 8
  ds_write_b32 v16, v12 offset:1024
  v_exp_f32 v191, v191
  v_fma_f32 v184, v184, v178, v178
  v_fma_f32 v185, v185, v178, v178
  s_waitcnt lgkmcnt(9)
  v_mfma_f32_32x32x16_bf16 v[112:127], v[140:143], v[236:239], v[112:127]
  v_fma_f32 v186, v186, v178, v178
  v_fma_f32 v187, v187, v178, v178
  v_fma_f32 v188, v188, v178, v178
  v_fma_f32 v189, v189, v178, v178
  v_fma_f32 v190, v190, v178, v178
  s_waitcnt lgkmcnt(7)
  v_mfma_f32_32x32x16_bf16 v[112:127], v[136:139], v[240:243], v[112:127]
  v_fma_f32 v191, v191, v178, v178
  v_rcp_f32 v184, v184
  v_rcp_f32 v185, v185
  v_rcp_f32 v186, v186
  s_waitcnt lgkmcnt(5)
  v_mfma_f32_32x32x16_bf16 v[112:127], v[148:151], v[244:247], v[112:127]
  v_rcp_f32 v187, v187
  v_rcp_f32 v188, v188
  s_waitcnt lgkmcnt(3)
  v_mfma_f32_32x32x16_bf16 v[112:127], v[128:131], v[248:251], v[112:127]
  ds_read_b32 v14, v17 offset:1024
  v_rcp_f32 v189, v189
  v_rcp_f32 v190, v190
  v_rcp_f32 v191, v191
  s_waitcnt lgkmcnt(2)
  v_mfma_f32_32x32x16_bf16 v[112:127], v[144:147], v[252:255], v[112:127]
  v_mul_f32 v184, v184, v104
  v_mul_f32 v185, v185, v105
  v_mul_f32 v186, v186, v106
  v_mul_f32 v187, v187, v107
  v_mfma_f32_32x32x16_bf16 v[112:127], v[170:173], v[174:177], v[112:127]
  v_mul_f32 v188, v188, v108
  v_mul_f32 v189, v189, v109
  v_mul_f32 v190, v190, v110
  v_mul_f32 v191, v191, v111
  v_cvt_pk_bf16_f32 v96, v184, v185
  v_cvt_pk_bf16_f32 v97, v186, v187
  v_cvt_pk_bf16_f32 v98, v188, v189
  v_cvt_pk_bf16_f32 v99, v190, v191
  s_add_u32 s67, s66, 524288
  buffer_store_dwordx4 v[96:99], v18, s[32:35], s67 offen offset:0 sc1
  s_nop 1
  v_mul_f32 v192, v179, v112
  v_mul_f32 v193, v179, v113
  v_mul_f32 v194, v179, v114
  v_mul_f32 v195, v179, v115
  v_mul_f32 v196, v179, v116
  v_mul_f32 v197, v179, v117
  v_mul_f32 v198, v179, v118
  v_mul_f32 v199, v179, v119
  v_exp_f32 v192, v192
  v_exp_f32 v193, v193
  v_exp_f32 v194, v194
  v_exp_f32 v195, v195
  v_exp_f32 v196, v196
  v_exp_f32 v197, v197
  v_exp_f32 v198, v198
  v_exp_f32 v199, v199
  v_fma_f32 v192, v192, v178, v178
  v_fma_f32 v193, v193, v178, v178
  v_fma_f32 v194, v194, v178, v178
  v_fma_f32 v195, v195, v178, v178
  v_fma_f32 v196, v196, v178, v178
  v_fma_f32 v197, v197, v178, v178
  v_fma_f32 v198, v198, v178, v178
  v_fma_f32 v199, v199, v178, v178
  v_rcp_f32 v192, v192
  v_rcp_f32 v193, v193
  v_rcp_f32 v194, v194
  v_rcp_f32 v195, v195
  v_rcp_f32 v196, v196
  v_rcp_f32 v197, v197
  v_rcp_f32 v198, v198
  v_rcp_f32 v199, v199
  v_mul_f32 v192, v192, v120
  v_mul_f32 v193, v193, v121
  v_mul_f32 v194, v194, v122
  v_mul_f32 v195, v195, v123
  v_mul_f32 v196, v196, v124
  v_mul_f32 v197, v197, v125
  v_mul_f32 v198, v198, v126
  v_mul_f32 v199, v199, v127
  v_cvt_pk_bf16_f32 v112, v192, v193
  v_cvt_pk_bf16_f32 v113, v194, v195
  v_cvt_pk_bf16_f32 v114, v196, v197
  v_cvt_pk_bf16_f32 v115, v198, v199
  s_add_u32 s67, s66, 655360
  buffer_store_dwordx4 v[112:115], v18, s[32:35], s67 offen offset:0 sc1
  v_mov_b32 v181, s12
  s_waitcnt vmcnt(3)
  s_mov_b64 exec, 1
  buffer_store_dword v181, off, s[28:31], s69 offset:0 sc1
  s_mov_b64 exec, -1
  s_waitcnt lgkmcnt(0)
  v_cmp_gt_u32 vcc, 8, v14
  s_nop 1
  s_cbranch_vccnz lw43
lw43x:
  s_add_u32 m0, s6, 0
  s_add_u32 s7, s44, 49152
  buffer_load_dwordx4 v2, s[48:51], s7 offen lds
  s_add_u32 m0, s6, 1024
  s_add_u32 s7, s44, 57344
  buffer_load_dwordx4 v2, s[48:51], s7 offen lds
  s_add_u32 m0, s6, 8192
  s_add_u32 s7, s45, 49152
  buffer_load_dwordx4 v2, s[48:51], s7 offen lds
  s_add_u32 m0, s6, 9216
  s_add_u32 s7, s45, 57344
  buffer_load_dwordx4 v2, s[48:51], s7 offen lds
  s_add_u32 m0, s6, 16384
  s_add_u32 s7, s46, 49152
  buffer_load_dwordx4 v2, s[48:51], s7 offen lds
  s_add_u32 m0, s6, 17408
  s_add_u32 s7, s46, 57344
  buffer_load_dwordx4 v2, s[48:51], s7 offen lds
  s_add_u32 m0, s6, 24576
  s_add_u32 s7, s47, 49152
  buffer_load_dwordx4 v2, s[48:51], s7 offen lds
  s_add_u32 m0, s6, 25600
  s_add_u32 s7, s47, 57344
  buffer_load_dwordx4 v2, s[48:51], s7 offen lds
  v_lshlrev_b32 v6, 4, v153
  v_lshl_add_u32 v6, v152, 10, v6
  s_lshl_b32 s65, s4, 16
  s_add_u32 s64, s64, s65
  s_lshl_b32 s65, s20, 13
  s_add_u32 s64, s64, s65
  v_add_u32 v6, s64, v6
  s_lshl_b32 s64, s4, 12
  v_and_b32 v3, 56, v1
  v_add_u32 v3, v3, v1
  v_lshl_add_u32 v3, v3, 4, s64
  v_lshrrev_b32 v4, 5, v1
  v_lshlrev_b32 v4, 9, v4
  v_bfe_u32 v5, v1, 2, 2
  v_lshl_add_u32 v4, v5, 7, v4
  v_and_b32 v5, 8, v1
  v_lshl_add_u32 v4, v5, 3, v4
  v_and_b32 v5, 16, v1
  v_lshl_add_u32 v4, v5, 1, v4
  v_and_b32 v5, 3, v1
  v_lshl_add_u32 v4, v5, 3, v4
  v_add_u32 v4, s6, v4
  v_xor_b32 v5, 64, v4
  v_add_u32 v20, 131328, v4
  v_add_u32 v21, 131328, v5
  v_mov_b32 v14, s12
  s_waitcnt vmcnt(9)
  s_mov_b64 exec, 1
  buffer_store_dword v14, off, s[28:31], s69 offset:1024 sc1
  s_mov_b64 exec, -1
  s_setprio 0
  s_add_u32 m0, s6, 32768
  s_add_u32 s7, s44, 65536
  buffer_load_dwordx4 v2, s[48:51], s7 offen lds
  s_add_u32 m0, s6, 33792
  s_add_u32 s7, s44, 73728
  buffer_load_dwordx4 v2, s[48:51], s7 offen lds
  s_add_u32 m0, s6, 40960
  s_add_u32 s7, s45, 65536
  buffer_load_dwordx4 v2, s[48:51], s7 offen lds
  s_add_u32 m0, s6, 41984
  s_add_u32 s7, s45, 73728
  buffer_load_dwordx4 v2, s[48:51], s7 offen lds
  s_add_u32 m0, s6, 49152
  s_add_u32 s7, s46, 65536
  buffer_load_dwordx4 v2, s[48:51], s7 offen lds
  s_add_u32 m0, s6, 50176
  s_add_u32 s7, s46, 73728
  buffer_load_dwordx4 v2, s[48:51], s7 offen lds
  s_add_u32 m0, s6, 131328
  s_add_u32 s7, s47, 65536
  buffer_load_dwordx4 v2, s[48:51], s7 offen lds
  s_add_u32 m0, s6, 132352
  s_add_u32 s7, s47, 73728
  buffer_load_dwordx4 v2, s[48:51], s7 offen lds
  s_add_u32 m0, s6, 139520
  s_add_u32 s7, s44, 81920
  buffer_load_dwordx4 v2, s[48:51], s7 offen lds
  s_add_u32 m0, s6, 140544
  s_add_u32 s7, s44, 90112
  buffer_load_dwordx4 v2, s[48:51], s7 offen lds
  s_add_u32 m0, s6, 147712
  s_add_u32 s7, s45, 81920
  buffer_load_dwordx4 v2, s[48:51], s7 offen lds
  s_add_u32 m0, s6, 148736
  s_add_u32 s7, s45, 90112
  buffer_load_dwordx4 v2, s[48:51], s7 offen lds
  s_load_dword s36, s[70:71], s68 offset:1024 glc
  s_load_dword s37, s[70:71], s68 offset:1152 glc
  s_load_dword s38, s[70:71], s68 offset:1280 glc
  s_load_dword s39, s[70:71], s68 offset:1408 glc
  s_load_dword s40, s[70:71], s68 offset:1536 glc
  s_load_dword s41, s[70:71], s68 offset:1664 glc
  s_load_dword s42, s[70:71], s68 offset:1792 glc
  s_load_dword s43, s[70:71], s68 offset:1920 glc
  s_waitcnt lgkmcnt(0)
  s_xor_b64 s[36:37], s[36:37], s[100:101]
  s_xor_b64 s[38:39], s[38:39], s[100:101]
  s_xor_b64 s[40:41], s[40:41], s[100:101]
  s_xor_b64 s[42:43], s[42:43], s[100:101]
  s_or_b64 s[36:37], s[36:37], s[38:39]
  s_or_b64 s[36:37], s[36:37], s[40:41]
  s_or_b64 s[36:37], s[36:37], s[42:43]
  s_cbranch_scc1 sf44
sf44x:
  s_lshl3_add_u32 s64, s44, 0x60000
  buffer_load_dwordx4 v[176:179], v3, s[32:35], s64 offen offset:0 sc1
  buffer_load_dwordx4 v[180:183], v3, s[32:35], s64 offen offset:2048 sc1
  s_lshl3_add_u32 s64, s45, 0x60000
  buffer_load_dwordx4 v[184:187], v3, s[32:35], s64 offen offset:0 sc1
  buffer_load_dwordx4 v[188:191], v3, s[32:35], s64 offen offset:2048 sc1
  s_lshl3_add_u32 s64, s46, 0x60000
  buffer_load_dwordx4 v[192:195], v3, s[32:35], s64 offen offset:0 sc1
  buffer_load_dwordx4 v[196:199], v3, s[32:35], s64 offen offset:2048 sc1
  s_lshl3_add_u32 s64, s47, 0x60000
  buffer_load_dwordx4 v[200:203], v3, s[32:35], s64 offen offset:0 sc1
  buffer_load_dwordx4 v[204:207], v3, s[32:35], s64 offen offset:2048 sc1
  s_lshl3_add_u32 s64, s44, 0x80000
  buffer_load_dwordx4 v[208:211], v3, s[32:35], s64 offen offset:0 sc1
  buffer_load_dwordx4 v[212:215], v3, s[32:35], s64 offen offset:2048 sc1
  s_lshl3_add_u32 s64, s45, 0x80000
  buffer_load_dwordx4 v[216:219], v3, s[32:35], s64 offen offset:0 sc1
  buffer_load_dwordx4 v[220:223], v3, s[32:35], s64 offen offset:2048 sc1
  s_lshl3_add_u32 s64, s46, 0x80000
  buffer_load_dwordx4 v[224:227], v3, s[32:35], s64 offen offset:0 sc1
  buffer_load_dwordx4 v[228:231], v3, s[32:35], s64 offen offset:2048 sc1
  s_lshl3_add_u32 s64, s47, 0x80000
  buffer_load_dwordx4 v[232:235], v3, s[32:35], s64 offen offset:0 sc1
  buffer_load_dwordx4 v[236:239], v3, s[32:35], s64 offen offset:2048 sc1
  s_lshl3_add_u32 s64, s44, 0xa0000
  buffer_load_dwordx4 v[240:243], v3, s[32:35], s64 offen offset:0 sc1
  buffer_load_dwordx4 v[244:247], v3, s[32:35], s64 offen offset:2048 sc1
  s_lshl3_add_u32 s64, s45, 0xa0000
  buffer_load_dwordx4 v[248:251], v3, s[32:35], s64 offen offset:0 sc1
  buffer_load_dwordx4 v[252:255], v3, s[32:35], s64 offen offset:2048 sc1
  buffer_load_dwordx4 v[8:11], v6, s[56:59], 0 offen
  s_waitcnt vmcnt(40)
  ds_read_b64_tr_b16 v[96:97], v4 offset:0
  ds_read_b64_tr_b16 v[98:99], v4 offset:1024
  ds_read_b64_tr_b16 v[100:101], v5 offset:0
  ds_read_b64_tr_b16 v[102:103], v5 offset:1024
  s_waitcnt vmcnt(38)
  ds_read_b64_tr_b16 v[104:105], v4 offset:8192
  ds_read_b64_tr_b16 v[106:107], v4 offset:9216
  ds_read_b64_tr_b16 v[108:109], v5 offset:8192
  ds_read_b64_tr_b16 v[110:111], v5 offset:9216
  s_waitcnt vmcnt(36)
  ds_read_b64_tr_b16 v[112:113], v4 offset:16384
  ds_read_b64_tr_b16 v[114:115], v4 offset:17408
  ds_read_b64_tr_b16 v[116:117], v5 offset:16384
  ds_read_b64_tr_b16 v[118:119], v5 offset:17408
  s_waitcnt vmcnt(34)
  ds_read_b64_tr_b16 v[120:121], v4 offset:24576
  ds_read_b64_tr_b16 v[122:123], v4 offset:25600
  ds_read_b64_tr_b16 v[124:125], v5 offset:24576
  ds_read_b64_tr_b16 v[126:127], v5 offset:25600
  s_waitcnt vmcnt(31)
  ds_read_b64_tr_b16 v[128:129], v4 offset:32768
  ds_read_b64_tr_b16 v[130:131], v4 offset:33792
  ds_read_b64_tr_b16 v[132:133], v5 offset:32768
  ds_read_b64_tr_b16 v[134:135], v5 offset:33792
  s_waitcnt vmcnt(29)
  ds_read_b64_tr_b16 v[136:137], v4 offset:40960
  ds_read_b64_tr_b16 v[138:139], v4 offset:41984
  ds_read_b64_tr_b16 v[140:141], v5 offset:40960
  ds_read_b64_tr_b16 v[142:143], v5 offset:41984
  s_waitcnt vmcnt(27)
  ds_read_b64_tr_b16 v[144:145], v4 offset:49152
  ds_read_b64_tr_b16 v[146:147], v4 offset:50176
  ds_read_b64_tr_b16 v[148:149], v5 offset:49152
  ds_read_b64_tr_b16 v[150:151], v5 offset:50176
  s_waitcnt vmcnt(25)
  ds_read_b64_tr_b16 v[152:153], v20 offset:0
  ds_read_b64_tr_b16 v[154:155], v20 offset:1024
  ds_read_b64_tr_b16 v[156:157], v21 offset:0
  ds_read_b64_tr_b16 v[158:159], v21 offset:1024
  s_waitcnt vmcnt(23)
  ds_read_b64_tr_b16 v[160:161], v20 offset:8192
  ds_read_b64_tr_b16 v[162:163], v20 offset:9216
  ds_read_b64_tr_b16 v[164:165], v21 offset:8192
  ds_read_b64_tr_b16 v[166:167], v21 offset:9216
  s_waitcnt vmcnt(21)
  ds_read_b64_tr_b16 v[168:169], v20 offset:16384
  ds_read_b64_tr_b16 v[170:171], v20 offset:17408
  ds_read_b64_tr_b16 v[172:173], v21 offset:16384
  ds_read_b64_tr_b16 v[174:175], v21 offset:17408
  s_waitcnt vmcnt(20) lgkmcnt(15)
  v_mfma_f32_32x32x16_bf16 v[32:47], v[96:99], v[176:179], 0
  v_mfma_f32_32x32x16_bf16 v[48:63], v[100:103], v[176:179], 0
  s_waitcnt vmcnt(19)
  v_mfma_f32_32x32x16_bf16 v[80:95], v[100:103], v[180:183], 0
  v_mfma_f32_32x32x16_bf16 v[64:79], v[96:99], v[180:183], 0
  s_waitcnt vmcnt(18)
  v_mfma_f32_32x32x16_bf16 v[32:47], v[104:107], v[184:187], v[32:47]
  v_mfma_f32_32x32x16_bf16 v[48:63], v[108:111], v[184:187], v[48:63]
  s_waitcnt vmcnt(17)
  v_mfma_f32_32x32x16_bf16 v[80:95], v[108:111], v[188:191], v[80:95]
  v_mfma_f32_32x32x16_bf16 v[64:79], v[104:107], v[188:191], v[64:79]
  s_waitcnt vmcnt(16)
  v_mfma_f32_32x32x16_bf16 v[32:47], v[112:115], v[192:195], v[32:47]
  v_mfma_f32_32x32x16_bf16 v[48:63], v[116:119], v[192:195], v[48:63]
  s_waitcnt vmcnt(15)
  v_mfma_f32_32x32x16_bf16 v[80:95], v[116:119], v[196:199], v[80:95]
  v_mfma_f32_32x32x16_bf16 v[64:79], v[112:115], v[196:199], v[64:79]
  s_waitcnt vmcnt(14)
  v_mfma_f32_32x32x16_bf16 v[32:47], v[120:123], v[200:203], v[32:47]
  v_mfma_f32_32x32x16_bf16 v[48:63], v[124:127], v[200:203], v[48:63]
  s_waitcnt vmcnt(13)
  v_mfma_f32_32x32x16_bf16 v[80:95], v[124:127], v[204:207], v[80:95]
  v_mfma_f32_32x32x16_bf16 v[64:79], v[120:123], v[204:207], v[64:79]
  s_waitcnt vmcnt(12)
  v_mfma_f32_32x32x16_bf16 v[32:47], v[128:131], v[208:211], v[32:47]
  v_mfma_f32_32x32x16_bf16 v[48:63], v[132:135], v[208:211], v[48:63]
  s_waitcnt vmcnt(11)
  v_mfma_f32_32x32x16_bf16 v[80:95], v[132:135], v[212:215], v[80:95]
  v_mfma_f32_32x32x16_bf16 v[64:79], v[128:131], v[212:215], v[64:79]
  s_waitcnt vmcnt(10)
  v_mfma_f32_32x32x16_bf16 v[32:47], v[136:139], v[216:219], v[32:47]
  v_mfma_f32_32x32x16_bf16 v[48:63], v[140:143], v[216:219], v[48:63]
  s_waitcnt vmcnt(9)
  v_mfma_f32_32x32x16_bf16 v[80:95], v[140:143], v[220:223], v[80:95]
  v_mfma_f32_32x32x16_bf16 v[64:79], v[136:139], v[220:223], v[64:79]
  s_waitcnt vmcnt(8) lgkmcnt(14)
  v_mfma_f32_32x32x16_bf16 v[32:47], v[144:147], v[224:227], v[32:47]
  s_waitcnt lgkmcnt(12)
  v_mfma_f32_32x32x16_bf16 v[48:63], v[148:151], v[224:227], v[48:63]
  s_waitcnt vmcnt(7)
  v_mfma_f32_32x32x16_bf16 v[80:95], v[148:151], v[228:231], v[80:95]
  v_mfma_f32_32x32x16_bf16 v[64:79], v[144:147], v[228:231], v[64:79]
  s_waitcnt vmcnt(6) lgkmcnt(10)
  v_mfma_f32_32x32x16_bf16 v[32:47], v[152:155], v[232:235], v[32:47]
  s_waitcnt lgkmcnt(8)
  v_mfma_f32_32x32x16_bf16 v[48:63], v[156:159], v[232:235], v[48:63]
  s_waitcnt vmcnt(5)
  v_mfma_f32_32x32x16_bf16 v[80:95], v[156:159], v[236:239], v[80:95]
  v_mfma_f32_32x32x16_bf16 v[64:79], v[152:155], v[236:239], v[64:79]
  s_waitcnt vmcnt(4) lgkmcnt(6)
  v_mfma_f32_32x32x16_bf16 v[32:47], v[160:163], v[240:243], v[32:47]
  s_waitcnt lgkmcnt(4)
  v_mfma_f32_32x32x16_bf16 v[48:63], v[164:167], v[240:243], v[48:63]
  s_waitcnt vmcnt(3)
  v_mfma_f32_32x32x16_bf16 v[80:95], v[164:167], v[244:247], v[80:95]
  v_mfma_f32_32x32x16_bf16 v[64:79], v[160:163], v[244:247], v[64:79]
  ds_read_b32 v14, v17 offset:2048
  s_waitcnt vmcnt(2) lgkmcnt(3)
  v_mfma_f32_32x32x16_bf16 v[32:47], v[168:171], v[248:251], v[32:47]
  s_waitcnt lgkmcnt(1)
  v_mfma_f32_32x32x16_bf16 v[48:63], v[172:175], v[248:251], v[48:63]
  s_waitcnt vmcnt(1)
  v_mfma_f32_32x32x16_bf16 v[80:95], v[172:175], v[252:255], v[80:95]
  v_mfma_f32_32x32x16_bf16 v[64:79], v[168:171], v[252:255], v[64:79]
  s_waitcnt lgkmcnt(0)
  v_cmp_gt_u32 vcc, 4, v14
  s_nop 1
  s_cbranch_vccnz lw45
lw45x:
  s_waitcnt vmcnt(0)
  s_branch parallel_sum__linear_kernel_hedgehog__glu_gated_glu__prompt_kernel_tail
lw32:
  s_mov_b32 s14, 0x40000
lw32l:
  ds_read_b32 v13, v17 offset:0
  s_sub_u32 s14, s14, 1
  s_waitcnt lgkmcnt(0)
  s_cbranch_scc1 lw32x
  v_cmp_gt_u32 vcc, 1, v13
  s_nop 1
  s_cbranch_vccnz lw32l
  s_branch lw32x
lw33:
  s_mov_b32 s14, 0x40000
lw33l:
  ds_read_b32 v15, v17 offset:2048
  s_sub_u32 s14, s14, 1
  s_waitcnt lgkmcnt(0)
  s_cbranch_scc1 lw33x
  v_cmp_gt_u32 vcc, 1, v15
  s_nop 1
  s_cbranch_vccnz lw33l
  s_branch lw33x
lw34:
  s_mov_b32 s14, 0x40000
lw34l:
  ds_read_b32 v14, v17 offset:1024
  s_sub_u32 s14, s14, 1
  s_waitcnt lgkmcnt(0)
  s_cbranch_scc1 lw34x
  v_cmp_gt_u32 vcc, 1, v14
  s_nop 1
  s_cbranch_vccnz lw34l
  s_branch lw34x
lw35:
  s_mov_b32 s14, 0x40000
lw35l:
  ds_read_b32 v13, v17 offset:0
  s_sub_u32 s14, s14, 1
  s_waitcnt lgkmcnt(0)
  s_cbranch_scc1 lw35x
  v_cmp_gt_u32 vcc, 2, v13
  s_nop 1
  s_cbranch_vccnz lw35l
  s_branch lw35x
lw36:
  s_mov_b32 s14, 0x40000
lw36l:
  ds_read_b32 v14, v17 offset:1024
  s_sub_u32 s14, s14, 1
  s_waitcnt lgkmcnt(0)
  s_cbranch_scc1 lw36x
  v_cmp_gt_u32 vcc, 2, v14
  s_nop 1
  s_cbranch_vccnz lw36l
  s_branch lw36x
lw37:
  s_mov_b32 s14, 0x40000
lw37l:
  ds_read_b32 v13, v17 offset:0
  s_sub_u32 s14, s14, 1
  s_waitcnt lgkmcnt(0)
  s_cbranch_scc1 lw37x
  v_cmp_gt_u32 vcc, 3, v13
  s_nop 1
  s_cbranch_vccnz lw37l
  s_branch lw37x
lw38:
  s_mov_b32 s14, 0x40000
lw38l:
  ds_read_b32 v14, v17 offset:1024
  s_sub_u32 s14, s14, 1
  s_waitcnt lgkmcnt(0)
  s_cbranch_scc1 lw38x
  v_cmp_gt_u32 vcc, 3, v14
  s_nop 1
  s_cbranch_vccnz lw38l
  s_branch lw38x
lw39:
  s_mov_b32 s14, 0x40000
lw39l:
  ds_read_b32 v13, v17 offset:0
  s_sub_u32 s14, s14, 1
  s_waitcnt lgkmcnt(0)
  s_cbranch_scc1 lw39x
  v_cmp_gt_u32 vcc, 4, v13
  s_nop 1
  s_cbranch_vccnz lw39l
  s_branch lw39x
lw40:
  s_mov_b32 s14, 0x40000
lw40l:
  ds_read_b32 v13, v17 offset:0
  s_sub_u32 s14, s14, 1
  s_waitcnt lgkmcnt(0)
  s_cbranch_scc1 lw40x
  v_cmp_gt_u32 vcc, 6, v13
  s_nop 1
  s_cbranch_vccnz lw40l
  s_branch lw40x
lw41:
  s_mov_b32 s14, 0x40000
lw41l:
  ds_read_b32 v13, v17 offset:0
  s_sub_u32 s14, s14, 1
  s_waitcnt lgkmcnt(0)
  s_cbranch_scc1 lw41x
  v_cmp_gt_u32 vcc, 7, v13
  s_nop 1
  s_cbranch_vccnz lw41l
  s_branch lw41x
lw42:
  s_mov_b32 s14, 0x40000
lw42l:
  ds_read_b32 v15, v17 offset:2048
  s_sub_u32 s14, s14, 1
  s_waitcnt lgkmcnt(0)
  s_cbranch_scc1 lw42x
  v_cmp_gt_u32 vcc, 2, v15
  s_nop 1
  s_cbranch_vccnz lw42l
  s_branch lw42x
lw43:
  s_mov_b32 s14, 0x40000
lw43l:
  ds_read_b32 v14, v17 offset:1024
  s_sub_u32 s14, s14, 1
  s_waitcnt lgkmcnt(0)
  s_cbranch_scc1 lw43x
  v_cmp_gt_u32 vcc, 8, v14
  s_nop 1
  s_cbranch_vccnz lw43l
  s_branch lw43x
sf44:
  s_mov_b32 s14, 0x40000
sf44l:
  s_load_dword s36, s[70:71], s68 offset:1024 glc
  s_load_dword s37, s[70:71], s68 offset:1152 glc
  s_load_dword s38, s[70:71], s68 offset:1280 glc
  s_load_dword s39, s[70:71], s68 offset:1408 glc
  s_load_dword s40, s[70:71], s68 offset:1536 glc
  s_load_dword s41, s[70:71], s68 offset:1664 glc
  s_load_dword s42, s[70:71], s68 offset:1792 glc
  s_load_dword s43, s[70:71], s68 offset:1920 glc
  s_sub_u32 s14, s14, 1
  s_waitcnt lgkmcnt(0)
  s_cbranch_scc1 sf44x
  s_xor_b64 s[36:37], s[36:37], s[100:101]
  s_xor_b64 s[38:39], s[38:39], s[100:101]
  s_xor_b64 s[40:41], s[40:41], s[100:101]
  s_xor_b64 s[42:43], s[42:43], s[100:101]
  s_or_b64 s[36:37], s[36:37], s[38:39]
  s_or_b64 s[36:37], s[36:37], s[40:41]
  s_or_b64 s[36:37], s[36:37], s[42:43]
  s_cbranch_scc1 sf44l
  s_branch sf44x
lw45:
  s_mov_b32 s14, 0x40000
lw45l:
  ds_read_b32 v14, v17 offset:2048
  s_sub_u32 s14, s14, 1
  s_waitcnt lgkmcnt(0)
  s_cbranch_scc1 lw45x
  v_cmp_gt_u32 vcc, 4, v14
  s_nop 1
  s_cbranch_vccnz lw45l
  s_branch lw45x
.fill (32768 - (. - parallel_sum__linear_kernel_hedgehog__glu_gated_glu__prompt_kernel))/4, 4, 0xBF810000
parallel_sum__linear_kernel_hedgehog__glu_gated_glu__prompt_kernel_b0:
  v_and_b32 v12, 31, v1
  v_bfe_u32 v13, v1, 1, 3
  v_lshrrev_b32 v14, 5, v1
  v_xor_b32 v13, v13, v14
  v_lshlrev_b32 v13, 4, v13
  v_lshl_add_u32 v13, v12, 7, v13
  v_mov_b32 v24, v13
  v_xor_b32 v25, 32, v24
  v_xor_b32 v26, 64, v24
  v_xor_b32 v27, 96, v24
  v_add_u32 v28, 65536, v24
  v_add_u32 v29, 65536, v25
  v_add_u32 v30, 65536, v26
  v_add_u32 v31, 65536, v27
  v_lshrrev_b32 v14, 5, v1
  v_bfe_u32 v12, v1, 2, 2
  v_lshl_add_u32 v12, v14, 3, v12
  v_and_b32 v13, 3, v1
  v_lshlrev_b32 v13, 3, v13
  v_bfe_u32 v14, v1, 4, 1
  v_lshl_add_u32 v32, v12, 7, v13
  v_and_b32 v15, 8, v1
  v_lshl_add_u32 v32, v15, 3, v32
  v_lshl_add_u32 v32, v14, 5, v32
  s_lshl_b32 s64, s27, 5
  v_xor_b32 v32, s64, v32
  v_lshl_add_u32 v32, v14, 13, v32
  v_add_u32 v32, 16384, v32
  v_mul_u32_u24 v36, 160, v12
  v_mul_u32_u24 v15, 10368, v14
  v_add3_u32 v36, v36, v13, v15
  v_add_u32 v36, 131328, v36
  v_add_u32 v35, s64, v36
  v_add_u32 v33, 65536, v32
  s_mov_b32 s15, 0x03020302
  s_mov_b32 s16, 0x01000100
  s_lshr_b32 s64, s21, 3
  s_lshl_b32 s64, s64, 4
  s_add_u32 s64, s64, s25
  s_mul_i32 s64, s64, 18432
  s_add_u32 s11, s64, 0x1400000
  s_lshl_b32 s64, s27, 8
  s_add_u32 s64, s64, 160640
  v_lshlrev_b32 v16, 2, v1
  v_add_u32 v16, s64, v16
  v_and_b32 v17, 3, v1
  v_mul_u32_u24 v17, 260, v17
  v_add_u32 v17, 160640, v17
  v_mov_b32 v12, 0
  ds_write_b32 v16, v12 offset:2048
  s_lshl_b32 s64, s21, 2
  s_lshl_b32 s65, s23, 1
  s_add_u32 s64, s64, s65
  s_lshl_b32 s64, s64, 11
  v_and_b32 v18, 56, v1
  v_add_u32 v18, v18, v1
  v_lshl_add_u32 v18, v18, 4, s64
  s_lshl_b32 s6, s27, 11
  s_add_u32 s6, s6, 65792
  v_lshrrev_b32 v12, 3, v1
  v_and_b32 v13, 7, v1
  v_lshlrev_b32 v2, 1, v12
  v_and_b32 v2, 4, v2
  v_xor_b32 v2, v2, v13
  v_lshlrev_b32 v2, 4, v2
  v_lshl_add_u32 v2, v12, 10, v2
  s_lshl_b32 s64, s5, 7
  v_add_u32 v2, s64, v2
  v_lshlrev_b32 v6, 4, v13
  v_lshl_add_u32 v6, v12, 10, v6
  s_lshl_b32 s65, s4, 16
  s_add_u32 s64, s64, s65
  s_lshl_b32 s65, s20, 13
  s_add_u32 s64, s64, s65
  v_add_u32 v6, s64, v6
  s_lshl_b32 s64, s4, 12
  v_and_b32 v3, 56, v1
  v_add_u32 v3, v3, v1
  v_lshl_add_u32 v3, v3, 4, s64
  v_lshrrev_b32 v4, 5, v1
  v_lshlrev_b32 v4, 9, v4
  v_bfe_u32 v5, v1, 2, 2
  v_lshl_add_u32 v4, v5, 7, v4
  v_and_b32 v5, 8, v1
  v_lshl_add_u32 v4, v5, 3, v4
  v_and_b32 v5, 16, v1
  v_lshl_add_u32 v4, v5, 1, v4
  v_and_b32 v5, 3, v1
  v_lshl_add_u32 v4, v5, 3, v4
  v_add_u32 v4, s6, v4
  v_xor_b32 v5, 64, v4
  s_mul_i32 s44, s27, 360448
  s_add_u32 s45, s44, 262144
  s_min_u32 s45, s45, 1310720
  s_add_u32 s46, s44, 98304
  s_sub_u32 s47, s45, 81920
  s_cmp_eq_u32 s27, 3
  s_cselect_b32 s10, 0x800000, s47
  s_lshl_b32 s13, s27, 17
  s_lshr_b32 s64, s2, 3
  s_cmp_lt_u32 s64, 24
  s_cselect_b32 s36, s48, s52
  s_cselect_b32 s37, s49, s53
  s_cselect_b32 s38, s50, s54
  s_cselect_b32 s65, 0, 24
  s_mov_b32 s39, 0x20000
  s_sub_u32 s64, s64, s65
  s_lshl_b32 s0, s64, 16
  v_and_b32 v34, 31, v1
  v_lshlrev_b32 v34, 2, v34
  v_lshlrev_b32 v38, 1, v34
  s_and_b32 s64, s21, 7
  s_lshl_b32 s64, s64, 8
  v_add_u32 v38, s64, v38
  v_mov_b32 v160, -1
  v_mov_b32 v161, -1
  v_mov_b32 v162, -1
  v_mov_b32 v163, -1
  s_lshl2_add_u32 s64, s22, s27
  s_lshl4_add_u32 s65, s64, s21
  s_lshl_b32 s65, s65, 11
  s_add_u32 s65, s65, 0x1600000
  s_lshl_b32 s64, s64, 11
  s_and_b32 s66, s21, 8
  s_add_u32 s66, s66, s21
  s_lshl4_add_u32 s64, s66, s64
  s_add_u32 s64, s64, 0x1700000
  v_and_b32 v12, 32, v34
  v_add_u32 v12, v12, v34
  v_lshl_add_u32 v37, v12, 2, s65
  v_mov_b32 v12, s64
  v_cmp_eq_u32 vcc, 64, v34
  s_nop 1
  v_cndmask_b32 v37, v37, v12, vcc
  v_bfrev_b32 v12, 2
  v_cmp_lt_u32 vcc, 64, v34
  s_nop 1
  v_cndmask_b32 v37, v37, v12, vcc
  v_and_b32 v12, 32, v1
  v_lshl_add_u32 v37, v12, 4, v37
  v_add_u32 v34, 160128, v34
  v_lshrrev_b32 v12, 2, v1
  v_and_b32 v12, 4, v12
  v_and_b32 v13, 12, v1
  v_cmp_eq_u32 vcc, v12, v13
  v_mov_b32 v12, 0x3f803f80
  s_nop 0
  v_cndmask_b32 v44, 0, v12, vcc
  v_cndmask_b32 v45, 0, v12, vcc
  v_cndmask_b32 v46, 0, v12, vcc
  v_cndmask_b32 v47, 0, v12, vcc
  v_mov_b32 v21, 0
  v_mov_b32 v22, 0
  v_mov_b32 v23, 0
  s_waitcnt vmcnt(1)
  s_waitcnt lgkmcnt(0)
  s_mul_i32 s12, s12, 1664525
  s_add_u32 s12, s12, 1013904223
  s_lshl2_add_u32 s65, s17, s27
  s_lshl_b32 s65, s65, 4
  s_add_u32 s65, s65, 0x1780000
  v_lshlrev_b32 v136, 16, v128
  v_and_b32 v137, 0xffff0000, v128
  v_lshlrev_b32 v138, 16, v129
  v_and_b32 v139, 0xffff0000, v129
  v_lshlrev_b32 v140, 16, v130
  v_and_b32 v141, 0xffff0000, v130
  v_lshlrev_b32 v142, 16, v131
  v_and_b32 v143, 0xffff0000, v131
  v_lshlrev_b32 v144, 16, v132
  v_and_b32 v145, 0xffff0000, v132
  v_lshlrev_b32 v146, 16, v133
  v_and_b32 v147, 0xffff0000, v133
  v_lshlrev_b32 v148, 16, v134
  v_and_b32 v149, 0xffff0000, v134
  v_lshlrev_b32 v150, 16, v135
  v_and_b32 v151, 0xffff0000, v135
  v_add_f32 v152, v136, v137
  v_add_f32 v153, v138, v139
  v_add_f32 v152, v152, v140
  v_add_f32 v153, v153, v141
  v_add_f32 v152, v152, v142
  v_add_f32 v153, v153, v143
  v_add_f32 v152, v152, v144
  v_add_f32 v153, v153, v145
  v_add_f32 v152, v152, v146
  v_add_f32 v153, v153, v147
  v_add_f32 v152, v152, v148
  v_add_f32 v153, v153, v149
  v_add_f32 v152, v152, v150
  v_add_f32 v153, v153, v151
  v_add_f32 v152, v152, v153
  s_nop 1
  v_add_f32_dpp v152, v152, v152 row_ror:8 row_mask:0xf bank_mask:0xf
  s_nop 1
  v_add_f32_dpp v152, v152, v152 row_ror:4 row_mask:0xf bank_mask:0xf
  s_nop 1
  v_add_f32_dpp v152, v152, v152 row_ror:2 row_mask:0xf bank_mask:0xf
  s_nop 1
  v_add_f32_dpp v152, v152, v152 row_ror:1 row_mask:0xf bank_mask:0xf
  v_mov_b32 v153, v152
  s_nop 1
  v_permlane16_swap_b32 v152, v153
  v_add_f32 v152, v152, v153
  v_mul_f32 v153, 0xbb000000, v152
  v_add_f32 v136, v136, v153
  v_add_f32 v137, v137, v153
  v_add_f32 v138, v138, v153
  v_add_f32 v139, v139, v153
  v_add_f32 v140, v140, v153
  v_add_f32 v141, v141, v153
  v_add_f32 v142, v142, v153
  v_add_f32 v143, v143, v153
  v_add_f32 v144, v144, v153
  v_add_f32 v145, v145, v153
  v_add_f32 v146, v146, v153
  v_add_f32 v147, v147, v153
  v_add_f32 v148, v148, v153
  v_add_f32 v149, v149, v153
  v_add_f32 v150, v150, v153
  v_add_f32 v151, v151, v153
  v_mul_f32 v152, v136, v136
  v_mul_f32 v154, v137, v137
  v_fmac_f32 v152, v138, v138
  v_fmac_f32 v154, v139, v139
  v_fmac_f32 v152, v140, v140
  v_fmac_f32 v154, v141, v141
  v_fmac_f32 v152, v142, v142
  v_fmac_f32 v154, v143, v143
  v_fmac_f32 v152, v144, v144
  v_fmac_f32 v154, v145, v145
  v_fmac_f32 v152, v146, v146
  v_fmac_f32 v154, v147, v147
  v_fmac_f32 v152, v148, v148
  v_fmac_f32 v154, v149, v149
  v_fmac_f32 v152, v150, v150
  v_fmac_f32 v154, v151, v151
  v_add_f32 v152, v152, v154
  s_nop 1
  v_add_f32_dpp v152, v152, v152 row_ror:8 row_mask:0xf bank_mask:0xf
  s_nop 1
  v_add_f32_dpp v152, v152, v152 row_ror:4 row_mask:0xf bank_mask:0xf
  s_nop 1
  v_add_f32_dpp v152, v152, v152 row_ror:2 row_mask:0xf bank_mask:0xf
  s_nop 1
  v_add_f32_dpp v152, v152, v152 row_ror:1 row_mask:0xf bank_mask:0xf
  v_mov_b32 v154, v152
  s_nop 1
  v_permlane16_swap_b32 v152, v154
  v_add_f32 v152, v152, v154
  v_mul_f32 v152, 0x3b000000, v152
  v_cvt_pk_bf16_f32 v152, v152, v152
  v_lshlrev_b32 v152, 16, v152
  v_add_f32 v152, 0x3727c5ac, v152
  v_cvt_pk_bf16_f32 v152, v152, v152
  v_lshlrev_b32 v152, 16, v152
  v_sqrt_f32 v152, v152
  s_nop 0
  v_cvt_pk_bf16_f32 v152, v152, v153
  v_mov_b32 v153, s12
  s_mov_b32 exec_lo, 1
  s_mov_b32 exec_hi, 1
  buffer_store_dwordx2 v[152:153], v157, s[28:31], s65 offen sc1
  s_mov_b64 exec, -1
  s_mov_b32 s100, s12
  s_mov_b32 s101, s12
  s_lshl2_add_u32 s68, s4, s27
  s_lshl_b32 s68, s68, 12
  s_add_u32 s68, s68, 0xb80000
  s_lshl1_add_u32 s64, s21, s23
  s_lshr_b32 s65, s25, 2
  s_lshl2_add_u32 s64, s64, s65
  s_lshl_b32 s64, s64, 5
  s_and_b32 s65, s25, 2
  s_add_u32 s65, s65, s24
  s_add_u32 s64, s64, s65
  s_lshl_b32 s64, s64, 7
  s_add_u32 s69, s64, 0xb80000
  buffer_store_dwordx4 v[160:163], v37, s[28:31], 0 offen offset:0 sc1
  buffer_store_dwordx4 v[160:163], v37, s[28:31], 0 offen offset:1024 sc1
  s_waitcnt vmcnt(3)
  s_lshl_b32 s64, s27, 9
  s_add_u32 s64, s64, 156032
  v_bfe_u32 v12, v1, 2, 2
  v_lshlrev_b32 v12, 5, v12
  v_and_b32 v13, 32, v1
  v_lshl_add_u32 v12, v13, 2, v12
  v_and_b32 v13, 16, v1
  v_add_u32 v12, v12, v13
  v_and_b32 v13, 2, v1
  v_lshl_add_u32 v12, v13, 2, v12
  v_add_u32 v12, s64, v12
  ds_read_b64_tr_b16 v[40:41], v12 offset:0
  ds_read_b64_tr_b16 v[42:43], v12 offset:256
  v_and_b32 v13, 4, v1
  v_cmp_ne_u32 vcc, 0, v13
  v_mov_b32 v13, 0x80008000
  s_nop 0
  v_cndmask_b32 v13, 0, v13, vcc
  s_waitcnt lgkmcnt(1)
  v_xor_b32 v40, v13, v40
  v_xor_b32 v41, v13, v41
  s_waitcnt lgkmcnt(0)
  v_xor_b32 v42, v13, v42
  v_xor_b32 v43, v13, v43
  s_barrier
  s_setprio 3
  ds_read_b128 v[48:51], v24 offset:0
  ds_read_b64_tr_b16 v[64:65], v32 offset:0
  ds_read_b64_tr_b16 v[66:67], v32 offset:512
  ds_read_b128 v[52:55], v24 offset:4096
  ds_read_b128 v[56:59], v24 offset:8192
  ds_read_b128 v[60:63], v24 offset:12288
  ds_read_b128 v[68:71], v25 offset:0
  ds_read_b64_tr_b16 v[84:85], v32 offset:2048
  ds_read_b64_tr_b16 v[86:87], v32 offset:2560
  ds_read_b128 v[72:75], v25 offset:4096
  ds_read_b128 v[76:79], v25 offset:8192
  ds_read_b128 v[80:83], v25 offset:12288
  s_waitcnt lgkmcnt(9)
  v_mfma_f32_16x16x32_bf16 v[252:255], v[44:47], v[64:67], 0
  v_mfma_f32_32x32x16_bf16 v[108:123], v[64:67], v[48:51], 0
  ds_read_b128 v[88:91], v26 offset:0
  ds_read_b64_tr_b16 v[104:105], v32 offset:4096
  s_waitcnt lgkmcnt(10)
  v_mfma_f32_32x32x16_bf16 v[124:139], v[64:67], v[52:55], 0
  ds_read_b64_tr_b16 v[106:107], v32 offset:4608
  ds_read_b128 v[92:95], v26 offset:4096
  s_waitcnt lgkmcnt(11)
  v_mfma_f32_32x32x16_bf16 v[140:155], v[64:67], v[56:59], 0
  ds_read_b128 v[96:99], v26 offset:8192
  ds_read_b128 v[100:103], v26 offset:12288
  s_waitcnt lgkmcnt(12)
  v_mfma_f32_32x32x16_bf16 v[156:171], v[64:67], v[60:63], 0
  s_waitcnt lgkmcnt(9)
  v_mfma_f32_16x16x32_bf16 v[252:255], v[44:47], v[84:87], v[252:255]
  v_mfma_f32_32x32x16_bf16 v[108:123], v[84:87], v[68:71], v[108:123]
  ds_read_b128 v[48:51], v27 offset:0
  ds_read_b64_tr_b16 v[64:65], v32 offset:6144
  s_waitcnt lgkmcnt(10)
  v_mfma_f32_32x32x16_bf16 v[124:139], v[84:87], v[72:75], v[124:139]
  ds_read_b64_tr_b16 v[66:67], v32 offset:6656
  ds_read_b128 v[52:55], v27 offset:4096
  s_waitcnt lgkmcnt(11)
  v_mfma_f32_32x32x16_bf16 v[140:155], v[84:87], v[76:79], v[140:155]
  ds_read_b128 v[56:59], v27 offset:8192
  ds_read_b128 v[60:63], v27 offset:12288
  s_waitcnt lgkmcnt(12)
  v_mfma_f32_32x32x16_bf16 v[156:171], v[84:87], v[80:83], v[156:171]
  s_waitcnt lgkmcnt(9)
  v_mfma_f32_16x16x32_bf16 v[252:255], v[44:47], v[104:107], v[252:255]
  v_mfma_f32_32x32x16_bf16 v[108:123], v[104:107], v[88:91], v[108:123]
  s_waitcnt lgkmcnt(0)
  s_barrier
  ds_read_b128 v[68:71], v24 offset:32768
  ds_read_b64_tr_b16 v[84:85], v32 offset:32768
  ds_read_b64_tr_b16 v[86:87], v32 offset:33280
  v_mfma_f32_32x32x16_bf16 v[124:139], v[104:107], v[92:95], v[124:139]
  ds_read_b128 v[72:75], v24 offset:36864
  ds_read_b128 v[76:79], v24 offset:40960
  v_mfma_f32_32x32x16_bf16 v[140:155], v[104:107], v[96:99], v[140:155]
  ds_read_b128 v[80:83], v24 offset:45056
  v_mfma_f32_32x32x16_bf16 v[156:171], v[104:107], v[100:103], v[156:171]
  v_mfma_f32_16x16x32_bf16 v[252:255], v[44:47], v[64:67], v[252:255]
  v_mfma_f32_32x32x16_bf16 v[108:123], v[64:67], v[48:51], v[108:123]
  ds_read_b128 v[88:91], v25 offset:32768
  ds_read_b64_tr_b16 v[104:105], v32 offset:34816
  v_mfma_f32_32x32x16_bf16 v[124:139], v[64:67], v[52:55], v[124:139]
  ds_read_b64_tr_b16 v[106:107], v32 offset:35328
  ds_read_b128 v[92:95], v25 offset:36864
  v_mfma_f32_32x32x16_bf16 v[140:155], v[64:67], v[56:59], v[140:155]
  ds_read_b128 v[96:99], v25 offset:40960
  ds_read_b128 v[100:103], v25 offset:45056
  v_mfma_f32_32x32x16_bf16 v[156:171], v[64:67], v[60:63], v[156:171]
  s_waitcnt lgkmcnt(9)
  v_mfma_f32_16x16x32_bf16 v[252:255], v[44:47], v[84:87], v[252:255]
  v_mfma_f32_32x32x16_bf16 v[108:123], v[84:87], v[68:71], v[108:123]
  ds_read_b128 v[48:51], v26 offset:32768
  ds_read_b64_tr_b16 v[64:65], v32 offset:36864
  s_waitcnt lgkmcnt(10)
  v_mfma_f32_32x32x16_bf16 v[124:139], v[84:87], v[72:75], v[124:139]
  ds_read_b64_tr_b16 v[66:67], v32 offset:37376
  ds_read_b128 v[52:55], v26 offset:36864
  s_waitcnt lgkmcnt(11)
  v_mfma_f32_32x32x16_bf16 v[140:155], v[84:87], v[76:79], v[140:155]
  ds_read_b128 v[56:59], v26 offset:40960
  ds_read_b128 v[60:63], v26 offset:45056
  s_waitcnt lgkmcnt(12)
  v_mfma_f32_32x32x16_bf16 v[156:171], v[84:87], v[80:83], v[156:171]
  s_waitcnt lgkmcnt(9)
  v_mfma_f32_16x16x32_bf16 v[252:255], v[44:47], v[104:107], v[252:255]
  v_mfma_f32_32x32x16_bf16 v[108:123], v[104:107], v[88:91], v[108:123]
  ds_read_b128 v[68:71], v27 offset:32768
  ds_read_b64_tr_b16 v[84:85], v32 offset:38912
  s_waitcnt lgkmcnt(10)
  v_mfma_f32_32x32x16_bf16 v[124:139], v[104:107], v[92:95], v[124:139]
  ds_read_b64_tr_b16 v[86:87], v32 offset:39424
  ds_read_b128 v[72:75], v27 offset:36864
  s_waitcnt lgkmcnt(11)
  v_mfma_f32_32x32x16_bf16 v[140:155], v[104:107], v[96:99], v[140:155]
  ds_read_b128 v[76:79], v27 offset:40960
  ds_read_b128 v[80:83], v27 offset:45056
  s_waitcnt lgkmcnt(12)
  v_mfma_f32_32x32x16_bf16 v[156:171], v[104:107], v[100:103], v[156:171]
  s_waitcnt lgkmcnt(9)
  v_mfma_f32_16x16x32_bf16 v[252:255], v[44:47], v[64:67], v[252:255]
  v_mfma_f32_32x32x16_bf16 v[108:123], v[64:67], v[48:51], v[108:123]
  s_waitcnt lgkmcnt(0)
  s_barrier
  ds_read_b128 v[88:91], v28 offset:0
  ds_read_b64_tr_b16 v[104:105], v33 offset:0
  ds_read_b64_tr_b16 v[106:107], v33 offset:512
  v_mfma_f32_32x32x16_bf16 v[124:139], v[64:67], v[52:55], v[124:139]
  ds_read_b128 v[92:95], v28 offset:4096
  ds_read_b128 v[96:99], v28 offset:8192
  v_mfma_f32_32x32x16_bf16 v[140:155], v[64:67], v[56:59], v[140:155]
  ds_read_b128 v[100:103], v28 offset:12288
  v_mfma_f32_32x32x16_bf16 v[156:171], v[64:67], v[60:63], v[156:171]
  v_mfma_f32_16x16x32_bf16 v[252:255], v[44:47], v[84:87], v[252:255]
  v_mfma_f32_32x32x16_bf16 v[108:123], v[84:87], v[68:71], v[108:123]
  ds_read_b128 v[48:51], v29 offset:0
  ds_read_b64_tr_b16 v[64:65], v33 offset:2048
  v_mfma_f32_32x32x16_bf16 v[124:139], v[84:87], v[72:75], v[124:139]
  ds_read_b64_tr_b16 v[66:67], v33 offset:2560
  ds_read_b128 v[52:55], v29 offset:4096
  v_mfma_f32_32x32x16_bf16 v[140:155], v[84:87], v[76:79], v[140:155]
  ds_read_b128 v[56:59], v29 offset:8192
  ds_read_b128 v[60:63], v29 offset:12288
  v_mfma_f32_32x32x16_bf16 v[156:171], v[84:87], v[80:83], v[156:171]
  s_waitcnt lgkmcnt(9)
  v_mfma_f32_16x16x32_bf16 v[252:255], v[44:47], v[104:107], v[252:255]
  v_mfma_f32_32x32x16_bf16 v[108:123], v[104:107], v[88:91], v[108:123]
  ds_read_b128 v[68:71], v30 offset:0
  ds_read_b64_tr_b16 v[84:85], v33 offset:4096
  s_waitcnt lgkmcnt(10)
  v_mfma_f32_32x32x16_bf16 v[124:139], v[104:107], v[92:95], v[124:139]
  ds_read_b64_tr_b16 v[86:87], v33 offset:4608
  ds_read_b128 v[72:75], v30 offset:4096
  s_waitcnt lgkmcnt(11)
  v_mfma_f32_32x32x16_bf16 v[140:155], v[104:107], v[96:99], v[140:155]
  ds_read_b128 v[76:79], v30 offset:8192
  ds_read_b128 v[80:83], v30 offset:12288
  s_waitcnt lgkmcnt(12)
  v_mfma_f32_32x32x16_bf16 v[156:171], v[104:107], v[100:103], v[156:171]
  s_waitcnt lgkmcnt(9)
  v_mfma_f32_16x16x32_bf16 v[252:255], v[44:47], v[64:67], v[252:255]
  v_mfma_f32_32x32x16_bf16 v[108:123], v[64:67], v[48:51], v[108:123]
  ds_read_b128 v[88:91], v31 offset:0
  ds_read_b64_tr_b16 v[104:105], v33 offset:6144
  s_waitcnt lgkmcnt(10)
  v_mfma_f32_32x32x16_bf16 v[124:139], v[64:67], v[52:55], v[124:139]
  ds_read_b64_tr_b16 v[106:107], v33 offset:6656
  ds_read_b128 v[92:95], v31 offset:4096
  s_waitcnt lgkmcnt(11)
  v_mfma_f32_32x32x16_bf16 v[140:155], v[64:67], v[56:59], v[140:155]
  ds_read_b128 v[96:99], v31 offset:8192
  ds_read_b128 v[100:103], v31 offset:12288
  s_waitcnt lgkmcnt(12)
  v_mfma_f32_32x32x16_bf16 v[156:171], v[64:67], v[60:63], v[156:171]
  s_waitcnt lgkmcnt(9)
  v_mfma_f32_16x16x32_bf16 v[252:255], v[44:47], v[84:87], v[252:255]
  v_mfma_f32_32x32x16_bf16 v[108:123], v[84:87], v[68:71], v[108:123]
  s_waitcnt lgkmcnt(0)
  s_barrier
  ds_read_b128 v[48:51], v28 offset:32768
  ds_read_b64_tr_b16 v[64:65], v33 offset:32768
  ds_read_b64_tr_b16 v[66:67], v33 offset:33280
  v_mfma_f32_32x32x16_bf16 v[124:139], v[84:87], v[72:75], v[124:139]
  ds_read_b128 v[52:55], v28 offset:36864
  ds_read_b128 v[56:59], v28 offset:40960
  v_mfma_f32_32x32x16_bf16 v[140:155], v[84:87], v[76:79], v[140:155]
  ds_read_b128 v[60:63], v28 offset:45056
  v_mfma_f32_32x32x16_bf16 v[156:171], v[84:87], v[80:83], v[156:171]
  v_mfma_f32_16x16x32_bf16 v[252:255], v[44:47], v[104:107], v[252:255]
  v_mfma_f32_32x32x16_bf16 v[108:123], v[104:107], v[88:91], v[108:123]
  ds_read_b128 v[68:71], v29 offset:32768
  ds_read_b64_tr_b16 v[84:85], v33 offset:34816
  s_add_u32 s64, s12, 0
  v_mov_b32 v14, s64
  s_lshl3_add_u32 s64, s17, s20
  s_lshl_b32 s64, s64, 7
  s_add_u32 s64, s64, 0xb00000
  s_waitcnt vmcnt(0)
  s_mov_b64 exec, 1
  buffer_store_dword v14, off, s[28:31], s64 sc1
  s_mov_b64 exec, -1
  v_mfma_f32_32x32x16_bf16 v[124:139], v[104:107], v[92:95], v[124:139]
  ds_read_b64_tr_b16 v[86:87], v33 offset:35328
  ds_read_b128 v[72:75], v29 offset:36864
  v_mfma_f32_32x32x16_bf16 v[140:155], v[104:107], v[96:99], v[140:155]
  ds_read_b128 v[76:79], v29 offset:40960
  ds_read_b128 v[80:83], v29 offset:45056
  v_mfma_f32_32x32x16_bf16 v[156:171], v[104:107], v[100:103], v[156:171]
  s_waitcnt lgkmcnt(9)
  v_mfma_f32_16x16x32_bf16 v[252:255], v[44:47], v[64:67], v[252:255]
  v_mfma_f32_32x32x16_bf16 v[108:123], v[64:67], v[48:51], v[108:123]
  ds_read_b128 v[88:91], v30 offset:32768
  ds_read_b64_tr_b16 v[104:105], v33 offset:36864
  s_waitcnt lgkmcnt(10)
  v_mfma_f32_32x32x16_bf16 v[124:139], v[64:67], v[52:55], v[124:139]
  ds_read_b64_tr_b16 v[106:107], v33 offset:37376
  ds_read_b128 v[92:95], v30 offset:36864
  s_waitcnt lgkmcnt(11)
  v_mfma_f32_32x32x16_bf16 v[140:155], v[64:67], v[56:59], v[140:155]
  ds_read_b128 v[96:99], v30 offset:40960
  ds_read_b128 v[100:103], v30 offset:45056
  s_waitcnt lgkmcnt(12)
  v_mfma_f32_32x32x16_bf16 v[156:171], v[64:67], v[60:63], v[156:171]
  s_waitcnt lgkmcnt(9)
  v_mfma_f32_16x16x32_bf16 v[252:255], v[44:47], v[84:87], v[252:255]
  v_mfma_f32_32x32x16_bf16 v[108:123], v[84:87], v[68:71], v[108:123]
  ds_read_b128 v[48:51], v31 offset:32768
  ds_read_b64_tr_b16 v[64:65], v33 offset:38912
  s_waitcnt lgkmcnt(10)
  v_mfma_f32_32x32x16_bf16 v[124:139], v[84:87], v[72:75], v[124:139]
  ds_read_b64_tr_b16 v[66:67], v33 offset:39424
  ds_read_b128 v[52:55], v31 offset:36864
  s_waitcnt lgkmcnt(11)
  v_mfma_f32_32x32x16_bf16 v[140:155], v[84:87], v[76:79], v[140:155]
  ds_read_b128 v[56:59], v31 offset:40960
  ds_read_b128 v[60:63], v31 offset:45056
  s_waitcnt lgkmcnt(12)
  v_mfma_f32_32x32x16_bf16 v[156:171], v[84:87], v[80:83], v[156:171]
  s_waitcnt lgkmcnt(9)
  v_mfma_f32_16x16x32_bf16 v[252:255], v[44:47], v[104:107], v[252:255]
  v_mfma_f32_32x32x16_bf16 v[108:123], v[104:107], v[88:91], v[108:123]
  s_waitcnt lgkmcnt(0)
  s_barrier
  ds_read_b128 v[68:71], v24 offset:0
  ds_read_b64_tr_b16 v[84:85], v32 offset:0
  ds_read_b64_tr_b16 v[86:87], v32 offset:512
  v_mfma_f32_32x32x16_bf16 v[124:139], v[104:107], v[92:95], v[124:139]
  ds_read_b128 v[72:75], v24 offset:4096
  ds_read_b128 v[76:79], v24 offset:8192
  v_mfma_f32_32x32x16_bf16 v[140:155], v[104:107], v[96:99], v[140:155]
  ds_read_b128 v[80:83], v24 offset:12288
  v_mfma_f32_32x32x16_bf16 v[156:171], v[104:107], v[100:103], v[156:171]
  v_mfma_f32_16x16x32_bf16 v[252:255], v[44:47], v[64:67], v[252:255]
  v_mfma_f32_32x32x16_bf16 v[108:123], v[64:67], v[48:51], v[108:123]
  ds_read_b128 v[88:91], v25 offset:0
  ds_read_b64_tr_b16 v[104:105], v32 offset:2048
  v_mfma_f32_32x32x16_bf16 v[124:139], v[64:67], v[52:55], v[124:139]
  ds_read_b64_tr_b16 v[106:107], v32 offset:2560
  ds_read_b128 v[92:95], v25 offset:4096
  v_mfma_f32_32x32x16_bf16 v[140:155], v[64:67], v[56:59], v[140:155]
  ds_read_b128 v[96:99], v25 offset:8192
  ds_read_b128 v[100:103], v25 offset:12288
  v_mfma_f32_32x32x16_bf16 v[156:171], v[64:67], v[60:63], v[156:171]
  s_waitcnt lgkmcnt(9)
  v_mfma_f32_16x16x32_bf16 v[252:255], v[44:47], v[84:87], v[252:255]
  v_mfma_f32_32x32x16_bf16 v[108:123], v[84:87], v[68:71], v[108:123]
  ds_read_b128 v[48:51], v26 offset:0
  ds_read_b64_tr_b16 v[64:65], v32 offset:4096
  buffer_load_dwordx4 v[8:11], v6, s[56:59], 0 offen
  s_waitcnt lgkmcnt(10)
  v_mfma_f32_32x32x16_bf16 v[124:139], v[84:87], v[72:75], v[124:139]
  ds_read_b64_tr_b16 v[66:67], v32 offset:4608
  ds_read_b128 v[52:55], v26 offset:4096
  s_waitcnt lgkmcnt(11)
  v_mfma_f32_32x32x16_bf16 v[140:155], v[84:87], v[76:79], v[140:155]
  ds_read_b128 v[56:59], v26 offset:8192
  ds_read_b128 v[60:63], v26 offset:12288
  s_waitcnt lgkmcnt(12)
  v_mfma_f32_32x32x16_bf16 v[156:171], v[84:87], v[80:83], v[156:171]
  s_waitcnt lgkmcnt(9)
  v_mfma_f32_16x16x32_bf16 v[252:255], v[44:47], v[104:107], v[252:255]
  v_mfma_f32_32x32x16_bf16 v[108:123], v[104:107], v[88:91], v[108:123]
  ds_read_b128 v[68:71], v27 offset:0
  ds_read_b64_tr_b16 v[84:85], v32 offset:6144
  s_waitcnt lgkmcnt(10)
  v_mfma_f32_32x32x16_bf16 v[124:139], v[104:107], v[92:95], v[124:139]
  ds_read_b64_tr_b16 v[86:87], v32 offset:6656
  ds_read_b128 v[72:75], v27 offset:4096
  s_waitcnt lgkmcnt(11)
  v_mfma_f32_32x32x16_bf16 v[140:155], v[104:107], v[96:99], v[140:155]
  ds_read_b128 v[76:79], v27 offset:8192
  ds_read_b128 v[80:83], v27 offset:12288
  s_waitcnt lgkmcnt(12)
  v_mfma_f32_32x32x16_bf16 v[156:171], v[104:107], v[100:103], v[156:171]
  s_waitcnt lgkmcnt(9)
  v_mfma_f32_16x16x32_bf16 v[252:255], v[44:47], v[64:67], v[252:255]
  v_mfma_f32_32x32x16_bf16 v[108:123], v[64:67], v[48:51], v[108:123]
  s_waitcnt lgkmcnt(0)
  s_barrier
  ds_read_b128 v[88:91], v24 offset:32768
  ds_read_b64_tr_b16 v[104:105], v32 offset:32768
  ds_read_b64_tr_b16 v[106:107], v32 offset:33280
  v_mfma_f32_32x32x16_bf16 v[124:139], v[64:67], v[52:55], v[124:139]
  ds_read_b128 v[92:95], v24 offset:36864
  ds_read_b128 v[96:99], v24 offset:40960
  v_mfma_f32_32x32x16_bf16 v[140:155], v[64:67], v[56:59], v[140:155]
  ds_read_b128 v[100:103], v24 offset:45056
  v_mfma_f32_32x32x16_bf16 v[156:171], v[64:67], v[60:63], v[156:171]
  v_mfma_f32_16x16x32_bf16 v[252:255], v[44:47], v[84:87], v[252:255]
  v_mfma_f32_32x32x16_bf16 v[108:123], v[84:87], v[68:71], v[108:123]
  ds_read_b128 v[48:51], v25 offset:32768
  ds_read_b64_tr_b16 v[64:65], v32 offset:34816
  v_mfma_f32_32x32x16_bf16 v[124:139], v[84:87], v[72:75], v[124:139]
  ds_read_b64_tr_b16 v[66:67], v32 offset:35328
  ds_read_b128 v[52:55], v25 offset:36864
  v_mfma_f32_32x32x16_bf16 v[140:155], v[84:87], v[76:79], v[140:155]
  ds_read_b128 v[56:59], v25 offset:40960
  ds_read_b128 v[60:63], v25 offset:45056
  v_mfma_f32_32x32x16_bf16 v[156:171], v[84:87], v[80:83], v[156:171]
  s_waitcnt lgkmcnt(9)
  v_mfma_f32_16x16x32_bf16 v[252:255], v[44:47], v[104:107], v[252:255]
  v_mfma_f32_32x32x16_bf16 v[108:123], v[104:107], v[88:91], v[108:123]
  ds_read_b128 v[68:71], v26 offset:32768
  ds_read_b64_tr_b16 v[84:85], v32 offset:36864
  s_waitcnt lgkmcnt(10)
  v_mfma_f32_32x32x16_bf16 v[124:139], v[104:107], v[92:95], v[124:139]
  ds_read_b64_tr_b16 v[86:87], v32 offset:37376
  ds_read_b128 v[72:75], v26 offset:36864
  s_waitcnt lgkmcnt(11)
  v_mfma_f32_32x32x16_bf16 v[140:155], v[104:107], v[96:99], v[140:155]
  ds_read_b128 v[76:79], v26 offset:40960
  ds_read_b128 v[80:83], v26 offset:45056
  s_waitcnt lgkmcnt(12)
  v_mfma_f32_32x32x16_bf16 v[156:171], v[104:107], v[100:103], v[156:171]
  s_waitcnt lgkmcnt(9)
  v_mfma_f32_16x16x32_bf16 v[252:255], v[44:47], v[64:67], v[252:255]
  v_mfma_f32_32x32x16_bf16 v[108:123], v[64:67], v[48:51], v[108:123]
  ds_read_b128 v[88:91], v27 offset:32768
  ds_read_b64_tr_b16 v[104:105], v32 offset:38912
  s_waitcnt lgkmcnt(10)
  v_mfma_f32_32x32x16_bf16 v[124:139], v[64:67], v[52:55], v[124:139]
  ds_read_b64_tr_b16 v[106:107], v32 offset:39424
  ds_read_b128 v[92:95], v27 offset:36864
  s_waitcnt lgkmcnt(11)
  v_mfma_f32_32x32x16_bf16 v[140:155], v[64:67], v[56:59], v[140:155]
  ds_read_b128 v[96:99], v27 offset:40960
  ds_read_b128 v[100:103], v27 offset:45056
  s_waitcnt lgkmcnt(12)
  v_mfma_f32_32x32x16_bf16 v[156:171], v[64:67], v[60:63], v[156:171]
  s_waitcnt lgkmcnt(9)
  v_mfma_f32_16x16x32_bf16 v[252:255], v[44:47], v[84:87], v[252:255]
  v_mfma_f32_32x32x16_bf16 v[108:123], v[84:87], v[68:71], v[108:123]
  s_waitcnt lgkmcnt(0)
  s_barrier
  ds_read_b128 v[48:51], v28 offset:0
  ds_read_b64_tr_b16 v[64:65], v33 offset:0
  ds_read_b64_tr_b16 v[66:67], v33 offset:512
  v_mfma_f32_32x32x16_bf16 v[124:139], v[84:87], v[72:75], v[124:139]
  ds_read_b128 v[52:55], v28 offset:4096
  ds_read_b128 v[56:59], v28 offset:8192
  v_mfma_f32_32x32x16_bf16 v[140:155], v[84:87], v[76:79], v[140:155]
  ds_read_b128 v[60:63], v28 offset:12288
  v_mfma_f32_32x32x16_bf16 v[156:171], v[84:87], v[80:83], v[156:171]
  v_mfma_f32_16x16x32_bf16 v[252:255], v[44:47], v[104:107], v[252:255]
  v_mfma_f32_32x32x16_bf16 v[108:123], v[104:107], v[88:91], v[108:123]
  ds_read_b128 v[68:71], v29 offset:0
  ds_read_b64_tr_b16 v[84:85], v33 offset:2048
  v_mfma_f32_32x32x16_bf16 v[124:139], v[104:107], v[92:95], v[124:139]
  ds_read_b64_tr_b16 v[86:87], v33 offset:2560
  ds_read_b128 v[72:75], v29 offset:4096
  v_mfma_f32_32x32x16_bf16 v[140:155], v[104:107], v[96:99], v[140:155]
  ds_read_b128 v[76:79], v29 offset:8192
  ds_read_b128 v[80:83], v29 offset:12288
  v_mfma_f32_32x32x16_bf16 v[156:171], v[104:107], v[100:103], v[156:171]
  s_waitcnt lgkmcnt(9)
  v_mfma_f32_16x16x32_bf16 v[252:255], v[44:47], v[64:67], v[252:255]
  v_mfma_f32_32x32x16_bf16 v[108:123], v[64:67], v[48:51], v[108:123]
  ds_read_b128 v[88:91], v30 offset:0
  ds_read_b64_tr_b16 v[104:105], v33 offset:4096
  s_waitcnt lgkmcnt(10)
  v_mfma_f32_32x32x16_bf16 v[124:139], v[64:67], v[52:55], v[124:139]
  ds_read_b64_tr_b16 v[106:107], v33 offset:4608
  ds_read_b128 v[92:95], v30 offset:4096
  s_waitcnt lgkmcnt(11)
  v_mfma_f32_32x32x16_bf16 v[140:155], v[64:67], v[56:59], v[140:155]
  ds_read_b128 v[96:99], v30 offset:8192
  ds_read_b128 v[100:103], v30 offset:12288
  s_waitcnt lgkmcnt(12)
  v_mfma_f32_32x32x16_bf16 v[156:171], v[64:67], v[60:63], v[156:171]
  s_waitcnt lgkmcnt(9)
  v_mfma_f32_16x16x32_bf16 v[252:255], v[44:47], v[84:87], v[252:255]
  v_mfma_f32_32x32x16_bf16 v[108:123], v[84:87], v[68:71], v[108:123]
  ds_read_b128 v[48:51], v31 offset:0
  ds_read_b64_tr_b16 v[64:65], v33 offset:6144
  s_waitcnt lgkmcnt(10)
  v_mfma_f32_32x32x16_bf16 v[124:139], v[84:87], v[72:75], v[124:139]
  ds_read_b64_tr_b16 v[66:67], v33 offset:6656
  ds_read_b128 v[52:55], v31 offset:4096
  s_waitcnt lgkmcnt(11)
  v_mfma_f32_32x32x16_bf16 v[140:155], v[84:87], v[76:79], v[140:155]
  ds_read_b128 v[56:59], v31 offset:8192
  ds_read_b128 v[60:63], v31 offset:12288
  s_waitcnt lgkmcnt(12)
  v_mfma_f32_32x32x16_bf16 v[156:171], v[84:87], v[80:83], v[156:171]
  s_waitcnt lgkmcnt(9)
  v_mfma_f32_16x16x32_bf16 v[252:255], v[44:47], v[104:107], v[252:255]
  v_mfma_f32_32x32x16_bf16 v[108:123], v[104:107], v[88:91], v[108:123]
  s_waitcnt lgkmcnt(0)
  s_barrier
  ds_read_b128 v[68:71], v28 offset:32768
  ds_read_b64_tr_b16 v[84:85], v33 offset:32768
  ds_read_b64_tr_b16 v[86:87], v33 offset:33280
  v_mfma_f32_32x32x16_bf16 v[124:139], v[104:107], v[92:95], v[124:139]
  ds_read_b128 v[72:75], v28 offset:36864
  ds_read_b128 v[76:79], v28 offset:40960
  v_mfma_f32_32x32x16_bf16 v[140:155], v[104:107], v[96:99], v[140:155]
  ds_read_b128 v[80:83], v28 offset:45056
  v_mfma_f32_32x32x16_bf16 v[156:171], v[104:107], v[100:103], v[156:171]
  v_mfma_f32_16x16x32_bf16 v[252:255], v[44:47], v[64:67], v[252:255]
  v_mfma_f32_32x32x16_bf16 v[108:123], v[64:67], v[48:51], v[108:123]
  ds_read_b128 v[88:91], v29 offset:32768
  ds_read_b64_tr_b16 v[104:105], v33 offset:34816
  v_mfma_f32_32x32x16_bf16 v[124:139], v[64:67], v[52:55], v[124:139]
  ds_read_b64_tr_b16 v[106:107], v33 offset:35328
  ds_read_b128 v[92:95], v29 offset:36864
  v_mfma_f32_32x32x16_bf16 v[140:155], v[64:67], v[56:59], v[140:155]
  ds_read_b128 v[96:99], v29 offset:40960
  ds_read_b128 v[100:103], v29 offset:45056
  v_mfma_f32_32x32x16_bf16 v[156:171], v[64:67], v[60:63], v[156:171]
  s_waitcnt lgkmcnt(9)
  v_mfma_f32_16x16x32_bf16 v[252:255], v[44:47], v[84:87], v[252:255]
  v_mfma_f32_32x32x16_bf16 v[108:123], v[84:87], v[68:71], v[108:123]
  ds_read_b128 v[48:51], v30 offset:32768
  ds_read_b64_tr_b16 v[64:65], v33 offset:36864
  s_waitcnt lgkmcnt(10)
  v_mfma_f32_32x32x16_bf16 v[124:139], v[84:87], v[72:75], v[124:139]
  ds_read_b64_tr_b16 v[66:67], v33 offset:37376
  ds_read_b128 v[52:55], v30 offset:36864
  s_waitcnt lgkmcnt(11)
  v_mfma_f32_32x32x16_bf16 v[140:155], v[84:87], v[76:79], v[140:155]
  ds_read_b128 v[56:59], v30 offset:40960
  ds_read_b128 v[60:63], v30 offset:45056
  s_waitcnt lgkmcnt(12)
  v_mfma_f32_32x32x16_bf16 v[156:171], v[84:87], v[80:83], v[156:171]
  s_waitcnt lgkmcnt(9)
  v_mfma_f32_16x16x32_bf16 v[252:255], v[44:47], v[104:107], v[252:255]
  v_mfma_f32_32x32x16_bf16 v[108:123], v[104:107], v[88:91], v[108:123]
  ds_read_b128 v[68:71], v31 offset:32768
  ds_read_b64_tr_b16 v[84:85], v33 offset:38912
  s_waitcnt lgkmcnt(10)
  v_mfma_f32_32x32x16_bf16 v[124:139], v[104:107], v[92:95], v[124:139]
  ds_read_b64_tr_b16 v[86:87], v33 offset:39424
  ds_read_b128 v[72:75], v31 offset:36864
  s_waitcnt lgkmcnt(11)
  v_mfma_f32_32x32x16_bf16 v[140:155], v[104:107], v[96:99], v[140:155]
  ds_read_b128 v[76:79], v31 offset:40960
  ds_read_b128 v[80:83], v31 offset:45056
  s_waitcnt lgkmcnt(12)
  v_mfma_f32_32x32x16_bf16 v[156:171], v[104:107], v[100:103], v[156:171]
  s_waitcnt lgkmcnt(9)
  v_mfma_f32_16x16x32_bf16 v[252:255], v[44:47], v[64:67], v[252:255]
  v_mfma_f32_32x32x16_bf16 v[108:123], v[64:67], v[48:51], v[108:123]
  s_waitcnt lgkmcnt(0)
  s_barrier
  ds_read_b32 v96, v34 offset:0
  ds_read_b32 v97, v34 offset:128
  ds_read_b32 v98, v34 offset:256
  ds_read_b32 v99, v34 offset:384
  v_mfma_f32_32x32x16_bf16 v[124:139], v[64:67], v[52:55], v[124:139]
  v_lshrrev_b32 v12, 3, v1
  v_and_b32 v12, 4, v12
  v_xor_b32 v12, v12, v1
  v_and_b32 v12, 30, v12
  v_and_b32 v13, 1, v1
  v_mfma_f32_32x32x16_bf16 v[140:155], v[64:67], v[56:59], v[140:155]
  v_lshlrev_b32 v13, 4, v13
  s_waitcnt lgkmcnt(3)
  v_lshlrev_b32 v89, 16, v96
  v_rcp_f32 v104, v89
  v_perm_b32 v88, v96, v96, s15
  v_mul_f32 v100, 0x3fb8aa3b, v104
  v_mfma_f32_32x32x16_bf16 v[156:171], v[64:67], v[60:63], v[156:171]
  s_waitcnt lgkmcnt(2)
  v_lshlrev_b32 v91, 16, v97
  v_rcp_f32 v105, v91
  v_perm_b32 v90, v97, v97, s15
  v_mul_f32 v101, 0x3fb8aa3b, v105
  s_waitcnt lgkmcnt(1)
  v_lshlrev_b32 v93, 16, v98
  v_mfma_f32_16x16x32_bf16 v[252:255], v[44:47], v[84:87], v[252:255]
  v_mfma_f32_32x32x16_bf16 v[108:123], v[84:87], v[68:71], v[108:123]
  v_rcp_f32 v106, v93
  v_perm_b32 v92, v98, v98, s15
  v_mul_f32 v102, 0x3fb8aa3b, v106
  s_waitcnt lgkmcnt(0)
  v_lshlrev_b32 v95, 16, v99
  v_rcp_f32 v107, v95
  v_mfma_f32_32x32x16_bf16 v[124:139], v[84:87], v[72:75], v[124:139]
  v_cvt_pk_bf16_f32 v253, v252, v252
  v_and_b32 v253, 0xffff0000, v253
  v_sub_f32 v252, v252, v253
  v_cvt_pk_bf16_f32 v20, v253, v252
  v_perm_b32 v94, v99, v99, s15
  v_mfma_f32_32x32x16_bf16 v[140:155], v[84:87], v[76:79], v[140:155]
  v_mul_f32 v103, 0x3fb8aa3b, v107
  v_mov_b32 v14, 0x3f80
  v_lshlrev_b32 v13, v13, v14
  v_cmp_eq_u32 vcc, 0, v12
  s_nop 1
  v_cndmask_b32 v28, 0, v13, vcc
  v_mfma_f32_32x32x16_bf16 v[156:171], v[84:87], v[80:83], v[156:171]
  v_cmp_eq_u32 vcc, 2, v12
  s_nop 1
  v_cndmask_b32 v29, 0, v13, vcc
  v_cmp_eq_u32 vcc, 8, v12
  s_nop 1
  v_cndmask_b32 v30, 0, v13, vcc
  v_cmp_eq_u32 vcc, 10, v12
  v_mfma_f32_32x32x16_bf16 v[108:123], v[20:23], v[88:91], v[108:123]
  s_nop 0
  v_cndmask_b32 v31, 0, v13, vcc
  v_cmp_eq_u32 vcc, 16, v12
  s_nop 1
  v_cndmask_b32 v24, 0, v13, vcc
  v_cmp_eq_u32 vcc, 18, v12
  s_nop 1
  v_cndmask_b32 v25, 0, v13, vcc
  v_mfma_f32_32x32x16_bf16 v[124:139], v[20:23], v[90:93], v[124:139]
  v_cmp_eq_u32 vcc, 24, v12
  s_nop 1
  v_cndmask_b32 v26, 0, v13, vcc
  v_cmp_eq_u32 vcc, 26, v12
  s_nop 1
  v_cndmask_b32 v27, 0, v13, vcc
  v_mfma_f32_32x32x16_bf16 v[140:155], v[20:23], v[92:95], v[140:155]
  v_mfma_f32_32x32x16_bf16 v[156:171], v[20:23], v[94:97], v[156:171]
  s_setprio 0
  s_setprio 3
  v_cvt_pk_bf16_f32 v236, v108, v109
  v_cvt_pk_bf16_f32 v237, v110, v111
  v_cvt_pk_bf16_f32 v238, v112, v113
  v_cvt_pk_bf16_f32 v239, v114, v115
  s_nop 1
  v_mfma_f32_32x32x16_bf16 v[172:187], v[40:43], v[236:239], 0
  ds_read_b64_tr_b16 v[48:49], v35 offset:0
  ds_read_b64_tr_b16 v[50:51], v35 offset:640
  ds_read_b64_tr_b16 v[52:53], v35 offset:2560
  ds_read_b64_tr_b16 v[54:55], v35 offset:3200
  v_cvt_pk_bf16_f32 v240, v124, v125
  v_cvt_pk_bf16_f32 v241, v126, v127
  v_cvt_pk_bf16_f32 v242, v128, v129
  v_cvt_pk_bf16_f32 v243, v130, v131
  s_nop 1
  v_mfma_f32_32x32x16_bf16 v[188:203], v[40:43], v[240:243], 0
  ds_read_b64_tr_b16 v[56:57], v35 offset:5120
  ds_read_b64_tr_b16 v[58:59], v35 offset:5760
  ds_read_b64_tr_b16 v[60:61], v35 offset:7680
  ds_read_b64_tr_b16 v[62:63], v35 offset:8320
  v_cvt_pk_bf16_f32 v244, v140, v141
  v_cvt_pk_bf16_f32 v245, v142, v143
  v_cvt_pk_bf16_f32 v246, v144, v145
  v_cvt_pk_bf16_f32 v247, v146, v147
  s_nop 1
  v_mfma_f32_32x32x16_bf16 v[204:219], v[40:43], v[244:247], 0
  ds_read_b64_tr_b16 v[64:65], v36 offset:128
  ds_read_b64_tr_b16 v[66:67], v36 offset:768
  ds_read_b64_tr_b16 v[68:69], v36 offset:2688
  ds_read_b64_tr_b16 v[70:71], v36 offset:3328
  v_cvt_pk_bf16_f32 v248, v156, v157
  v_cvt_pk_bf16_f32 v249, v158, v159
  v_cvt_pk_bf16_f32 v250, v160, v161
  v_cvt_pk_bf16_f32 v251, v162, v163
  s_nop 1
  v_mfma_f32_32x32x16_bf16 v[220:235], v[40:43], v[248:251], 0
  ds_read_b64_tr_b16 v[72:73], v36 offset:5248
  ds_read_b64_tr_b16 v[74:75], v36 offset:5888
  ds_read_b64_tr_b16 v[76:77], v36 offset:7808
  ds_read_b64_tr_b16 v[78:79], v36 offset:8448
  s_setprio 0
  v_mov_b32 v12, 1
  ds_write_b32 v16, v12 offset:2048
  v_mul_f32 v116, v104, v116
  v_mul_f32 v117, v104, v117
  v_mul_f32 v118, v104, v118
  v_mul_f32 v119, v104, v119
  v_mul_f32 v120, v104, v120
  v_mul_f32 v121, v104, v121
  v_mul_f32 v122, v104, v122
  v_mul_f32 v123, v104, v123
  v_cvt_pk_bf16_f32 v116, v116, v117
  v_cvt_pk_bf16_f32 v117, v118, v119
  v_cvt_pk_bf16_f32 v118, v120, v121
  v_cvt_pk_bf16_f32 v119, v122, v123
  v_max3_f32 v12, v172, v173, v174
  v_max3_f32 v13, v175, v176, v177
  v_max3_f32 v12, v12, v178, v179
  v_max3_f32 v13, v13, v180, v181
  s_setprio 3
  s_waitcnt lgkmcnt(15)
  v_mfma_f32_16x16x32_bf16 v[80:83], v[44:47], v[48:51], 0
  s_waitcnt lgkmcnt(7)
  v_mfma_f32_16x16x32_bf16 v[84:87], v[44:47], v[64:67], 0
  v_mfma_f32_16x16x32_bf16 v[80:83], v[44:47], v[52:55], v[80:83]
  s_waitcnt lgkmcnt(5)
  v_mfma_f32_16x16x32_bf16 v[84:87], v[44:47], v[68:71], v[84:87]
  v_mfma_f32_16x16x32_bf16 v[80:83], v[44:47], v[56:59], v[80:83]
  s_waitcnt lgkmcnt(3)
  v_mfma_f32_16x16x32_bf16 v[84:87], v[44:47], v[72:75], v[84:87]
  v_mfma_f32_16x16x32_bf16 v[80:83], v[44:47], v[60:63], v[80:83]
  s_waitcnt lgkmcnt(1)
  v_mfma_f32_16x16x32_bf16 v[84:87], v[44:47], v[76:79], v[84:87]
  s_setprio 0
  v_max3_f32 v12, v12, v182, v183
  v_max3_f32 v13, v13, v184, v185
  v_max3_f32 v12, v12, v186, v187
  v_max_f32 v12, v12, v13
  v_mul_f32 v12, v100, v12
  v_fma_f32 v172, v172, v100, -v12
  s_cmp_gt_u32 s27, 0
  s_cbranch_scc1 pv47
  v_lshlrev_b32 v40, 10, v1
  buffer_load_dwordx2 v[40:41], v40, s[36:39], s0 offen offset:444
pv47:
  v_fma_f32 v173, v173, v100, -v12
  v_fma_f32 v174, v174, v100, -v12
  v_fma_f32 v175, v175, v100, -v12
  v_fma_f32 v176, v176, v100, -v12
  v_fma_f32 v177, v177, v100, -v12
  v_fma_f32 v178, v178, v100, -v12
  v_fma_f32 v179, v179, v100, -v12
  v_fma_f32 v180, v180, v100, -v12
  v_fma_f32 v181, v181, v100, -v12
  v_fma_f32 v182, v182, v100, -v12
  v_fma_f32 v183, v183, v100, -v12
  v_fma_f32 v184, v184, v100, -v12
  v_fma_f32 v185, v185, v100, -v12
  v_fma_f32 v186, v186, v100, -v12
  v_fma_f32 v187, v187, v100, -v12
  v_exp_f32 v172, v172
  s_lshl_b32 s64, s27, 11
  s_add_u32 s8, s64, s11
  s_add_u32 s9, s11, 8192
  v_mov_b32 v81, s12
  v_mov_b32 v85, s12
  s_mov_b32 exec_hi, 0
  buffer_store_dwordx2 v[80:81], v38, s[28:31], s8 offen sc1
  buffer_store_dwordx2 v[84:85], v38, s[28:31], s9 offen sc1
  s_mov_b64 exec, -1
  s_mov_b32 vcc_lo, 0xffff0000
  s_mov_b32 vcc_hi, 0xffff0000
  v_cndmask_b32_e64 v48, 0, 1.0, vcc
  v_cndmask_b32_e64 v49, 0, 1.0, vcc
  v_cndmask_b32_e64 v50, 0, 1.0, vcc
  v_cndmask_b32_e64 v51, 0, 1.0, vcc
  v_cndmask_b32_e64 v52, 0, 1.0, vcc
  v_cndmask_b32_e64 v53, 0, 1.0, vcc
  v_cndmask_b32_e64 v54, 0, 1.0, vcc
  v_cndmask_b32_e64 v55, 0, 1.0, vcc
  v_cndmask_b32_e64 v56, 0, 1.0, vcc
  v_cndmask_b32_e64 v57, 0, 1.0, vcc
  v_cndmask_b32_e64 v58, 0, 1.0, vcc
  v_cndmask_b32_e64 v59, 0, 1.0, vcc
  v_cndmask_b32_e64 v60, 0, 1.0, vcc
  v_cndmask_b32_e64 v61, 0, 1.0, vcc
  v_cndmask_b32_e64 v62, 0, 1.0, vcc
  v_cndmask_b32_e64 v63, 0, 1.0, vcc
  v_exp_f32 v173, v173
  v_exp_f32 v174, v174
  v_exp_f32 v175, v175
  v_exp_f32 v176, v176
  v_exp_f32 v177, v177
  v_exp_f32 v178, v178
  v_exp_f32 v179, v179
  v_exp_f32 v180, v180
  s_setprio 3
  v_mfma_f32_32x32x16_bf16 v[64:79], v[116:119], v[28:31], v[48:63]
  s_setprio 0
  v_exp_f32 v181, v181
  v_exp_f32 v182, v182
  v_exp_f32 v183, v183
  v_exp_f32 v184, v184
  v_exp_f32 v185, v185
  v_exp_f32 v186, v186
  v_exp_f32 v187, v187
  v_add_f32 v12, v172, v173
  v_add_f32 v13, v174, v175
  v_add_f32 v12, v12, v176
  v_add_f32 v13, v13, v177
  v_add_f32 v12, v12, v178
  v_add_f32 v13, v13, v179
  v_add_f32 v12, v12, v180
  v_add_f32 v13, v13, v181
  v_add_f32 v12, v12, v182
  v_add_f32 v13, v13, v183
  v_add_f32 v12, v12, v184
  v_add_f32 v13, v13, v185
  v_add_f32 v12, v12, v186
  v_add_f32 v13, v13, v187
  v_add_f32 v12, v12, v13
  v_cvt_pk_bf16_f32 v116, v64, v65
  v_cvt_pk_bf16_f32 v117, v66, v67
  v_cvt_pk_bf16_f32 v118, v68, v69
  v_cvt_pk_bf16_f32 v119, v70, v71
  v_cvt_pk_bf16_f32 v120, v72, v73
  v_cvt_pk_bf16_f32 v121, v74, v75
  v_cvt_pk_bf16_f32 v122, v76, v77
  v_cvt_pk_bf16_f32 v123, v78, v79
  v_rcp_f32 v12, v12
  s_nop 0
  v_mul_f32 v172, v172, v12
  v_mul_f32 v173, v173, v12
  v_mul_f32 v174, v174, v12
  v_mul_f32 v175, v175, v12
  v_mul_f32 v176, v176, v12
  v_mul_f32 v177, v177, v12
  v_mul_f32 v178, v178, v12
  v_mul_f32 v179, v179, v12
  v_mul_f32 v180, v180, v12
  v_mul_f32 v181, v181, v12
  v_mul_f32 v182, v182, v12
  v_mul_f32 v183, v183, v12
  v_mul_f32 v184, v184, v12
  v_mul_f32 v185, v185, v12
  v_mul_f32 v186, v186, v12
  v_mul_f32 v187, v187, v12
  v_cvt_pk_bf16_f32 v108, v172, v173
  v_cvt_pk_bf16_f32 v109, v174, v175
  v_cvt_pk_bf16_f32 v110, v176, v177
  v_cvt_pk_bf16_f32 v111, v178, v179
  v_cvt_pk_bf16_f32 v112, v180, v181
  v_cvt_pk_bf16_f32 v113, v182, v183
  v_cvt_pk_bf16_f32 v114, v184, v185
  v_cvt_pk_bf16_f32 v115, v186, v187
  s_setprio 3
  v_mfma_f32_32x32x16_bf16 v[172:187], v[108:111], v[28:31], 0
  v_mfma_f32_32x32x16_bf16 v[172:187], v[112:115], v[24:27], v[172:187]
  s_setprio 0
  v_mul_f32 v132, v105, v132
  v_mul_f32 v133, v105, v133
  v_mul_f32 v134, v105, v134
  v_mul_f32 v135, v105, v135
  v_mul_f32 v136, v105, v136
  v_mul_f32 v137, v105, v137
  v_mul_f32 v138, v105, v138
  v_mul_f32 v139, v105, v139
  v_cvt_pk_bf16_f32 v132, v132, v133
  v_cvt_pk_bf16_f32 v133, v134, v135
  v_cvt_pk_bf16_f32 v134, v136, v137
  v_cvt_pk_bf16_f32 v135, v138, v139
  v_max3_f32 v12, v188, v189, v190
  v_max3_f32 v13, v191, v192, v193
  v_max3_f32 v12, v12, v194, v195
  v_max3_f32 v13, v13, v196, v197
  s_setprio 3
  v_mfma_f32_32x32x16_bf16 v[64:79], v[132:135], v[28:31], v[48:63]
  s_setprio 0
  v_max3_f32 v12, v12, v198, v199
  v_max3_f32 v13, v13, v200, v201
  v_max3_f32 v12, v12, v202, v203
  v_max_f32 v12, v12, v13
  v_mul_f32 v12, v101, v12
  v_fma_f32 v188, v188, v101, -v12
  v_fma_f32 v189, v189, v101, -v12
  v_fma_f32 v190, v190, v101, -v12
  v_fma_f32 v191, v191, v101, -v12
  v_fma_f32 v192, v192, v101, -v12
  v_fma_f32 v193, v193, v101, -v12
  v_fma_f32 v194, v194, v101, -v12
  v_cvt_pk_bf16_f32 v108, v172, v173
  v_cvt_pk_bf16_f32 v109, v174, v175
  v_cvt_pk_bf16_f32 v110, v176, v177
  v_cvt_pk_bf16_f32 v111, v178, v179
  v_cvt_pk_bf16_f32 v112, v180, v181
  v_cvt_pk_bf16_f32 v113, v182, v183
  v_cvt_pk_bf16_f32 v114, v184, v185
  v_cvt_pk_bf16_f32 v115, v186, v187
  v_fma_f32 v195, v195, v101, -v12
  v_fma_f32 v196, v196, v101, -v12
  v_fma_f32 v197, v197, v101, -v12
  v_fma_f32 v198, v198, v101, -v12
  v_fma_f32 v199, v199, v101, -v12
  v_fma_f32 v200, v200, v101, -v12
  s_setprio 3
  v_mfma_f32_32x32x16_bf16 v[236:251], v[108:111], v[116:119], 0
  s_setprio 0
  v_fma_f32 v201, v201, v101, -v12
  v_fma_f32 v202, v202, v101, -v12
  v_fma_f32 v203, v203, v101, -v12
  v_exp_f32 v188, v188
  v_exp_f32 v189, v189
  v_exp_f32 v190, v190
  v_exp_f32 v191, v191
  v_exp_f32 v192, v192
  s_setprio 3
  v_mfma_f32_32x32x16_bf16 v[236:251], v[112:115], v[120:123], v[236:251]
  s_setprio 0
  v_exp_f32 v193, v193
  v_exp_f32 v194, v194
  v_exp_f32 v195, v195
  v_exp_f32 v196, v196
  v_exp_f32 v197, v197
  v_exp_f32 v198, v198
  v_exp_f32 v199, v199
  v_exp_f32 v200, v200
  v_exp_f32 v201, v201
  v_exp_f32 v202, v202
  v_cvt_pk_bf16_f32 v132, v64, v65
  v_cvt_pk_bf16_f32 v133, v66, v67
  v_cvt_pk_bf16_f32 v134, v68, v69
  v_cvt_pk_bf16_f32 v135, v70, v71
  v_cvt_pk_bf16_f32 v136, v72, v73
  v_cvt_pk_bf16_f32 v137, v74, v75
  v_cvt_pk_bf16_f32 v138, v76, v77
  v_cvt_pk_bf16_f32 v139, v78, v79
  v_exp_f32 v203, v203
  v_add_f32 v12, v188, v189
  v_add_f32 v13, v190, v191
  v_add_f32 v12, v12, v192
  v_add_f32 v13, v13, v193
  v_add_f32 v12, v12, v194
  v_add_f32 v13, v13, v195
  v_add_f32 v12, v12, v196
  v_add_f32 v13, v13, v197
  v_add_f32 v12, v12, v198
  v_add_f32 v13, v13, v199
  v_add_f32 v12, v12, v200
  v_add_f32 v13, v13, v201
  v_add_f32 v12, v12, v202
  v_add_f32 v13, v13, v203
  v_add_f32 v12, v12, v13
  v_rcp_f32 v12, v12
  s_nop 0
  v_mul_f32 v188, v188, v12
  v_mul_f32 v189, v189, v12
  v_mul_f32 v190, v190, v12
  v_mul_f32 v191, v191, v12
  v_mul_f32 v192, v192, v12
  v_mul_f32 v193, v193, v12
  v_mul_f32 v194, v194, v12
  v_mul_f32 v195, v195, v12
  v_mul_f32 v196, v196, v12
  v_mul_f32 v197, v197, v12
  v_mul_f32 v198, v198, v12
  v_mul_f32 v199, v199, v12
  v_mul_f32 v200, v200, v12
  v_mul_f32 v201, v201, v12
  v_mul_f32 v202, v202, v12
  v_mul_f32 v203, v203, v12
  v_cvt_pk_bf16_f32 v124, v188, v189
  v_cvt_pk_bf16_f32 v125, v190, v191
  v_cvt_pk_bf16_f32 v126, v192, v193
  v_cvt_pk_bf16_f32 v127, v194, v195
  v_cvt_pk_bf16_f32 v128, v196, v197
  v_cvt_pk_bf16_f32 v129, v198, v199
  v_cvt_pk_bf16_f32 v130, v200, v201
  v_cvt_pk_bf16_f32 v131, v202, v203
  s_setprio 3
  v_mfma_f32_32x32x16_bf16 v[188:203], v[124:127], v[28:31], 0
  v_mfma_f32_32x32x16_bf16 v[188:203], v[128:131], v[24:27], v[188:203]
  s_setprio 0
  v_mul_f32 v148, v106, v148
  v_mul_f32 v149, v106, v149
  v_mul_f32 v150, v106, v150
  v_mul_f32 v151, v106, v151
  v_mul_f32 v152, v106, v152
  v_mul_f32 v153, v106, v153
  v_mul_f32 v154, v106, v154
  v_mul_f32 v155, v106, v155
  v_cvt_pk_bf16_f32 v148, v148, v149
  v_cvt_pk_bf16_f32 v149, v150, v151
  v_cvt_pk_bf16_f32 v150, v152, v153
  v_cvt_pk_bf16_f32 v151, v154, v155
  v_max3_f32 v12, v204, v205, v206
  v_max3_f32 v13, v207, v208, v209
  v_max3_f32 v12, v12, v210, v211
  v_max3_f32 v13, v13, v212, v213
  s_setprio 3
  v_mfma_f32_32x32x16_bf16 v[64:79], v[148:151], v[28:31], v[48:63]
  s_setprio 0
  v_max3_f32 v12, v12, v214, v215
  v_max3_f32 v13, v13, v216, v217
  v_max3_f32 v12, v12, v218, v219
  v_max_f32 v12, v12, v13
  v_mul_f32 v12, v102, v12
  v_fma_f32 v204, v204, v102, -v12
  v_fma_f32 v205, v205, v102, -v12
  v_fma_f32 v206, v206, v102, -v12
  v_fma_f32 v207, v207, v102, -v12
  v_fma_f32 v208, v208, v102, -v12
  v_fma_f32 v209, v209, v102, -v12
  v_fma_f32 v210, v210, v102, -v12
  v_cvt_pk_bf16_f32 v124, v188, v189
  v_cvt_pk_bf16_f32 v125, v190, v191
  v_cvt_pk_bf16_f32 v126, v192, v193
  v_cvt_pk_bf16_f32 v127, v194, v195
  v_cvt_pk_bf16_f32 v128, v196, v197
  v_cvt_pk_bf16_f32 v129, v198, v199
  v_cvt_pk_bf16_f32 v130, v200, v201
  v_cvt_pk_bf16_f32 v131, v202, v203
  v_fma_f32 v211, v211, v102, -v12
  v_fma_f32 v212, v212, v102, -v12
  v_fma_f32 v213, v213, v102, -v12
  v_fma_f32 v214, v214, v102, -v12
  v_fma_f32 v215, v215, v102, -v12
  v_fma_f32 v216, v216, v102, -v12
  s_setprio 3
  v_mfma_f32_32x32x16_bf16 v[236:251], v[124:127], v[132:135], v[236:251]
  s_setprio 0
  v_fma_f32 v217, v217, v102, -v12
  v_fma_f32 v218, v218, v102, -v12
  v_fma_f32 v219, v219, v102, -v12
  v_exp_f32 v204, v204
  v_exp_f32 v205, v205
  v_exp_f32 v206, v206
  v_exp_f32 v207, v207
  v_exp_f32 v208, v208
  s_setprio 3
  v_mfma_f32_32x32x16_bf16 v[236:251], v[128:131], v[136:139], v[236:251]
  s_setprio 0
  v_exp_f32 v209, v209
  v_exp_f32 v210, v210
  v_exp_f32 v211, v211
  v_exp_f32 v212, v212
  v_exp_f32 v213, v213
  v_exp_f32 v214, v214
  v_exp_f32 v215, v215
  v_exp_f32 v216, v216
  v_exp_f32 v217, v217
  v_exp_f32 v218, v218
  v_cvt_pk_bf16_f32 v148, v64, v65
  v_cvt_pk_bf16_f32 v149, v66, v67
  v_cvt_pk_bf16_f32 v150, v68, v69
  v_cvt_pk_bf16_f32 v151, v70, v71
  v_cvt_pk_bf16_f32 v152, v72, v73
  v_cvt_pk_bf16_f32 v153, v74, v75
  v_cvt_pk_bf16_f32 v154, v76, v77
  v_cvt_pk_bf16_f32 v155, v78, v79
  v_exp_f32 v219, v219
  v_add_f32 v12, v204, v205
  v_add_f32 v13, v206, v207
  v_add_f32 v12, v12, v208
  v_and_b32 v33, 31, v1
  v_lshlrev_b32 v33, 3, v33
  v_and_b32 v35, 32, v1
  v_lshl_add_u32 v33, v35, 5, v33
  buffer_load_dwordx2 v[172:173], v33, s[28:31], s8 offen offset:0 sc1
  buffer_load_dwordx2 v[174:175], v33, s[28:31], s8 offen offset:256 sc1
  buffer_load_dwordx2 v[176:177], v33, s[28:31], s8 offen offset:512 sc1
  buffer_load_dwordx2 v[178:179], v33, s[28:31], s8 offen offset:768 sc1
  buffer_load_dwordx2 v[180:181], v33, s[28:31], s9 offen offset:0 sc1
  buffer_load_dwordx2 v[182:183], v33, s[28:31], s9 offen offset:256 sc1
  buffer_load_dwordx2 v[184:185], v33, s[28:31], s9 offen offset:512 sc1
  buffer_load_dwordx2 v[186:187], v33, s[28:31], s9 offen offset:768 sc1
  v_add_f32 v13, v13, v209
  v_add_f32 v12, v12, v210
  v_add_f32 v13, v13, v211
  v_add_f32 v12, v12, v212
  v_add_f32 v13, v13, v213
  v_add_f32 v12, v12, v214
  v_add_f32 v13, v13, v215
  v_add_f32 v12, v12, v216
  v_add_f32 v13, v13, v217
  v_add_f32 v12, v12, v218
  v_add_f32 v13, v13, v219
  v_add_f32 v12, v12, v13
  v_rcp_f32 v12, v12
  s_nop 0
  v_mul_f32 v204, v204, v12
  v_mul_f32 v205, v205, v12
  v_mul_f32 v206, v206, v12
  v_mul_f32 v207, v207, v12
  v_mul_f32 v208, v208, v12
  v_mul_f32 v209, v209, v12
  v_mul_f32 v210, v210, v12
  v_mul_f32 v211, v211, v12
  v_mul_f32 v212, v212, v12
  v_mul_f32 v213, v213, v12
  v_mul_f32 v214, v214, v12
  v_mul_f32 v215, v215, v12
  v_mul_f32 v216, v216, v12
  v_mul_f32 v217, v217, v12
  v_mul_f32 v218, v218, v12
  v_mul_f32 v219, v219, v12
  v_cvt_pk_bf16_f32 v140, v204, v205
  v_cvt_pk_bf16_f32 v141, v206, v207
  v_cvt_pk_bf16_f32 v142, v208, v209
  v_cvt_pk_bf16_f32 v143, v210, v211
  v_cvt_pk_bf16_f32 v144, v212, v213
  v_cvt_pk_bf16_f32 v145, v214, v215
  v_cvt_pk_bf16_f32 v146, v216, v217
  v_cvt_pk_bf16_f32 v147, v218, v219
  s_setprio 3
  v_mfma_f32_32x32x16_bf16 v[204:219], v[140:143], v[28:31], 0
  v_mfma_f32_32x32x16_bf16 v[204:219], v[144:147], v[24:27], v[204:219]
  s_setprio 0
  v_mul_f32 v164, v107, v164
  v_mul_f32 v165, v107, v165
  v_mul_f32 v166, v107, v166
  v_mul_f32 v167, v107, v167
  v_mul_f32 v168, v107, v168
  v_mul_f32 v169, v107, v169
  v_mul_f32 v170, v107, v170
  v_mul_f32 v171, v107, v171
  v_cvt_pk_bf16_f32 v164, v164, v165
  v_cvt_pk_bf16_f32 v165, v166, v167
  v_cvt_pk_bf16_f32 v166, v168, v169
  v_cvt_pk_bf16_f32 v167, v170, v171
  v_max3_f32 v12, v220, v221, v222
  v_max3_f32 v13, v223, v224, v225
  v_max3_f32 v12, v12, v226, v227
  v_max3_f32 v13, v13, v228, v229
  s_setprio 3
  v_mfma_f32_32x32x16_bf16 v[64:79], v[164:167], v[28:31], v[48:63]
  s_setprio 0
  v_max3_f32 v12, v12, v230, v231
  v_max3_f32 v13, v13, v232, v233
  v_max3_f32 v12, v12, v234, v235
  v_max_f32 v12, v12, v13
  v_mul_f32 v12, v103, v12
  v_fma_f32 v220, v220, v103, -v12
  v_fma_f32 v221, v221, v103, -v12
  v_fma_f32 v222, v222, v103, -v12
  v_fma_f32 v223, v223, v103, -v12
  v_fma_f32 v224, v224, v103, -v12
  v_fma_f32 v225, v225, v103, -v12
  v_fma_f32 v226, v226, v103, -v12
  v_cvt_pk_bf16_f32 v140, v204, v205
  v_cvt_pk_bf16_f32 v141, v206, v207
  v_cvt_pk_bf16_f32 v142, v208, v209
  v_cvt_pk_bf16_f32 v143, v210, v211
  v_cvt_pk_bf16_f32 v144, v212, v213
  v_cvt_pk_bf16_f32 v145, v214, v215
  v_cvt_pk_bf16_f32 v146, v216, v217
  v_cvt_pk_bf16_f32 v147, v218, v219
  v_fma_f32 v227, v227, v103, -v12
  v_fma_f32 v228, v228, v103, -v12
  v_fma_f32 v229, v229, v103, -v12
  v_fma_f32 v230, v230, v103, -v12
  v_fma_f32 v231, v231, v103, -v12
  v_fma_f32 v232, v232, v103, -v12
  s_setprio 3
  v_mfma_f32_32x32x16_bf16 v[236:251], v[140:143], v[148:151], v[236:251]
  s_setprio 0
  v_fma_f32 v233, v233, v103, -v12
  v_fma_f32 v234, v234, v103, -v12
  v_fma_f32 v235, v235, v103, -v12
  v_exp_f32 v220, v220
  v_exp_f32 v221, v221
  v_exp_f32 v222, v222
  v_exp_f32 v223, v223
  v_exp_f32 v224, v224
  s_setprio 3
  v_mfma_f32_32x32x16_bf16 v[236:251], v[144:147], v[152:155], v[236:251]
  s_setprio 0
  v_exp_f32 v225, v225
  v_exp_f32 v226, v226
  v_exp_f32 v227, v227
  v_exp_f32 v228, v228
  v_exp_f32 v229, v229
  v_exp_f32 v230, v230
  v_exp_f32 v231, v231
  v_exp_f32 v232, v232
  v_exp_f32 v233, v233
  v_exp_f32 v234, v234
  v_cvt_pk_bf16_f32 v164, v64, v65
  v_cvt_pk_bf16_f32 v165, v66, v67
  v_cvt_pk_bf16_f32 v166, v68, v69
  v_cvt_pk_bf16_f32 v167, v70, v71
  v_cvt_pk_bf16_f32 v168, v72, v73
  v_cvt_pk_bf16_f32 v169, v74, v75
  v_cvt_pk_bf16_f32 v170, v76, v77
  v_cvt_pk_bf16_f32 v171, v78, v79
  v_exp_f32 v235, v235
  v_add_f32 v12, v220, v221
  v_add_f32 v13, v222, v223
  v_add_f32 v12, v12, v224
  v_add_f32 v13, v13, v225
  v_add_f32 v12, v12, v226
  v_add_f32 v13, v13, v227
  v_add_f32 v12, v12, v228
  v_add_f32 v13, v13, v229
  v_add_f32 v12, v12, v230
  v_add_f32 v13, v13, v231
  v_add_f32 v12, v12, v232
  v_add_f32 v13, v13, v233
  v_add_f32 v12, v12, v234
  v_add_f32 v13, v13, v235
  v_add_f32 v12, v12, v13
  v_rcp_f32 v12, v12
  s_nop 0
  v_mul_f32 v220, v220, v12
  v_mul_f32 v221, v221, v12
  v_mul_f32 v222, v222, v12
  v_mul_f32 v223, v223, v12
  v_mul_f32 v224, v224, v12
  v_mul_f32 v225, v225, v12
  v_mul_f32 v226, v226, v12
  v_mul_f32 v227, v227, v12
  v_mul_f32 v228, v228, v12
  v_mul_f32 v229, v229, v12
  v_mul_f32 v230, v230, v12
  v_mul_f32 v231, v231, v12
  v_mul_f32 v232, v232, v12
  v_mul_f32 v233, v233, v12
  v_mul_f32 v234, v234, v12
  v_mul_f32 v235, v235, v12
  v_cvt_pk_bf16_f32 v156, v220, v221
  v_cvt_pk_bf16_f32 v157, v222, v223
  v_cvt_pk_bf16_f32 v158, v224, v225
  v_cvt_pk_bf16_f32 v159, v226, v227
  v_cvt_pk_bf16_f32 v160, v228, v229
  v_cvt_pk_bf16_f32 v161, v230, v231
  v_cvt_pk_bf16_f32 v162, v232, v233
  v_cvt_pk_bf16_f32 v163, v234, v235
  s_setprio 3
  v_mfma_f32_32x32x16_bf16 v[220:235], v[156:159], v[28:31], 0
  v_mfma_f32_32x32x16_bf16 v[220:235], v[160:163], v[24:27], v[220:235]
  s_setprio 0
  s_waitcnt vmcnt(7)
  v_xor_b32 v12, s12, v173
  s_waitcnt vmcnt(6)
  v_xor_b32 v13, s12, v175
  v_or_b32 v12, v12, v13
  s_waitcnt vmcnt(5)
  v_xor_b32 v13, s12, v177
  v_or_b32 v12, v12, v13
  s_waitcnt vmcnt(4)
  v_xor_b32 v13, s12, v179
  v_or_b32 v12, v12, v13
  s_waitcnt vmcnt(3)
  v_xor_b32 v13, s12, v181
  v_or_b32 v12, v12, v13
  s_waitcnt vmcnt(2)
  v_xor_b32 v13, s12, v183
  v_or_b32 v12, v12, v13
  s_waitcnt vmcnt(1)
  v_xor_b32 v13, s12, v185
  v_or_b32 v12, v12, v13
  s_waitcnt vmcnt(0)
  v_xor_b32 v13, s12, v187
  v_or_b32 v12, v12, v13
  v_cmp_ne_u32 vcc, 0, v12
  s_nop 1
  s_cbranch_vccz gr48x
  s_mov_b32 s14, 0x40000
gr48:
  buffer_load_dwordx2 v[172:173], v33, s[28:31], s8 offen offset:0 sc1
  buffer_load_dwordx2 v[174:175], v33, s[28:31], s8 offen offset:256 sc1
  buffer_load_dwordx2 v[176:177], v33, s[28:31], s8 offen offset:512 sc1
  buffer_load_dwordx2 v[178:179], v33, s[28:31], s8 offen offset:768 sc1
  buffer_load_dwordx2 v[180:181], v33, s[28:31], s9 offen offset:0 sc1
  buffer_load_dwordx2 v[182:183], v33, s[28:31], s9 offen offset:256 sc1
  buffer_load_dwordx2 v[184:185], v33, s[28:31], s9 offen offset:512 sc1
  buffer_load_dwordx2 v[186:187], v33, s[28:31], s9 offen offset:768 sc1
  s_sub_u32 s14, s14, 1
  s_waitcnt vmcnt(0)
  s_cbranch_scc1 gr48x
  v_xor_b32 v12, s12, v173
  v_xor_b32 v13, s12, v175
  v_or_b32 v12, v12, v13
  v_xor_b32 v13, s12, v177
  v_or_b32 v12, v12, v13
  v_xor_b32 v13, s12, v179
  v_or_b32 v12, v12, v13
  v_xor_b32 v13, s12, v181
  v_or_b32 v12, v12, v13
  v_xor_b32 v13, s12, v183
  v_or_b32 v12, v12, v13
  v_xor_b32 v13, s12, v185
  v_or_b32 v12, v12, v13
  v_xor_b32 v13, s12, v187
  v_or_b32 v12, v12, v13
  v_cmp_ne_u32 vcc, 0, v12
  s_nop 1
  s_cbranch_vccnz gr48
gr48x:
  v_subrev_u32 v36, 2560, v16
  v_lshlrev_b32 v35, 2, v1
  v_add_u32 v35, 158080, v35
  v_add_f32 v172, v172, v174
  v_add_f32 v176, v176, v178
  v_add_f32 v172, v172, v176
  v_cvt_pk_bf16_f32 v12, v172, v172
  v_and_b32 v12, 0xffff0000, v12
  v_sub_f32 v172, v172, v12
  v_cvt_pk_bf16_f32 v172, v12, v172
  ds_write_b32 v36, v172 offset:0
  v_add_f32 v180, v180, v182
  v_add_f32 v184, v184, v186
  v_add_f32 v180, v180, v184
  v_cvt_pk_bf16_f32 v12, v180, v180
  v_and_b32 v12, 0xffff0000, v12
  v_sub_f32 v180, v180, v12
  v_cvt_pk_bf16_f32 v180, v12, v180
  ds_write_b32 v35, v180 offset:1024
  v_mov_b32 v12, 2
  ds_write_b32 v16, v12 offset:2048
  v_cvt_pk_bf16_f32 v156, v220, v221
  v_cvt_pk_bf16_f32 v157, v222, v223
  v_cvt_pk_bf16_f32 v158, v224, v225
  v_cvt_pk_bf16_f32 v159, v226, v227
  v_cvt_pk_bf16_f32 v160, v228, v229
  v_cvt_pk_bf16_f32 v161, v230, v231
  v_cvt_pk_bf16_f32 v162, v232, v233
  v_cvt_pk_bf16_f32 v163, v234, v235
  s_setprio 3
  v_mfma_f32_32x32x16_bf16 v[236:251], v[156:159], v[164:167], v[236:251]
  s_setprio 0
  s_setprio 3
  v_mfma_f32_32x32x16_bf16 v[236:251], v[160:163], v[168:171], v[236:251]
  s_setprio 0
  s_nop 10
  v_cvt_pk_bf16_f32 v236, v236, v237
  v_cvt_pk_bf16_f32 v237, v238, v239
  v_cvt_pk_bf16_f32 v238, v240, v241
  v_cvt_pk_bf16_f32 v239, v242, v243
  v_cvt_pk_bf16_f32 v240, v244, v245
  v_cvt_pk_bf16_f32 v241, v246, v247
  v_cvt_pk_bf16_f32 v242, v248, v249
  v_cvt_pk_bf16_f32 v243, v250, v251
  s_bitcmp1_b32 s21, 0
  s_cselect_b32 exec_lo, 0xffff, 0
  s_mov_b32 exec_hi, exec_lo
  v_swap_b32 v236, v238
  v_swap_b32 v237, v239
  v_swap_b32 v240, v242
  v_swap_b32 v241, v243
  s_mov_b64 exec, -1
  buffer_store_dwordx4 v[236:239], v37, s[28:31], 0 offen offset:0 sc1
  buffer_store_dwordx4 v[240:243], v37, s[28:31], 0 offen offset:1024 sc1
  s_lshl2_add_u32 s64, s22, s27
  s_lshl4_add_u32 s64, s64, s21
  s_lshl_b32 s64, s64, 7
  s_add_u32 s64, s64, 0xc00000
  v_mov_b32 v12, s12
  s_mov_b64 exec, 1
  buffer_store_dword v12, off, s[28:31], s64 sc1
  s_mov_b64 exec, -1
  s_setprio 0
  s_add_u32 m0, s6, 32768
  s_add_u32 s7, s44, 0
  buffer_load_dwordx4 v2, s[48:51], s7 offen lds
  s_add_u32 m0, s6, 33792
  s_add_u32 s7, s44, 8192
  buffer_load_dwordx4 v2, s[48:51], s7 offen lds
  s_add_u32 m0, s6, 40960
  s_add_u32 s7, s45, 0
  buffer_load_dwordx4 v2, s[48:51], s7 offen lds
  s_add_u32 m0, s6, 41984
  s_add_u32 s7, s45, 8192
  buffer_load_dwordx4 v2, s[48:51], s7 offen lds
  s_add_u32 m0, s6, 49152
  s_add_u32 s7, s46, 0
  buffer_load_dwordx4 v2, s[48:51], s7 offen lds
  s_add_u32 m0, s6, 50176
  s_add_u32 s7, s46, 8192
  buffer_load_dwordx4 v2, s[48:51], s7 offen lds
  s_add_u32 m0, s6, 57344
  s_add_u32 s7, s10, 0
  buffer_load_dwordx4 v2, s[48:51], s7 offen lds
  s_add_u32 m0, s6, 58368
  s_add_u32 s7, s10, 8192
  buffer_load_dwordx4 v2, s[48:51], s7 offen lds
  ds_read_b32 v14, v17 offset:1024
  s_waitcnt lgkmcnt(0)
  v_cmp_gt_u32 vcc, 5, v14
  s_nop 1
  s_cbranch_vccnz lw49
lw49x:
  s_add_u32 m0, s6, 0
  s_add_u32 s7, s44, 16384
  buffer_load_dwordx4 v2, s[48:51], s7 offen lds
  s_add_u32 m0, s6, 1024
  s_add_u32 s7, s44, 24576
  buffer_load_dwordx4 v2, s[48:51], s7 offen lds
  s_add_u32 m0, s6, 8192
  s_add_u32 s7, s45, 16384
  buffer_load_dwordx4 v2, s[48:51], s7 offen lds
  s_add_u32 m0, s6, 9216
  s_add_u32 s7, s45, 24576
  buffer_load_dwordx4 v2, s[48:51], s7 offen lds
  s_add_u32 m0, s6, 16384
  s_add_u32 s7, s46, 16384
  buffer_load_dwordx4 v2, s[48:51], s7 offen lds
  s_add_u32 m0, s6, 17408
  s_add_u32 s7, s46, 24576
  buffer_load_dwordx4 v2, s[48:51], s7 offen lds
  s_add_u32 m0, s6, 24576
  s_add_u32 s7, s10, 16384
  buffer_load_dwordx4 v2, s[48:51], s7 offen lds
  s_add_u32 m0, s6, 25600
  s_add_u32 s7, s10, 24576
  buffer_load_dwordx4 v2, s[48:51], s7 offen lds
  s_waitcnt vmcnt(14)
  ds_read_b64_tr_b16 v[96:97], v4 offset:32768
  ds_read_b64_tr_b16 v[98:99], v4 offset:33792
  ds_read_b64_tr_b16 v[100:101], v5 offset:32768
  ds_read_b64_tr_b16 v[102:103], v5 offset:33792
  s_waitcnt vmcnt(12)
  ds_read_b64_tr_b16 v[104:105], v4 offset:40960
  ds_read_b64_tr_b16 v[106:107], v4 offset:41984
  ds_read_b64_tr_b16 v[108:109], v5 offset:40960
  ds_read_b64_tr_b16 v[110:111], v5 offset:41984
  s_waitcnt lgkmcnt(4)
  s_add_u32 m0, s6, 32768
  s_add_u32 s7, s44, 32768
  buffer_load_dwordx4 v2, s[48:51], s7 offen lds
  s_add_u32 m0, s6, 33792
  s_add_u32 s7, s44, 40960
  buffer_load_dwordx4 v2, s[48:51], s7 offen lds
  s_waitcnt vmcnt(12)
  ds_read_b64_tr_b16 v[112:113], v4 offset:49152
  ds_read_b64_tr_b16 v[114:115], v4 offset:50176
  ds_read_b64_tr_b16 v[116:117], v5 offset:49152
  ds_read_b64_tr_b16 v[118:119], v5 offset:50176
  s_waitcnt lgkmcnt(4)
  s_add_u32 m0, s6, 40960
  s_add_u32 s7, s45, 32768
  buffer_load_dwordx4 v2, s[48:51], s7 offen lds
  s_add_u32 m0, s6, 41984
  s_add_u32 s7, s45, 40960
  buffer_load_dwordx4 v2, s[48:51], s7 offen lds
  s_waitcnt vmcnt(12)
  ds_read_b64_tr_b16 v[120:121], v4 offset:57344
  ds_read_b64_tr_b16 v[122:123], v4 offset:58368
  ds_read_b64_tr_b16 v[124:125], v5 offset:57344
  ds_read_b64_tr_b16 v[126:127], v5 offset:58368
  s_waitcnt lgkmcnt(4)
  s_add_u32 m0, s6, 49152
  s_add_u32 s7, s46, 32768
  buffer_load_dwordx4 v2, s[48:51], s7 offen lds
  s_add_u32 m0, s6, 50176
  s_add_u32 s7, s46, 40960
  buffer_load_dwordx4 v2, s[48:51], s7 offen lds
  s_waitcnt vmcnt(12)
  ds_read_b64_tr_b16 v[128:129], v4 offset:0
  ds_read_b64_tr_b16 v[130:131], v4 offset:1024
  ds_read_b64_tr_b16 v[132:133], v5 offset:0
  ds_read_b64_tr_b16 v[134:135], v5 offset:1024
  s_waitcnt lgkmcnt(4)
  s_add_u32 m0, s6, 57344
  s_add_u32 s7, s47, 32768
  buffer_load_dwordx4 v2, s[48:51], s7 offen lds
  s_add_u32 m0, s6, 58368
  s_add_u32 s7, s47, 40960
  buffer_load_dwordx4 v2, s[48:51], s7 offen lds
  s_waitcnt vmcnt(12)
  ds_read_b64_tr_b16 v[136:137], v4 offset:8192
  ds_read_b64_tr_b16 v[138:139], v4 offset:9216
  ds_read_b64_tr_b16 v[140:141], v5 offset:8192
  ds_read_b64_tr_b16 v[142:143], v5 offset:9216
  s_waitcnt lgkmcnt(4)
  s_add_u32 m0, s6, 0
  s_add_u32 s7, s13, 0
  buffer_load_dwordx4 v2, s[52:55], s7 offen lds
  s_add_u32 m0, s6, 1024
  s_add_u32 s7, s13, 8192
  buffer_load_dwordx4 v2, s[52:55], s7 offen lds
  s_waitcnt vmcnt(12)
  ds_read_b64_tr_b16 v[144:145], v4 offset:16384
  ds_read_b64_tr_b16 v[146:147], v4 offset:17408
  ds_read_b64_tr_b16 v[148:149], v5 offset:16384
  ds_read_b64_tr_b16 v[150:151], v5 offset:17408
  s_waitcnt lgkmcnt(4)
  s_add_u32 m0, s6, 8192
  s_add_u32 s7, s13, 16384
  buffer_load_dwordx4 v2, s[52:55], s7 offen lds
  s_add_u32 m0, s6, 9216
  s_add_u32 s7, s13, 24576
  buffer_load_dwordx4 v2, s[52:55], s7 offen lds
  s_waitcnt vmcnt(12)
  ds_read_b64_tr_b16 v[152:153], v4 offset:24576
  ds_read_b64_tr_b16 v[154:155], v4 offset:25600
  ds_read_b64_tr_b16 v[156:157], v5 offset:24576
  ds_read_b64_tr_b16 v[158:159], v5 offset:25600
  s_waitcnt lgkmcnt(4)
  s_add_u32 m0, s6, 16384
  s_add_u32 s7, s13, 32768
  buffer_load_dwordx4 v2, s[52:55], s7 offen lds
  s_add_u32 m0, s6, 17408
  s_add_u32 s7, s13, 40960
  buffer_load_dwordx4 v2, s[52:55], s7 offen lds
  s_waitcnt vmcnt(12)
  ds_read_b64_tr_b16 v[160:161], v4 offset:32768
  ds_read_b64_tr_b16 v[162:163], v4 offset:33792
  ds_read_b64_tr_b16 v[164:165], v5 offset:32768
  ds_read_b64_tr_b16 v[166:167], v5 offset:33792
  s_waitcnt lgkmcnt(4)
  s_add_u32 m0, s6, 24576
  s_add_u32 s7, s13, 49152
  buffer_load_dwordx4 v2, s[52:55], s7 offen lds
  s_add_u32 m0, s6, 25600
  s_add_u32 s7, s13, 57344
  buffer_load_dwordx4 v2, s[52:55], s7 offen lds
  s_waitcnt vmcnt(12)
  ds_read_b64_tr_b16 v[168:169], v4 offset:40960
  ds_read_b64_tr_b16 v[170:171], v4 offset:41984
  ds_read_b64_tr_b16 v[172:173], v5 offset:40960
  ds_read_b64_tr_b16 v[174:175], v5 offset:41984
  s_waitcnt lgkmcnt(4)
  s_add_u32 m0, s6, 32768
  s_add_u32 s7, s13, 65536
  buffer_load_dwordx4 v2, s[52:55], s7 offen lds
  s_add_u32 m0, s6, 33792
  s_add_u32 s7, s13, 73728
  buffer_load_dwordx4 v2, s[52:55], s7 offen lds
  s_waitcnt vmcnt(12)
  ds_read_b64_tr_b16 v[176:177], v4 offset:49152
  ds_read_b64_tr_b16 v[178:179], v4 offset:50176
  ds_read_b64_tr_b16 v[180:181], v5 offset:49152
  ds_read_b64_tr_b16 v[182:183], v5 offset:50176
  s_waitcnt lgkmcnt(4)
  s_add_u32 m0, s6, 40960
  s_add_u32 s7, s13, 81920
  buffer_load_dwordx4 v2, s[52:55], s7 offen lds
  s_add_u32 m0, s6, 41984
  s_add_u32 s7, s13, 90112
  buffer_load_dwordx4 v2, s[52:55], s7 offen lds
  s_waitcnt vmcnt(12)
  ds_read_b64_tr_b16 v[184:185], v4 offset:57344
  ds_read_b64_tr_b16 v[186:187], v4 offset:58368
  ds_read_b64_tr_b16 v[188:189], v5 offset:57344
  ds_read_b64_tr_b16 v[190:191], v5 offset:58368
  s_waitcnt lgkmcnt(4)
  s_add_u32 m0, s6, 49152
  s_add_u32 s7, s13, 98304
  buffer_load_dwordx4 v2, s[52:55], s7 offen lds
  s_add_u32 m0, s6, 50176
  s_add_u32 s7, s13, 106496
  buffer_load_dwordx4 v2, s[52:55], s7 offen lds
  s_waitcnt lgkmcnt(0)
  s_add_u32 m0, s6, 57344
  s_add_u32 s7, s13, 114688
  buffer_load_dwordx4 v2, s[52:55], s7 offen lds
  s_add_u32 m0, s6, 58368
  s_add_u32 s7, s13, 122880
  buffer_load_dwordx4 v2, s[52:55], s7 offen lds
  s_load_dword s36, s[70:71], s68 offset:0 glc
  s_load_dword s37, s[70:71], s68 offset:128 glc
  s_load_dword s38, s[70:71], s68 offset:256 glc
  s_load_dword s39, s[70:71], s68 offset:384 glc
  s_load_dword s40, s[70:71], s68 offset:512 glc
  s_load_dword s41, s[70:71], s68 offset:640 glc
  s_load_dword s42, s[70:71], s68 offset:768 glc
  s_load_dword s43, s[70:71], s68 offset:896 glc
  s_waitcnt lgkmcnt(0)
  s_xor_b64 s[36:37], s[36:37], s[100:101]
  s_xor_b64 s[38:39], s[38:39], s[100:101]
  s_xor_b64 s[40:41], s[40:41], s[100:101]
  s_xor_b64 s[42:43], s[42:43], s[100:101]
  s_or_b64 s[36:37], s[36:37], s[38:39]
  s_or_b64 s[36:37], s[36:37], s[40:41]
  s_or_b64 s[36:37], s[36:37], s[42:43]
  s_cbranch_scc1 sf50
sf50x:
  s_lshl3_add_u32 s64, s44, 0x0
  buffer_load_dwordx4 v[192:195], v3, s[32:35], s64 offen offset:0 sc1
  buffer_load_dwordx4 v[196:199], v3, s[32:35], s64 offen offset:2048 sc1
  s_lshl3_add_u32 s64, s45, 0x0
  buffer_load_dwordx4 v[200:203], v3, s[32:35], s64 offen offset:0 sc1
  buffer_load_dwordx4 v[204:207], v3, s[32:35], s64 offen offset:2048 sc1
  s_lshl3_add_u32 s64, s46, 0x0
  buffer_load_dwordx4 v[208:211], v3, s[32:35], s64 offen offset:0 sc1
  buffer_load_dwordx4 v[212:215], v3, s[32:35], s64 offen offset:2048 sc1
  s_lshl3_add_u32 s64, s10, 0x0
  buffer_load_dwordx4 v[216:219], v3, s[32:35], s64 offen offset:0 sc1
  buffer_load_dwordx4 v[220:223], v3, s[32:35], s64 offen offset:2048 sc1
  s_lshl3_add_u32 s64, s44, 0x20000
  buffer_load_dwordx4 v[224:227], v3, s[32:35], s64 offen offset:0 sc1
  buffer_load_dwordx4 v[228:231], v3, s[32:35], s64 offen offset:2048 sc1
  s_lshl3_add_u32 s64, s45, 0x20000
  buffer_load_dwordx4 v[232:235], v3, s[32:35], s64 offen offset:0 sc1
  buffer_load_dwordx4 v[236:239], v3, s[32:35], s64 offen offset:2048 sc1
  s_lshl3_add_u32 s64, s46, 0x20000
  buffer_load_dwordx4 v[240:243], v3, s[32:35], s64 offen offset:0 sc1
  buffer_load_dwordx4 v[244:247], v3, s[32:35], s64 offen offset:2048 sc1
  s_lshl3_add_u32 s64, s10, 0x20000
  buffer_load_dwordx4 v[248:251], v3, s[32:35], s64 offen offset:0 sc1
  buffer_load_dwordx4 v[252:255], v3, s[32:35], s64 offen offset:2048 sc1
  s_waitcnt vmcnt(15)
  v_mfma_f32_32x32x16_bf16 v[32:47], v[96:99], v[192:195], 0
  v_mfma_f32_32x32x16_bf16 v[48:63], v[100:103], v[192:195], 0
  s_waitcnt vmcnt(14)
  v_mfma_f32_32x32x16_bf16 v[80:95], v[100:103], v[196:199], 0
  v_mfma_f32_32x32x16_bf16 v[64:79], v[96:99], v[196:199], 0
  s_lshl3_add_u32 s64, s44, 0x40000
  buffer_load_dwordx4 v[192:195], v3, s[32:35], s64 offen offset:0 sc1
  buffer_load_dwordx4 v[196:199], v3, s[32:35], s64 offen offset:2048 sc1
  ds_read_b64_tr_b16 v[96:97], v4 offset:0
  ds_read_b64_tr_b16 v[98:99], v4 offset:1024
  ds_read_b64_tr_b16 v[100:101], v5 offset:0
  ds_read_b64_tr_b16 v[102:103], v5 offset:1024
  s_waitcnt vmcnt(15)
  v_mfma_f32_32x32x16_bf16 v[32:47], v[104:107], v[200:203], v[32:47]
  v_mfma_f32_32x32x16_bf16 v[48:63], v[108:111], v[200:203], v[48:63]
  s_waitcnt vmcnt(14)
  v_mfma_f32_32x32x16_bf16 v[80:95], v[108:111], v[204:207], v[80:95]
  v_mfma_f32_32x32x16_bf16 v[64:79], v[104:107], v[204:207], v[64:79]
  s_lshl3_add_u32 s64, s45, 0x40000
  buffer_load_dwordx4 v[200:203], v3, s[32:35], s64 offen offset:0 sc1
  buffer_load_dwordx4 v[204:207], v3, s[32:35], s64 offen offset:2048 sc1
  ds_read_b64_tr_b16 v[104:105], v4 offset:8192
  ds_read_b64_tr_b16 v[106:107], v4 offset:9216
  ds_read_b64_tr_b16 v[108:109], v5 offset:8192
  ds_read_b64_tr_b16 v[110:111], v5 offset:9216
  s_waitcnt vmcnt(15)
  v_mfma_f32_32x32x16_bf16 v[32:47], v[112:115], v[208:211], v[32:47]
  v_mfma_f32_32x32x16_bf16 v[48:63], v[116:119], v[208:211], v[48:63]
  s_waitcnt vmcnt(14)
  v_mfma_f32_32x32x16_bf16 v[80:95], v[116:119], v[212:215], v[80:95]
  v_mfma_f32_32x32x16_bf16 v[64:79], v[112:115], v[212:215], v[64:79]
  s_lshl3_add_u32 s64, s46, 0x40000
  buffer_load_dwordx4 v[208:211], v3, s[32:35], s64 offen offset:0 sc1
  buffer_load_dwordx4 v[212:215], v3, s[32:35], s64 offen offset:2048 sc1
  ds_read_b64_tr_b16 v[112:113], v4 offset:16384
  ds_read_b64_tr_b16 v[114:115], v4 offset:17408
  ds_read_b64_tr_b16 v[116:117], v5 offset:16384
  ds_read_b64_tr_b16 v[118:119], v5 offset:17408
  s_waitcnt vmcnt(15)
  v_mfma_f32_32x32x16_bf16 v[32:47], v[120:123], v[216:219], v[32:47]
  v_mfma_f32_32x32x16_bf16 v[48:63], v[124:127], v[216:219], v[48:63]
  s_waitcnt vmcnt(14)
  v_mfma_f32_32x32x16_bf16 v[80:95], v[124:127], v[220:223], v[80:95]
  v_mfma_f32_32x32x16_bf16 v[64:79], v[120:123], v[220:223], v[64:79]
  s_lshl3_add_u32 s64, s47, 0x40000
  buffer_load_dwordx4 v[216:219], v3, s[32:35], s64 offen offset:0 sc1
  buffer_load_dwordx4 v[220:223], v3, s[32:35], s64 offen offset:2048 sc1
  ds_read_b64_tr_b16 v[120:121], v4 offset:24576
  ds_read_b64_tr_b16 v[122:123], v4 offset:25600
  ds_read_b64_tr_b16 v[124:125], v5 offset:24576
  ds_read_b64_tr_b16 v[126:127], v5 offset:25600
  s_waitcnt vmcnt(15)
  v_mfma_f32_32x32x16_bf16 v[32:47], v[128:131], v[224:227], v[32:47]
  v_mfma_f32_32x32x16_bf16 v[48:63], v[132:135], v[224:227], v[48:63]
  s_waitcnt vmcnt(14)
  v_mfma_f32_32x32x16_bf16 v[80:95], v[132:135], v[228:231], v[80:95]
  v_mfma_f32_32x32x16_bf16 v[64:79], v[128:131], v[228:231], v[64:79]
  ds_read_b64_tr_b16 v[128:129], v4 offset:32768
  ds_read_b64_tr_b16 v[130:131], v4 offset:33792
  ds_read_b64_tr_b16 v[132:133], v5 offset:32768
  ds_read_b64_tr_b16 v[134:135], v5 offset:33792
  s_waitcnt vmcnt(13)
  v_mfma_f32_32x32x16_bf16 v[32:47], v[136:139], v[232:235], v[32:47]
  v_mfma_f32_32x32x16_bf16 v[48:63], v[140:143], v[232:235], v[48:63]
  s_waitcnt vmcnt(12)
  v_mfma_f32_32x32x16_bf16 v[80:95], v[140:143], v[236:239], v[80:95]
  v_mfma_f32_32x32x16_bf16 v[64:79], v[136:139], v[236:239], v[64:79]
  ds_read_b64_tr_b16 v[136:137], v4 offset:40960
  ds_read_b64_tr_b16 v[138:139], v4 offset:41984
  ds_read_b64_tr_b16 v[140:141], v5 offset:40960
  ds_read_b64_tr_b16 v[142:143], v5 offset:41984
  s_waitcnt vmcnt(11)
  v_mfma_f32_32x32x16_bf16 v[32:47], v[144:147], v[240:243], v[32:47]
  v_mfma_f32_32x32x16_bf16 v[48:63], v[148:151], v[240:243], v[48:63]
  s_waitcnt vmcnt(10)
  v_mfma_f32_32x32x16_bf16 v[80:95], v[148:151], v[244:247], v[80:95]
  v_mfma_f32_32x32x16_bf16 v[64:79], v[144:147], v[244:247], v[64:79]
  ds_read_b64_tr_b16 v[144:145], v4 offset:49152
  ds_read_b64_tr_b16 v[146:147], v4 offset:50176
  ds_read_b64_tr_b16 v[148:149], v5 offset:49152
  ds_read_b64_tr_b16 v[150:151], v5 offset:50176
  s_load_dword s36, s[70:71], s68 offset:2048 glc
  s_load_dword s37, s[70:71], s68 offset:2176 glc
  s_load_dword s38, s[70:71], s68 offset:2304 glc
  s_load_dword s39, s[70:71], s68 offset:2432 glc
  s_waitcnt vmcnt(9)
  v_mfma_f32_32x32x16_bf16 v[32:47], v[152:155], v[248:251], v[32:47]
  v_mfma_f32_32x32x16_bf16 v[48:63], v[156:159], v[248:251], v[48:63]
  s_waitcnt vmcnt(8)
  v_mfma_f32_32x32x16_bf16 v[80:95], v[156:159], v[252:255], v[80:95]
  v_mfma_f32_32x32x16_bf16 v[64:79], v[152:155], v[252:255], v[64:79]
  ds_read_b64_tr_b16 v[152:153], v4 offset:57344
  ds_read_b64_tr_b16 v[154:155], v4 offset:58368
  ds_read_b64_tr_b16 v[156:157], v5 offset:57344
  ds_read_b64_tr_b16 v[158:159], v5 offset:58368
  s_waitcnt vmcnt(7)
  v_mfma_f32_32x32x16_bf16 v[32:47], v[160:163], v[192:195], v[32:47]
  v_mfma_f32_32x32x16_bf16 v[48:63], v[164:167], v[192:195], v[48:63]
  s_waitcnt vmcnt(6)
  v_mfma_f32_32x32x16_bf16 v[80:95], v[164:167], v[196:199], v[80:95]
  v_mfma_f32_32x32x16_bf16 v[64:79], v[160:163], v[196:199], v[64:79]
  s_waitcnt vmcnt(5)
  v_mfma_f32_32x32x16_bf16 v[32:47], v[168:171], v[200:203], v[32:47]
  v_mfma_f32_32x32x16_bf16 v[48:63], v[172:175], v[200:203], v[48:63]
  s_waitcnt vmcnt(4)
  v_mfma_f32_32x32x16_bf16 v[80:95], v[172:175], v[204:207], v[80:95]
  v_mfma_f32_32x32x16_bf16 v[64:79], v[168:171], v[204:207], v[64:79]
  s_waitcnt vmcnt(3)
  v_mfma_f32_32x32x16_bf16 v[32:47], v[176:179], v[208:211], v[32:47]
  v_mfma_f32_32x32x16_bf16 v[48:63], v[180:183], v[208:211], v[48:63]
  s_waitcnt vmcnt(2)
  v_mfma_f32_32x32x16_bf16 v[80:95], v[180:183], v[212:215], v[80:95]
  v_mfma_f32_32x32x16_bf16 v[64:79], v[176:179], v[212:215], v[64:79]
  s_waitcnt vmcnt(1)
  v_mfma_f32_32x32x16_bf16 v[32:47], v[184:187], v[216:219], v[32:47]
  v_mfma_f32_32x32x16_bf16 v[48:63], v[188:191], v[216:219], v[48:63]
  s_waitcnt vmcnt(0)
  v_mfma_f32_32x32x16_bf16 v[80:95], v[188:191], v[220:223], v[80:95]
  v_mfma_f32_32x32x16_bf16 v[64:79], v[184:187], v[220:223], v[64:79]
  s_waitcnt lgkmcnt(0)
  s_xor_b64 s[36:37], s[36:37], s[100:101]
  s_xor_b64 s[38:39], s[38:39], s[100:101]
  s_or_b64 s[36:37], s[36:37], s[38:39]
  s_cbranch_scc1 sf51
sf51x:
  s_lshl3_add_u32 s64, s13, 0x1000000
  buffer_load_dwordx4 v[224:227], v3, s[28:31], s64 offen offset:0 sc1
  buffer_load_dwordx4 v[228:231], v3, s[28:31], s64 offen offset:2048 sc1
  s_lshl3_add_u32 s64, s13, 0x1020000
  buffer_load_dwordx4 v[232:235], v3, s[28:31], s64 offen offset:0 sc1
  buffer_load_dwordx4 v[236:239], v3, s[28:31], s64 offen offset:2048 sc1
  s_lshl3_add_u32 s64, s13, 0x1040000
  buffer_load_dwordx4 v[240:243], v3, s[28:31], s64 offen offset:0 sc1
  buffer_load_dwordx4 v[244:247], v3, s[28:31], s64 offen offset:2048 sc1
  s_lshl3_add_u32 s64, s13, 0x1060000
  buffer_load_dwordx4 v[248:251], v3, s[28:31], s64 offen offset:0 sc1
  buffer_load_dwordx4 v[252:255], v3, s[28:31], s64 offen offset:2048 sc1
  s_lshl3_add_u32 s64, s13, 0x1080000
  buffer_load_dwordx4 v[192:195], v3, s[28:31], s64 offen offset:0 sc1
  buffer_load_dwordx4 v[196:199], v3, s[28:31], s64 offen offset:2048 sc1
  s_lshl3_add_u32 s64, s13, 0x10a0000
  buffer_load_dwordx4 v[200:203], v3, s[28:31], s64 offen offset:0 sc1
  buffer_load_dwordx4 v[204:207], v3, s[28:31], s64 offen offset:2048 sc1
  s_lshl3_add_u32 s64, s13, 0x10c0000
  buffer_load_dwordx4 v[208:211], v3, s[28:31], s64 offen offset:0 sc1
  buffer_load_dwordx4 v[212:215], v3, s[28:31], s64 offen offset:2048 sc1
  s_lshl3_add_u32 s64, s13, 0x10e0000
  buffer_load_dwordx4 v[216:219], v3, s[28:31], s64 offen offset:0 sc1
  buffer_load_dwordx4 v[220:223], v3, s[28:31], s64 offen offset:2048 sc1
  s_waitcnt vmcnt(15)
  v_mfma_f32_32x32x16_bf16 v[32:47], v[96:99], v[224:227], v[32:47]
  v_mfma_f32_32x32x16_bf16 v[48:63], v[100:103], v[224:227], v[48:63]
  s_waitcnt vmcnt(14)
  v_mfma_f32_32x32x16_bf16 v[80:95], v[100:103], v[228:231], v[80:95]
  v_mfma_f32_32x32x16_bf16 v[64:79], v[96:99], v[228:231], v[64:79]
  s_waitcnt vmcnt(13)
  v_mfma_f32_32x32x16_bf16 v[32:47], v[104:107], v[232:235], v[32:47]
  v_mfma_f32_32x32x16_bf16 v[48:63], v[108:111], v[232:235], v[48:63]
  s_waitcnt vmcnt(12)
  v_mfma_f32_32x32x16_bf16 v[80:95], v[108:111], v[236:239], v[80:95]
  v_mfma_f32_32x32x16_bf16 v[64:79], v[104:107], v[236:239], v[64:79]
  s_waitcnt vmcnt(11)
  v_mfma_f32_32x32x16_bf16 v[32:47], v[112:115], v[240:243], v[32:47]
  v_mfma_f32_32x32x16_bf16 v[48:63], v[116:119], v[240:243], v[48:63]
  s_waitcnt vmcnt(10)
  v_mfma_f32_32x32x16_bf16 v[80:95], v[116:119], v[244:247], v[80:95]
  v_mfma_f32_32x32x16_bf16 v[64:79], v[112:115], v[244:247], v[64:79]
  s_waitcnt vmcnt(9)
  v_mfma_f32_32x32x16_bf16 v[32:47], v[120:123], v[248:251], v[32:47]
  v_mfma_f32_32x32x16_bf16 v[48:63], v[124:127], v[248:251], v[48:63]
  s_waitcnt vmcnt(8)
  v_mfma_f32_32x32x16_bf16 v[80:95], v[124:127], v[252:255], v[80:95]
  v_mfma_f32_32x32x16_bf16 v[64:79], v[120:123], v[252:255], v[64:79]
  s_waitcnt vmcnt(7)
  v_mfma_f32_32x32x16_bf16 v[32:47], v[128:131], v[192:195], v[32:47]
  v_mfma_f32_32x32x16_bf16 v[48:63], v[132:135], v[192:195], v[48:63]
  s_waitcnt vmcnt(6)
  v_mfma_f32_32x32x16_bf16 v[80:95], v[132:135], v[196:199], v[80:95]
  v_mfma_f32_32x32x16_bf16 v[64:79], v[128:131], v[196:199], v[64:79]
  s_waitcnt vmcnt(5)
  v_mfma_f32_32x32x16_bf16 v[32:47], v[136:139], v[200:203], v[32:47]
  v_mfma_f32_32x32x16_bf16 v[48:63], v[140:143], v[200:203], v[48:63]
  s_waitcnt vmcnt(4)
  v_mfma_f32_32x32x16_bf16 v[80:95], v[140:143], v[204:207], v[80:95]
  v_mfma_f32_32x32x16_bf16 v[64:79], v[136:139], v[204:207], v[64:79]
  s_waitcnt vmcnt(3)
  v_mfma_f32_32x32x16_bf16 v[32:47], v[144:147], v[208:211], v[32:47]
  v_mfma_f32_32x32x16_bf16 v[48:63], v[148:151], v[208:211], v[48:63]
  s_waitcnt vmcnt(2)
  v_mfma_f32_32x32x16_bf16 v[80:95], v[148:151], v[212:215], v[80:95]
  v_mfma_f32_32x32x16_bf16 v[64:79], v[144:147], v[212:215], v[64:79]
  s_waitcnt vmcnt(1)
  v_mfma_f32_32x32x16_bf16 v[32:47], v[152:155], v[216:219], v[32:47]
  v_mfma_f32_32x32x16_bf16 v[48:63], v[156:159], v[216:219], v[48:63]
  s_waitcnt vmcnt(0)
  v_mfma_f32_32x32x16_bf16 v[80:95], v[156:159], v[220:223], v[80:95]
  v_mfma_f32_32x32x16_bf16 v[64:79], v[152:155], v[220:223], v[64:79]
  s_branch parallel_sum__linear_kernel_hedgehog__glu_gated_glu__prompt_kernel_tail
lw49:
  s_mov_b32 s14, 0x40000
lw49l:
  ds_read_b32 v14, v17 offset:1024
  s_sub_u32 s14, s14, 1
  s_waitcnt lgkmcnt(0)
  s_cbranch_scc1 lw49x
  v_cmp_gt_u32 vcc, 5, v14
  s_nop 1
  s_cbranch_vccnz lw49l
  s_branch lw49x
sf50:
  s_mov_b32 s14, 0x40000
sf50l:
  s_load_dword s36, s[70:71], s68 offset:0 glc
  s_load_dword s37, s[70:71], s68 offset:128 glc
  s_load_dword s38, s[70:71], s68 offset:256 glc
  s_load_dword s39, s[70:71], s68 offset:384 glc
  s_load_dword s40, s[70:71], s68 offset:512 glc
  s_load_dword s41, s[70:71], s68 offset:640 glc
  s_load_dword s42, s[70:71], s68 offset:768 glc
  s_load_dword s43, s[70:71], s68 offset:896 glc
  s_sub_u32 s14, s14, 1
  s_waitcnt lgkmcnt(0)
  s_cbranch_scc1 sf50x
  s_xor_b64 s[36:37], s[36:37], s[100:101]
  s_xor_b64 s[38:39], s[38:39], s[100:101]
  s_xor_b64 s[40:41], s[40:41], s[100:101]
  s_xor_b64 s[42:43], s[42:43], s[100:101]
  s_or_b64 s[36:37], s[36:37], s[38:39]
  s_or_b64 s[36:37], s[36:37], s[40:41]
  s_or_b64 s[36:37], s[36:37], s[42:43]
  s_cbranch_scc1 sf50l
  s_branch sf50x
sf51:
  s_mov_b32 s14, 0x40000
sf51l:
  s_load_dword s36, s[70:71], s68 offset:2048 glc
  s_load_dword s37, s[70:71], s68 offset:2176 glc
  s_load_dword s38, s[70:71], s68 offset:2304 glc
  s_load_dword s39, s[70:71], s68 offset:2432 glc
  s_sub_u32 s14, s14, 1
  s_waitcnt lgkmcnt(0)
  s_cbranch_scc1 sf51x
  s_xor_b64 s[36:37], s[36:37], s[100:101]
  s_xor_b64 s[38:39], s[38:39], s[100:101]
  s_or_b64 s[36:37], s[36:37], s[38:39]
  s_cbranch_scc1 sf51l
  s_branch sf51x
.fill (49152 - (. - parallel_sum__linear_kernel_hedgehog__glu_gated_glu__prompt_kernel))/4, 4, 0xBF810000
parallel_sum__linear_kernel_hedgehog__glu_gated_glu__prompt_kernel_b2:
  v_and_b32 v12, 31, v1
  v_bfe_u32 v13, v1, 1, 3
  v_lshrrev_b32 v14, 5, v1
  v_xor_b32 v13, v13, v14
  v_lshlrev_b32 v13, 4, v13
  v_lshl_add_u32 v13, v12, 7, v13
  s_lshl_b32 s64, s23, 13
  v_add_u32 v24, s64, v13
  v_xor_b32 v25, 32, v24
  v_xor_b32 v26, 64, v24
  v_xor_b32 v27, 96, v24
  v_add_u32 v28, 73824, v24
  v_add_u32 v29, 73824, v25
  v_add_u32 v30, 73824, v26
  v_add_u32 v31, 73824, v27
  v_lshrrev_b32 v14, 5, v1
  v_bfe_u32 v12, v1, 2, 2
  v_lshl_add_u32 v12, v14, 3, v12
  v_and_b32 v13, 3, v1
  v_lshlrev_b32 v13, 3, v13
  v_bfe_u32 v14, v1, 4, 1
  v_lshl_add_u32 v32, v12, 7, v13
  v_and_b32 v15, 8, v1
  v_lshl_add_u32 v32, v15, 3, v32
  v_lshl_add_u32 v32, v14, 5, v32
  s_lshl_b32 s64, s24, 6
  v_xor_b32 v32, s64, v32
  s_lshl_b32 s64, s27, 5
  v_add_u32 v32, 16384, v32
  v_mul_u32_u24 v36, 192, v12
  v_mul_u32_u24 v15, 12320, v14
  v_add3_u32 v36, v36, v13, v15
  v_add_u32 v36, 131328, v36
  v_add_u32 v35, s64, v36
  s_lshl_b32 s64, s23, 5
  v_add_u32 v36, s64, v36
  v_add_u32 v33, 73824, v32
  s_mov_b32 s15, 0x03020302
  s_mov_b32 s16, 0x01000100
  s_lshr_b32 s64, s21, 3
  s_lshl_b32 s64, s64, 4
  s_add_u32 s64, s64, s25
  s_mul_i32 s64, s64, 18432
  s_add_u32 s11, s64, 0x1400000
  s_lshl_b32 s64, s27, 8
  s_add_u32 s64, s64, 160640
  v_lshlrev_b32 v16, 2, v1
  v_add_u32 v16, s64, v16
  v_and_b32 v17, 3, v1
  v_mul_u32_u24 v17, 260, v17
  v_add_u32 v17, 160640, v17
  v_mov_b32 v12, 0
  ds_write_b32 v16, v12 offset:2048
  s_lshl_b32 s64, s21, 2
  s_lshl_b32 s65, s23, 1
  s_add_u32 s64, s64, s65
  s_lshl_b32 s64, s64, 11
  v_and_b32 v18, 56, v1
  v_add_u32 v18, v18, v1
  v_lshl_add_u32 v18, v18, 4, s64
  s_lshl_b32 s6, s27, 11
  s_add_u32 s6, s6, 65792
  v_lshrrev_b32 v12, 3, v1
  v_and_b32 v13, 7, v1
  v_lshlrev_b32 v2, 1, v12
  v_and_b32 v2, 4, v2
  v_xor_b32 v2, v2, v13
  v_lshlrev_b32 v2, 4, v2
  v_lshl_add_u32 v2, v12, 10, v2
  s_lshl_b32 s64, s5, 7
  v_add_u32 v2, s64, v2
  v_lshlrev_b32 v6, 4, v13
  v_lshl_add_u32 v6, v12, 10, v6
  s_lshl_b32 s65, s4, 16
  s_add_u32 s64, s64, s65
  s_lshl_b32 s65, s20, 13
  s_add_u32 s64, s64, s65
  v_add_u32 v6, s64, v6
  s_lshl_b32 s64, s4, 12
  v_and_b32 v3, 56, v1
  v_add_u32 v3, v3, v1
  v_lshl_add_u32 v3, v3, 4, s64
  v_lshrrev_b32 v4, 5, v1
  v_lshlrev_b32 v4, 9, v4
  v_bfe_u32 v5, v1, 2, 2
  v_lshl_add_u32 v4, v5, 7, v4
  v_and_b32 v5, 8, v1
  v_lshl_add_u32 v4, v5, 3, v4
  v_and_b32 v5, 16, v1
  v_lshl_add_u32 v4, v5, 1, v4
  v_and_b32 v5, 3, v1
  v_lshl_add_u32 v4, v5, 3, v4
  v_add_u32 v4, s6, v4
  v_xor_b32 v5, 64, v4
  s_mul_i32 s44, s27, 360448
  s_add_u32 s45, s44, 262144
  s_min_u32 s45, s45, 1310720
  s_add_u32 s46, s44, 98304
  s_sub_u32 s47, s45, 81920
  s_cmp_eq_u32 s27, 3
  s_cselect_b32 s10, 0x800000, s47
  s_lshl_b32 s13, s27, 17
  s_lshr_b32 s64, s2, 3
  s_cmp_lt_u32 s64, 24
  s_cselect_b32 s36, s48, s52
  s_cselect_b32 s37, s49, s53
  s_cselect_b32 s38, s50, s54
  s_cselect_b32 s65, 0, 24
  s_mov_b32 s39, 0x20000
  s_sub_u32 s64, s64, s65
  s_lshl_b32 s0, s64, 16
  v_and_b32 v12, 15, v1
  s_lshl4_add_u32 s64, s22, s27
  s_lshl_b32 s64, s64, 7
  s_add_u32 s64, s64, 0xb00000
  v_lshl_add_u32 v7, v12, 14, s64
  v_and_b32 v34, 31, v1
  v_lshlrev_b32 v34, 2, v34
  v_lshlrev_b32 v38, 1, v34
  s_and_b32 s64, s21, 7
  s_lshl_b32 s64, s64, 8
  v_add_u32 v38, s64, v38
  s_lshl_b32 s64, s23, 8
  s_add_u32 s64, s64, 160128
  v_add_u32 v34, s64, v34
  v_lshrrev_b32 v12, 2, v1
  v_and_b32 v12, 4, v12
  v_and_b32 v13, 12, v1
  v_cmp_eq_u32 vcc, v12, v13
  v_mov_b32 v12, 0x3f803f80
  s_nop 0
  v_cndmask_b32 v44, 0, v12, vcc
  v_cndmask_b32 v45, 0, v12, vcc
  v_cndmask_b32 v46, 0, v12, vcc
  v_cndmask_b32 v47, 0, v12, vcc
  v_mov_b32 v21, 0
  v_mov_b32 v22, 0
  v_mov_b32 v23, 0
  s_waitcnt vmcnt(1)
  s_waitcnt lgkmcnt(0)
  s_mul_i32 s12, s12, 1664525
  s_add_u32 s12, s12, 1013904223
  s_lshl2_add_u32 s65, s17, s27
  s_lshl_b32 s65, s65, 4
  s_add_u32 s65, s65, 0x1780000
  v_lshlrev_b32 v136, 16, v128
  v_and_b32 v137, 0xffff0000, v128
  v_lshlrev_b32 v138, 16, v129
  v_and_b32 v139, 0xffff0000, v129
  v_lshlrev_b32 v140, 16, v130
  v_and_b32 v141, 0xffff0000, v130
  v_lshlrev_b32 v142, 16, v131
  v_and_b32 v143, 0xffff0000, v131
  v_lshlrev_b32 v144, 16, v132
  v_and_b32 v145, 0xffff0000, v132
  v_lshlrev_b32 v146, 16, v133
  v_and_b32 v147, 0xffff0000, v133
  v_lshlrev_b32 v148, 16, v134
  v_and_b32 v149, 0xffff0000, v134
  v_lshlrev_b32 v150, 16, v135
  v_and_b32 v151, 0xffff0000, v135
  v_add_f32 v152, v136, v137
  v_add_f32 v153, v138, v139
  v_add_f32 v152, v152, v140
  v_add_f32 v153, v153, v141
  v_add_f32 v152, v152, v142
  v_add_f32 v153, v153, v143
  v_add_f32 v152, v152, v144
  v_add_f32 v153, v153, v145
  v_add_f32 v152, v152, v146
  v_add_f32 v153, v153, v147
  v_add_f32 v152, v152, v148
  v_add_f32 v153, v153, v149
  v_add_f32 v152, v152, v150
  v_add_f32 v153, v153, v151
  v_add_f32 v152, v152, v153
  s_nop 1
  v_add_f32_dpp v152, v152, v152 row_ror:8 row_mask:0xf bank_mask:0xf
  s_nop 1
  v_add_f32_dpp v152, v152, v152 row_ror:4 row_mask:0xf bank_mask:0xf
  s_nop 1
  v_add_f32_dpp v152, v152, v152 row_ror:2 row_mask:0xf bank_mask:0xf
  s_nop 1
  v_add_f32_dpp v152, v152, v152 row_ror:1 row_mask:0xf bank_mask:0xf
  v_mov_b32 v153, v152
  s_nop 1
  v_permlane16_swap_b32 v152, v153
  v_add_f32 v152, v152, v153
  v_mul_f32 v153, 0xbb000000, v152
  v_add_f32 v136, v136, v153
  v_add_f32 v137, v137, v153
  v_add_f32 v138, v138, v153
  v_add_f32 v139, v139, v153
  v_add_f32 v140, v140, v153
  v_add_f32 v141, v141, v153
  v_add_f32 v142, v142, v153
  v_add_f32 v143, v143, v153
  v_add_f32 v144, v144, v153
  v_add_f32 v145, v145, v153
  v_add_f32 v146, v146, v153
  v_add_f32 v147, v147, v153
  v_add_f32 v148, v148, v153
  v_add_f32 v149, v149, v153
  v_add_f32 v150, v150, v153
  v_add_f32 v151, v151, v153
  v_mul_f32 v152, v136, v136
  v_mul_f32 v154, v137, v137
  v_fmac_f32 v152, v138, v138
  v_fmac_f32 v154, v139, v139
  v_fmac_f32 v152, v140, v140
  v_fmac_f32 v154, v141, v141
  v_fmac_f32 v152, v142, v142
  v_fmac_f32 v154, v143, v143
  v_fmac_f32 v152, v144, v144
  v_fmac_f32 v154, v145, v145
  v_fmac_f32 v152, v146, v146
  v_fmac_f32 v154, v147, v147
  v_fmac_f32 v152, v148, v148
  v_fmac_f32 v154, v149, v149
  v_fmac_f32 v152, v150, v150
  v_fmac_f32 v154, v151, v151
  v_add_f32 v152, v152, v154
  s_nop 1
  v_add_f32_dpp v152, v152, v152 row_ror:8 row_mask:0xf bank_mask:0xf
  s_nop 1
  v_add_f32_dpp v152, v152, v152 row_ror:4 row_mask:0xf bank_mask:0xf
  s_nop 1
  v_add_f32_dpp v152, v152, v152 row_ror:2 row_mask:0xf bank_mask:0xf
  s_nop 1
  v_add_f32_dpp v152, v152, v152 row_ror:1 row_mask:0xf bank_mask:0xf
  v_mov_b32 v154, v152
  s_nop 1
  v_permlane16_swap_b32 v152, v154
  v_add_f32 v152, v152, v154
  v_mul_f32 v152, 0x3b000000, v152
  v_cvt_pk_bf16_f32 v152, v152, v152
  v_lshlrev_b32 v152, 16, v152
  v_add_f32 v152, 0x3727c5ac, v152
  v_cvt_pk_bf16_f32 v152, v152, v152
  v_lshlrev_b32 v152, 16, v152
  v_sqrt_f32 v152, v152
  s_nop 0
  v_cvt_pk_bf16_f32 v152, v152, v153
  v_mov_b32 v153, s12
  s_mov_b32 exec_lo, 1
  s_mov_b32 exec_hi, 1
  buffer_store_dwordx2 v[152:153], v157, s[28:31], s65 offen sc1
  s_mov_b64 exec, -1
  s_mov_b32 s100, s12
  s_mov_b32 s101, s12
  s_lshl2_add_u32 s68, s4, s27
  s_lshl_b32 s68, s68, 12
  s_add_u32 s68, s68, 0xb80000
  s_lshl1_add_u32 s64, s21, s23
  s_lshr_b32 s65, s25, 2
  s_lshl2_add_u32 s64, s64, s65
  s_lshl_b32 s64, s64, 5
  s_and_b32 s65, s25, 2
  s_add_u32 s65, s65, s24
  s_add_u32 s64, s64, s65
  s_lshl_b32 s64, s64, 7
  s_add_u32 s69, s64, 0xb80000
  s_waitcnt vmcnt(1)
  s_lshl_b32 s64, s24, 10
  s_add_u32 s64, s64, 156032
  v_bfe_u32 v12, v1, 2, 2
  v_lshlrev_b32 v12, 5, v12
  v_and_b32 v13, 32, v1
  v_lshl_add_u32 v12, v13, 2, v12
  v_and_b32 v13, 16, v1
  v_add_u32 v12, v12, v13
  v_and_b32 v13, 2, v1
  v_lshl_add_u32 v12, v13, 2, v12
  v_add_u32 v12, s64, v12
  ds_read_b64_tr_b16 v[96:97], v12 offset:0
  ds_read_b64_tr_b16 v[98:99], v12 offset:256
  ds_read_b64_tr_b16 v[100:101], v12 offset:512
  ds_read_b64_tr_b16 v[102:103], v12 offset:768
  v_and_b32 v13, 4, v1
  v_cmp_ne_u32 vcc, 0, v13
  v_mov_b32 v13, 0x80008000
  s_nop 0
  v_cndmask_b32 v13, 0, v13, vcc
  s_waitcnt lgkmcnt(3)
  v_xor_b32 v96, v13, v96
  v_xor_b32 v97, v13, v97
  s_waitcnt lgkmcnt(2)
  v_xor_b32 v98, v13, v98
  v_xor_b32 v99, v13, v99
  s_waitcnt lgkmcnt(1)
  v_xor_b32 v100, v13, v100
  v_xor_b32 v101, v13, v101
  s_waitcnt lgkmcnt(0)
  v_xor_b32 v102, v13, v102
  v_xor_b32 v103, v13, v103
  s_barrier
  s_setprio 3
  ds_read_b128 v[48:51], v24 offset:49216
  ds_read_b64_tr_b16 v[56:57], v32 offset:49216
  ds_read_b64_tr_b16 v[58:59], v32 offset:49728
  ds_read_b128 v[52:55], v24 offset:53312
  ds_read_b128 v[60:63], v25 offset:49216
  ds_read_b64_tr_b16 v[68:69], v32 offset:51264
  ds_read_b64_tr_b16 v[70:71], v32 offset:51776
  ds_read_b128 v[64:67], v25 offset:53312
  ds_read_b128 v[72:75], v26 offset:49216
  ds_read_b64_tr_b16 v[80:81], v32 offset:53312
  ds_read_b64_tr_b16 v[82:83], v32 offset:53824
  ds_read_b128 v[76:79], v26 offset:53312
  s_waitcnt lgkmcnt(9)
  v_mfma_f32_16x16x32_bf16 v[252:255], v[44:47], v[56:59], 0
  v_mfma_f32_32x32x16_bf16 v[108:123], v[56:59], v[48:51], 0
  ds_read_b128 v[84:87], v27 offset:49216
  ds_read_b64_tr_b16 v[92:93], v32 offset:55360
  ds_read_b64_tr_b16 v[94:95], v32 offset:55872
  ds_read_b128 v[88:91], v27 offset:53312
  s_waitcnt lgkmcnt(12)
  v_mfma_f32_32x32x16_bf16 v[124:139], v[56:59], v[52:55], 0
  s_waitcnt lgkmcnt(9)
  v_mfma_f32_16x16x32_bf16 v[252:255], v[44:47], v[68:71], v[252:255]
  v_mfma_f32_32x32x16_bf16 v[108:123], v[68:71], v[60:63], v[108:123]
  s_waitcnt lgkmcnt(0)
  s_barrier
  ds_read_b128 v[48:51], v28 offset:0
  ds_read_b64_tr_b16 v[56:57], v33 offset:0
  ds_read_b64_tr_b16 v[58:59], v33 offset:512
  v_mfma_f32_32x32x16_bf16 v[124:139], v[68:71], v[64:67], v[124:139]
  ds_read_b128 v[52:55], v28 offset:4096
  v_mfma_f32_16x16x32_bf16 v[252:255], v[44:47], v[80:83], v[252:255]
  v_mfma_f32_32x32x16_bf16 v[108:123], v[80:83], v[72:75], v[108:123]
  ds_read_b128 v[60:63], v29 offset:0
  ds_read_b64_tr_b16 v[68:69], v33 offset:2048
  ds_read_b64_tr_b16 v[70:71], v33 offset:2560
  ds_read_b128 v[64:67], v29 offset:4096
  v_mfma_f32_32x32x16_bf16 v[124:139], v[80:83], v[76:79], v[124:139]
  v_mfma_f32_16x16x32_bf16 v[252:255], v[44:47], v[92:95], v[252:255]
  v_mfma_f32_32x32x16_bf16 v[108:123], v[92:95], v[84:87], v[108:123]
  ds_read_b128 v[72:75], v30 offset:0
  ds_read_b64_tr_b16 v[80:81], v33 offset:4096
  ds_read_b64_tr_b16 v[82:83], v33 offset:4608
  ds_read_b128 v[76:79], v30 offset:4096
  v_mfma_f32_32x32x16_bf16 v[124:139], v[92:95], v[88:91], v[124:139]
  s_waitcnt lgkmcnt(9)
  v_mfma_f32_16x16x32_bf16 v[252:255], v[44:47], v[56:59], v[252:255]
  v_mfma_f32_32x32x16_bf16 v[108:123], v[56:59], v[48:51], v[108:123]
  ds_read_b128 v[84:87], v31 offset:0
  ds_read_b64_tr_b16 v[92:93], v33 offset:6144
  ds_read_b64_tr_b16 v[94:95], v33 offset:6656
  ds_read_b128 v[88:91], v31 offset:4096
  s_waitcnt lgkmcnt(12)
  v_mfma_f32_32x32x16_bf16 v[124:139], v[56:59], v[52:55], v[124:139]
  s_waitcnt lgkmcnt(9)
  v_mfma_f32_16x16x32_bf16 v[252:255], v[44:47], v[68:71], v[252:255]
  v_mfma_f32_32x32x16_bf16 v[108:123], v[68:71], v[60:63], v[108:123]
  s_waitcnt lgkmcnt(0)
  s_barrier
  ds_read_b128 v[48:51], v28 offset:24608
  ds_read_b64_tr_b16 v[56:57], v33 offset:24608
  ds_read_b64_tr_b16 v[58:59], v33 offset:25120
  v_mfma_f32_32x32x16_bf16 v[124:139], v[68:71], v[64:67], v[124:139]
  ds_read_b128 v[52:55], v28 offset:28704
  v_mfma_f32_16x16x32_bf16 v[252:255], v[44:47], v[80:83], v[252:255]
  v_mfma_f32_32x32x16_bf16 v[108:123], v[80:83], v[72:75], v[108:123]
  ds_read_b128 v[60:63], v29 offset:24608
  ds_read_b64_tr_b16 v[68:69], v33 offset:26656
  ds_read_b64_tr_b16 v[70:71], v33 offset:27168
  ds_read_b128 v[64:67], v29 offset:28704
  v_mfma_f32_32x32x16_bf16 v[124:139], v[80:83], v[76:79], v[124:139]
  v_mfma_f32_16x16x32_bf16 v[252:255], v[44:47], v[92:95], v[252:255]
  v_mfma_f32_32x32x16_bf16 v[108:123], v[92:95], v[84:87], v[108:123]
  ds_read_b128 v[72:75], v30 offset:24608
  ds_read_b64_tr_b16 v[80:81], v33 offset:28704
  ds_read_b64_tr_b16 v[82:83], v33 offset:29216
  ds_read_b128 v[76:79], v30 offset:28704
  v_mfma_f32_32x32x16_bf16 v[124:139], v[92:95], v[88:91], v[124:139]
  s_waitcnt lgkmcnt(9)
  v_mfma_f32_16x16x32_bf16 v[252:255], v[44:47], v[56:59], v[252:255]
  v_mfma_f32_32x32x16_bf16 v[108:123], v[56:59], v[48:51], v[108:123]
  ds_read_b128 v[84:87], v31 offset:24608
  ds_read_b64_tr_b16 v[92:93], v33 offset:30752
  ds_read_b64_tr_b16 v[94:95], v33 offset:31264
  ds_read_b128 v[88:91], v31 offset:28704
  s_waitcnt lgkmcnt(12)
  v_mfma_f32_32x32x16_bf16 v[124:139], v[56:59], v[52:55], v[124:139]
  s_waitcnt lgkmcnt(9)
  v_mfma_f32_16x16x32_bf16 v[252:255], v[44:47], v[68:71], v[252:255]
  v_mfma_f32_32x32x16_bf16 v[108:123], v[68:71], v[60:63], v[108:123]
  s_waitcnt lgkmcnt(0)
  s_barrier
  ds_read_b128 v[48:51], v24 offset:0
  ds_read_b64_tr_b16 v[56:57], v32 offset:0
  ds_read_b64_tr_b16 v[58:59], v32 offset:512
  v_mfma_f32_32x32x16_bf16 v[124:139], v[68:71], v[64:67], v[124:139]
  ds_read_b128 v[52:55], v24 offset:4096
  v_mfma_f32_16x16x32_bf16 v[252:255], v[44:47], v[80:83], v[252:255]
  v_mfma_f32_32x32x16_bf16 v[108:123], v[80:83], v[72:75], v[108:123]
  ds_read_b128 v[60:63], v25 offset:0
  ds_read_b64_tr_b16 v[68:69], v32 offset:2048
  ds_read_b64_tr_b16 v[70:71], v32 offset:2560
  ds_read_b128 v[64:67], v25 offset:4096
  v_mfma_f32_32x32x16_bf16 v[124:139], v[80:83], v[76:79], v[124:139]
  v_mfma_f32_16x16x32_bf16 v[252:255], v[44:47], v[92:95], v[252:255]
  v_mfma_f32_32x32x16_bf16 v[108:123], v[92:95], v[84:87], v[108:123]
  ds_read_b128 v[72:75], v26 offset:0
  ds_read_b64_tr_b16 v[80:81], v32 offset:4096
  ds_read_b64_tr_b16 v[82:83], v32 offset:4608
  ds_read_b128 v[76:79], v26 offset:4096
  v_mfma_f32_32x32x16_bf16 v[124:139], v[92:95], v[88:91], v[124:139]
  s_waitcnt lgkmcnt(9)
  v_mfma_f32_16x16x32_bf16 v[252:255], v[44:47], v[56:59], v[252:255]
  v_mfma_f32_32x32x16_bf16 v[108:123], v[56:59], v[48:51], v[108:123]
  ds_read_b128 v[84:87], v27 offset:0
  ds_read_b64_tr_b16 v[92:93], v32 offset:6144
  ds_read_b64_tr_b16 v[94:95], v32 offset:6656
  ds_read_b128 v[88:91], v27 offset:4096
  s_waitcnt lgkmcnt(12)
  v_mfma_f32_32x32x16_bf16 v[124:139], v[56:59], v[52:55], v[124:139]
  s_waitcnt lgkmcnt(9)
  v_mfma_f32_16x16x32_bf16 v[252:255], v[44:47], v[68:71], v[252:255]
  v_mfma_f32_32x32x16_bf16 v[108:123], v[68:71], v[60:63], v[108:123]
  s_waitcnt lgkmcnt(0)
  s_barrier
  ds_read_b128 v[48:51], v24 offset:24608
  ds_read_b64_tr_b16 v[56:57], v32 offset:24608
  ds_read_b64_tr_b16 v[58:59], v32 offset:25120
  v_mfma_f32_32x32x16_bf16 v[124:139], v[68:71], v[64:67], v[124:139]
  ds_read_b128 v[52:55], v24 offset:28704
  v_mfma_f32_16x16x32_bf16 v[252:255], v[44:47], v[80:83], v[252:255]
  v_mfma_f32_32x32x16_bf16 v[108:123], v[80:83], v[72:75], v[108:123]
  ds_read_b128 v[60:63], v25 offset:24608
  ds_read_b64_tr_b16 v[68:69], v32 offset:26656
  ds_read_b64_tr_b16 v[70:71], v32 offset:27168
  ds_read_b128 v[64:67], v25 offset:28704
  v_mfma_f32_32x32x16_bf16 v[124:139], v[80:83], v[76:79], v[124:139]
  v_mfma_f32_16x16x32_bf16 v[252:255], v[44:47], v[92:95], v[252:255]
  v_mfma_f32_32x32x16_bf16 v[108:123], v[92:95], v[84:87], v[108:123]
  ds_read_b128 v[72:75], v26 offset:24608
  ds_read_b64_tr_b16 v[80:81], v32 offset:28704
  ds_read_b64_tr_b16 v[82:83], v32 offset:29216
  ds_read_b128 v[76:79], v26 offset:28704
  v_mfma_f32_32x32x16_bf16 v[124:139], v[92:95], v[88:91], v[124:139]
  s_waitcnt lgkmcnt(9)
  v_mfma_f32_16x16x32_bf16 v[252:255], v[44:47], v[56:59], v[252:255]
  v_mfma_f32_32x32x16_bf16 v[108:123], v[56:59], v[48:51], v[108:123]
  ds_read_b128 v[84:87], v27 offset:24608
  ds_read_b64_tr_b16 v[92:93], v32 offset:30752
  ds_read_b64_tr_b16 v[94:95], v32 offset:31264
  ds_read_b128 v[88:91], v27 offset:28704
  buffer_load_dwordx4 v[8:11], v6, s[56:59], 0 offen
  s_waitcnt lgkmcnt(12)
  v_mfma_f32_32x32x16_bf16 v[124:139], v[56:59], v[52:55], v[124:139]
  s_waitcnt lgkmcnt(9)
  v_mfma_f32_16x16x32_bf16 v[252:255], v[44:47], v[68:71], v[252:255]
  v_mfma_f32_32x32x16_bf16 v[108:123], v[68:71], v[60:63], v[108:123]
  s_waitcnt lgkmcnt(0)
  s_barrier
  ds_read_b128 v[48:51], v24 offset:49216
  ds_read_b64_tr_b16 v[56:57], v32 offset:49216
  ds_read_b64_tr_b16 v[58:59], v32 offset:49728
  v_mfma_f32_32x32x16_bf16 v[124:139], v[68:71], v[64:67], v[124:139]
  ds_read_b128 v[52:55], v24 offset:53312
  v_mfma_f32_16x16x32_bf16 v[252:255], v[44:47], v[80:83], v[252:255]
  v_mfma_f32_32x32x16_bf16 v[108:123], v[80:83], v[72:75], v[108:123]
  ds_read_b128 v[60:63], v25 offset:49216
  ds_read_b64_tr_b16 v[68:69], v32 offset:51264
  ds_read_b64_tr_b16 v[70:71], v32 offset:51776
  ds_read_b128 v[64:67], v25 offset:53312
  v_mfma_f32_32x32x16_bf16 v[124:139], v[80:83], v[76:79], v[124:139]
  v_mfma_f32_16x16x32_bf16 v[252:255], v[44:47], v[92:95], v[252:255]
  v_mfma_f32_32x32x16_bf16 v[108:123], v[92:95], v[84:87], v[108:123]
  ds_read_b128 v[72:75], v26 offset:49216
  ds_read_b64_tr_b16 v[80:81], v32 offset:53312
  ds_read_b64_tr_b16 v[82:83], v32 offset:53824
  ds_read_b128 v[76:79], v26 offset:53312
  v_mfma_f32_32x32x16_bf16 v[124:139], v[92:95], v[88:91], v[124:139]
  s_waitcnt lgkmcnt(9)
  v_mfma_f32_16x16x32_bf16 v[252:255], v[44:47], v[56:59], v[252:255]
  v_mfma_f32_32x32x16_bf16 v[108:123], v[56:59], v[48:51], v[108:123]
  ds_read_b128 v[84:87], v27 offset:49216
  ds_read_b64_tr_b16 v[92:93], v32 offset:55360
  ds_read_b64_tr_b16 v[94:95], v32 offset:55872
  ds_read_b128 v[88:91], v27 offset:53312
  s_waitcnt lgkmcnt(12)
  v_mfma_f32_32x32x16_bf16 v[124:139], v[56:59], v[52:55], v[124:139]
  s_waitcnt lgkmcnt(9)
  v_mfma_f32_16x16x32_bf16 v[252:255], v[44:47], v[68:71], v[252:255]
  v_mfma_f32_32x32x16_bf16 v[108:123], v[68:71], v[60:63], v[108:123]
  s_waitcnt lgkmcnt(0)
  s_barrier
  ds_read_b128 v[48:51], v28 offset:0
  ds_read_b64_tr_b16 v[56:57], v33 offset:0
  ds_read_b64_tr_b16 v[58:59], v33 offset:512
  v_mfma_f32_32x32x16_bf16 v[124:139], v[68:71], v[64:67], v[124:139]
  ds_read_b128 v[52:55], v28 offset:4096
  v_mfma_f32_16x16x32_bf16 v[252:255], v[44:47], v[80:83], v[252:255]
  v_mfma_f32_32x32x16_bf16 v[108:123], v[80:83], v[72:75], v[108:123]
  ds_read_b128 v[60:63], v29 offset:0
  ds_read_b64_tr_b16 v[68:69], v33 offset:2048
  ds_read_b64_tr_b16 v[70:71], v33 offset:2560
  ds_read_b128 v[64:67], v29 offset:4096
  v_mfma_f32_32x32x16_bf16 v[124:139], v[80:83], v[76:79], v[124:139]
  v_mfma_f32_16x16x32_bf16 v[252:255], v[44:47], v[92:95], v[252:255]
  v_mfma_f32_32x32x16_bf16 v[108:123], v[92:95], v[84:87], v[108:123]
  ds_read_b128 v[72:75], v30 offset:0
  ds_read_b64_tr_b16 v[80:81], v33 offset:4096
  ds_read_b64_tr_b16 v[82:83], v33 offset:4608
  ds_read_b128 v[76:79], v30 offset:4096
  v_mfma_f32_32x32x16_bf16 v[124:139], v[92:95], v[88:91], v[124:139]
  s_waitcnt lgkmcnt(9)
  v_mfma_f32_16x16x32_bf16 v[252:255], v[44:47], v[56:59], v[252:255]
  v_mfma_f32_32x32x16_bf16 v[108:123], v[56:59], v[48:51], v[108:123]
  ds_read_b128 v[84:87], v31 offset:0
  ds_read_b64_tr_b16 v[92:93], v33 offset:6144
  ds_read_b64_tr_b16 v[94:95], v33 offset:6656
  ds_read_b128 v[88:91], v31 offset:4096
  s_waitcnt lgkmcnt(12)
  v_mfma_f32_32x32x16_bf16 v[124:139], v[56:59], v[52:55], v[124:139]
  s_waitcnt lgkmcnt(9)
  v_mfma_f32_16x16x32_bf16 v[252:255], v[44:47], v[68:71], v[252:255]
  v_mfma_f32_32x32x16_bf16 v[108:123], v[68:71], v[60:63], v[108:123]
  s_waitcnt lgkmcnt(0)
  s_barrier
  ds_read_b128 v[48:51], v28 offset:24608
  ds_read_b64_tr_b16 v[56:57], v33 offset:24608
  ds_read_b64_tr_b16 v[58:59], v33 offset:25120
  v_mfma_f32_32x32x16_bf16 v[124:139], v[68:71], v[64:67], v[124:139]
  ds_read_b128 v[52:55], v28 offset:28704
  v_mfma_f32_16x16x32_bf16 v[252:255], v[44:47], v[80:83], v[252:255]
  v_mfma_f32_32x32x16_bf16 v[108:123], v[80:83], v[72:75], v[108:123]
  ds_read_b128 v[60:63], v29 offset:24608
  ds_read_b64_tr_b16 v[68:69], v33 offset:26656
  ds_read_b64_tr_b16 v[70:71], v33 offset:27168
  ds_read_b128 v[64:67], v29 offset:28704
  v_mfma_f32_32x32x16_bf16 v[124:139], v[80:83], v[76:79], v[124:139]
  v_mfma_f32_16x16x32_bf16 v[252:255], v[44:47], v[92:95], v[252:255]
  v_mfma_f32_32x32x16_bf16 v[108:123], v[92:95], v[84:87], v[108:123]
  ds_read_b128 v[72:75], v30 offset:24608
  ds_read_b64_tr_b16 v[80:81], v33 offset:28704
  ds_read_b64_tr_b16 v[82:83], v33 offset:29216
  ds_read_b128 v[76:79], v30 offset:28704
  v_mfma_f32_32x32x16_bf16 v[124:139], v[92:95], v[88:91], v[124:139]
  s_waitcnt lgkmcnt(9)
  v_mfma_f32_16x16x32_bf16 v[252:255], v[44:47], v[56:59], v[252:255]
  v_mfma_f32_32x32x16_bf16 v[108:123], v[56:59], v[48:51], v[108:123]
  ds_read_b128 v[84:87], v31 offset:24608
  ds_read_b64_tr_b16 v[92:93], v33 offset:30752
  ds_read_b64_tr_b16 v[94:95], v33 offset:31264
  ds_read_b128 v[88:91], v31 offset:28704
  s_waitcnt lgkmcnt(12)
  v_mfma_f32_32x32x16_bf16 v[124:139], v[56:59], v[52:55], v[124:139]
  s_waitcnt lgkmcnt(9)
  v_mfma_f32_16x16x32_bf16 v[252:255], v[44:47], v[68:71], v[252:255]
  v_mfma_f32_32x32x16_bf16 v[108:123], v[68:71], v[60:63], v[108:123]
  s_waitcnt lgkmcnt(0)
  s_barrier
  ds_read_b32 v144, v34 offset:0
  ds_read_b32 v145, v34 offset:128
  v_mfma_f32_32x32x16_bf16 v[124:139], v[68:71], v[64:67], v[124:139]
  v_lshrrev_b32 v12, 2, v1
  v_and_b32 v12, 12, v12
  v_xor_b32 v12, v12, v1
  v_and_b32 v12, 14, v12
  v_and_b32 v13, 1, v1
  v_mfma_f32_16x16x32_bf16 v[252:255], v[44:47], v[80:83], v[252:255]
  v_mfma_f32_32x32x16_bf16 v[108:123], v[80:83], v[72:75], v[108:123]
  v_lshlrev_b32 v13, 4, v13
  s_waitcnt lgkmcnt(1)
  v_lshlrev_b32 v141, 16, v144
  v_rcp_f32 v146, v141
  v_perm_b32 v140, v144, v144, s15
  v_mul_f32 v146, 0x3fb8aa3b, v146
  v_mfma_f32_32x32x16_bf16 v[124:139], v[80:83], v[76:79], v[124:139]
  s_waitcnt lgkmcnt(0)
  v_lshlrev_b32 v143, 16, v145
  v_rcp_f32 v147, v143
  v_perm_b32 v142, v145, v145, s15
  v_mul_f32 v147, 0x3fb8aa3b, v147
  v_mov_b32 v14, 0x3f80
  v_mfma_f32_16x16x32_bf16 v[252:255], v[44:47], v[92:95], v[252:255]
  v_mfma_f32_32x32x16_bf16 v[108:123], v[92:95], v[84:87], v[108:123]
  v_lshlrev_b32 v13, v13, v14
  v_cmp_eq_u32 vcc, 0, v12
  s_nop 1
  v_cndmask_b32 v28, 0, v13, vcc
  v_cmp_eq_u32 vcc, 2, v12
  s_nop 1
  v_cndmask_b32 v29, 0, v13, vcc
  v_mfma_f32_32x32x16_bf16 v[124:139], v[92:95], v[88:91], v[124:139]
  v_cvt_pk_bf16_f32 v253, v252, v252
  v_and_b32 v253, 0xffff0000, v253
  v_sub_f32 v252, v252, v253
  v_cvt_pk_bf16_f32 v20, v253, v252
  v_cmp_eq_u32 vcc, 0, v12
  s_nop 0
  v_mfma_f32_32x32x16_bf16 v[108:123], v[20:23], v[140:143], v[108:123]
  v_cndmask_b32 v30, 0, v13, vcc
  v_cmp_eq_u32 vcc, 2, v12
  s_nop 1
  v_cndmask_b32 v31, 0, v13, vcc
  v_mfma_f32_32x32x16_bf16 v[124:139], v[20:23], v[142:145], v[124:139]
  s_setprio 0
  s_setprio 3
  s_nop 3
  v_cvt_pk_bf16_f32 v148, v108, v109
  v_cvt_pk_bf16_f32 v149, v110, v111
  v_cvt_pk_bf16_f32 v150, v112, v113
  v_cvt_pk_bf16_f32 v151, v114, v115
  s_nop 1
  v_mfma_f32_32x32x16_bf16 v[192:207], v[96:99], v[148:151], 0
  ds_read_b64_tr_b16 v[48:49], v35 offset:0
  ds_read_b64_tr_b16 v[50:51], v35 offset:768
  ds_read_b64_tr_b16 v[52:53], v35 offset:3072
  ds_read_b64_tr_b16 v[54:55], v35 offset:3840
  v_cvt_pk_bf16_f32 v152, v116, v117
  v_cvt_pk_bf16_f32 v153, v118, v119
  v_cvt_pk_bf16_f32 v154, v120, v121
  v_cvt_pk_bf16_f32 v155, v122, v123
  s_nop 1
  v_mfma_f32_32x32x16_bf16 v[208:223], v[100:103], v[152:155], 0
  ds_read_b64_tr_b16 v[56:57], v35 offset:6144
  ds_read_b64_tr_b16 v[58:59], v35 offset:6912
  ds_read_b64_tr_b16 v[60:61], v35 offset:9216
  ds_read_b64_tr_b16 v[62:63], v35 offset:9984
  v_cvt_pk_bf16_f32 v156, v124, v125
  v_cvt_pk_bf16_f32 v157, v126, v127
  v_cvt_pk_bf16_f32 v158, v128, v129
  v_cvt_pk_bf16_f32 v159, v130, v131
  s_nop 1
  v_mfma_f32_32x32x16_bf16 v[224:239], v[96:99], v[156:159], 0
  ds_read_b64_tr_b16 v[64:65], v36 offset:128
  ds_read_b64_tr_b16 v[66:67], v36 offset:896
  ds_read_b64_tr_b16 v[68:69], v36 offset:3200
  ds_read_b64_tr_b16 v[70:71], v36 offset:3968
  v_cvt_pk_bf16_f32 v160, v132, v133
  v_cvt_pk_bf16_f32 v161, v134, v135
  v_cvt_pk_bf16_f32 v162, v136, v137
  v_cvt_pk_bf16_f32 v163, v138, v139
  s_nop 1
  v_mfma_f32_32x32x16_bf16 v[240:255], v[100:103], v[160:163], 0
  ds_read_b64_tr_b16 v[72:73], v36 offset:6272
  ds_read_b64_tr_b16 v[74:75], v36 offset:7040
  ds_read_b64_tr_b16 v[76:77], v36 offset:9344
  ds_read_b64_tr_b16 v[78:79], v36 offset:10112
  s_setprio 0
  v_mov_b32 v12, 1
  ds_write_b32 v16, v12 offset:2048
  v_max3_f32 v12, v192, v193, v194
  v_max3_f32 v13, v195, v196, v197
  v_max3_f32 v12, v12, v198, v199
  v_max3_f32 v13, v13, v200, v201
  s_setprio 3
  s_waitcnt lgkmcnt(15)
  v_mfma_f32_16x16x32_bf16 v[80:83], v[44:47], v[48:51], 0
  s_waitcnt lgkmcnt(7)
  v_mfma_f32_16x16x32_bf16 v[84:87], v[44:47], v[64:67], 0
  v_mfma_f32_16x16x32_bf16 v[80:83], v[44:47], v[52:55], v[80:83]
  s_waitcnt lgkmcnt(5)
  v_mfma_f32_16x16x32_bf16 v[84:87], v[44:47], v[68:71], v[84:87]
  v_mfma_f32_16x16x32_bf16 v[80:83], v[44:47], v[56:59], v[80:83]
  s_waitcnt lgkmcnt(3)
  v_mfma_f32_16x16x32_bf16 v[84:87], v[44:47], v[72:75], v[84:87]
  v_mfma_f32_16x16x32_bf16 v[80:83], v[44:47], v[60:63], v[80:83]
  s_waitcnt lgkmcnt(1)
  v_mfma_f32_16x16x32_bf16 v[84:87], v[44:47], v[76:79], v[84:87]
  s_setprio 0
  v_max3_f32 v12, v12, v202, v203
  v_max3_f32 v13, v13, v204, v205
  v_max3_f32 v12, v12, v206, v207
  v_max_f32 v12, v12, v13
  v_mul_f32 v12, v146, v12
  v_fma_f32 v192, v192, v146, -v12
  s_cmp_gt_u32 s27, 0
  s_cbranch_scc1 pv53
  v_lshlrev_b32 v100, 10, v1
  buffer_load_dwordx2 v[100:101], v100, s[36:39], s0 offen offset:444
pv53:
  v_fma_f32 v193, v193, v146, -v12
  v_fma_f32 v194, v194, v146, -v12
  v_fma_f32 v195, v195, v146, -v12
  v_fma_f32 v196, v196, v146, -v12
  v_fma_f32 v197, v197, v146, -v12
  v_fma_f32 v198, v198, v146, -v12
  v_fma_f32 v199, v199, v146, -v12
  v_fma_f32 v200, v200, v146, -v12
  v_fma_f32 v201, v201, v146, -v12
  v_fma_f32 v202, v202, v146, -v12
  v_fma_f32 v203, v203, v146, -v12
  v_fma_f32 v204, v204, v146, -v12
  v_fma_f32 v205, v205, v146, -v12
  v_fma_f32 v206, v206, v146, -v12
  v_fma_f32 v207, v207, v146, -v12
  v_exp_f32 v192, v192
  s_lshl_b32 s64, s27, 11
  s_add_u32 s8, s64, s11
  s_add_u32 s9, s11, 8192
  s_lshl_b32 s64, s23, 11
  s_add_u32 s9, s9, s64
  v_mov_b32 v81, s12
  v_mov_b32 v85, s12
  s_mov_b32 exec_hi, 0
  buffer_store_dwordx2 v[80:81], v38, s[28:31], s8 offen sc1
  buffer_store_dwordx2 v[84:85], v38, s[28:31], s9 offen sc1
  s_mov_b64 exec, -1
  v_exp_f32 v193, v193
  v_exp_f32 v194, v194
  v_exp_f32 v195, v195
  v_exp_f32 v196, v196
  v_exp_f32 v197, v197
  v_exp_f32 v198, v198
  v_exp_f32 v199, v199
  v_exp_f32 v200, v200
  v_exp_f32 v201, v201
  v_exp_f32 v202, v202
  v_exp_f32 v203, v203
  v_exp_f32 v204, v204
  v_exp_f32 v205, v205
  v_exp_f32 v206, v206
  v_exp_f32 v207, v207
  v_add_f32 v12, v192, v193
  v_add_f32 v13, v194, v195
  v_add_f32 v12, v12, v196
  v_add_f32 v13, v13, v197
  v_add_f32 v12, v12, v198
  v_add_f32 v13, v13, v199
  v_add_f32 v12, v12, v200
  s_add_u32 m0, s6, 32768
  s_add_u32 s7, s44, 0
  buffer_load_dwordx4 v2, s[48:51], s7 offen lds
  v_add_f32 v13, v13, v201
  v_add_f32 v12, v12, v202
  v_add_f32 v13, v13, v203
  v_add_f32 v12, v12, v204
  v_add_f32 v13, v13, v205
  v_add_f32 v12, v12, v206
  v_add_f32 v13, v13, v207
  v_add_f32 v12, v12, v13
  s_add_u32 m0, s6, 33792
  s_add_u32 s7, s44, 8192
  buffer_load_dwordx4 v2, s[48:51], s7 offen lds
  v_rcp_f32 v12, v12
  s_nop 0
  v_mul_f32 v192, v192, v12
  v_mul_f32 v193, v193, v12
  v_mul_f32 v194, v194, v12
  v_mul_f32 v195, v195, v12
  v_mul_f32 v196, v196, v12
  v_mul_f32 v197, v197, v12
  v_mul_f32 v198, v198, v12
  v_mul_f32 v199, v199, v12
  v_mul_f32 v200, v200, v12
  v_mul_f32 v201, v201, v12
  v_mul_f32 v202, v202, v12
  v_mul_f32 v203, v203, v12
  v_mul_f32 v204, v204, v12
  v_mul_f32 v205, v205, v12
  v_mul_f32 v206, v206, v12
  v_mul_f32 v207, v207, v12
  v_cvt_pk_bf16_f32 v32, v192, v193
  v_cvt_pk_bf16_f32 v33, v194, v195
  v_cvt_pk_bf16_f32 v34, v196, v197
  v_cvt_pk_bf16_f32 v35, v198, v199
  v_cvt_pk_bf16_f32 v36, v200, v201
  v_cvt_pk_bf16_f32 v37, v202, v203
  v_cvt_pk_bf16_f32 v38, v204, v205
  v_cvt_pk_bf16_f32 v39, v206, v207
  v_max3_f32 v12, v208, v209, v210
  v_max3_f32 v13, v211, v212, v213
  v_max3_f32 v12, v12, v214, v215
  v_max3_f32 v13, v13, v216, v217
  v_max3_f32 v12, v12, v218, v219
  v_max3_f32 v13, v13, v220, v221
  v_max3_f32 v12, v12, v222, v223
  v_max_f32 v12, v12, v13
  v_mul_f32 v12, v146, v12
  v_fma_f32 v208, v208, v146, -v12
  v_fma_f32 v209, v209, v146, -v12
  v_fma_f32 v210, v210, v146, -v12
  v_fma_f32 v211, v211, v146, -v12
  v_fma_f32 v212, v212, v146, -v12
  v_fma_f32 v213, v213, v146, -v12
  v_fma_f32 v214, v214, v146, -v12
  v_fma_f32 v215, v215, v146, -v12
  v_fma_f32 v216, v216, v146, -v12
  v_fma_f32 v217, v217, v146, -v12
  v_fma_f32 v218, v218, v146, -v12
  v_fma_f32 v219, v219, v146, -v12
  v_fma_f32 v220, v220, v146, -v12
  v_fma_f32 v221, v221, v146, -v12
  v_fma_f32 v222, v222, v146, -v12
  v_fma_f32 v223, v223, v146, -v12
  v_exp_f32 v208, v208
  v_exp_f32 v209, v209
  v_exp_f32 v210, v210
  v_exp_f32 v211, v211
  v_exp_f32 v212, v212
  v_exp_f32 v213, v213
  v_exp_f32 v214, v214
  v_exp_f32 v215, v215
  v_exp_f32 v216, v216
  v_exp_f32 v217, v217
  v_exp_f32 v218, v218
  v_exp_f32 v219, v219
  v_exp_f32 v220, v220
  v_exp_f32 v221, v221
  v_exp_f32 v222, v222
  v_exp_f32 v223, v223
  v_add_f32 v12, v208, v209
  v_add_f32 v13, v210, v211
  v_add_f32 v12, v12, v212
  v_add_f32 v13, v13, v213
  v_add_f32 v12, v12, v214
  v_add_f32 v13, v13, v215
  v_add_f32 v12, v12, v216
  s_add_u32 m0, s6, 40960
  s_add_u32 s7, s45, 0
  buffer_load_dwordx4 v2, s[48:51], s7 offen lds
  v_add_f32 v13, v13, v217
  v_add_f32 v12, v12, v218
  v_add_f32 v13, v13, v219
  v_add_f32 v12, v12, v220
  v_add_f32 v13, v13, v221
  v_add_f32 v12, v12, v222
  v_add_f32 v13, v13, v223
  v_add_f32 v12, v12, v13
  s_add_u32 m0, s6, 41984
  s_add_u32 s7, s45, 8192
  buffer_load_dwordx4 v2, s[48:51], s7 offen lds
  v_rcp_f32 v12, v12
  s_nop 0
  v_mul_f32 v208, v208, v12
  v_mul_f32 v209, v209, v12
  v_mul_f32 v210, v210, v12
  v_mul_f32 v211, v211, v12
  v_mul_f32 v212, v212, v12
  v_mul_f32 v213, v213, v12
  v_mul_f32 v214, v214, v12
  v_mul_f32 v215, v215, v12
  v_mul_f32 v216, v216, v12
  v_mul_f32 v217, v217, v12
  v_mul_f32 v218, v218, v12
  v_mul_f32 v219, v219, v12
  v_mul_f32 v220, v220, v12
  v_mul_f32 v221, v221, v12
  v_mul_f32 v222, v222, v12
  v_mul_f32 v223, v223, v12
  v_cvt_pk_bf16_f32 v40, v208, v209
  v_cvt_pk_bf16_f32 v41, v210, v211
  v_cvt_pk_bf16_f32 v42, v212, v213
  v_cvt_pk_bf16_f32 v43, v214, v215
  v_cvt_pk_bf16_f32 v44, v216, v217
  v_cvt_pk_bf16_f32 v45, v218, v219
  v_cvt_pk_bf16_f32 v46, v220, v221
  v_cvt_pk_bf16_f32 v47, v222, v223
  v_max3_f32 v12, v224, v225, v226
  v_max3_f32 v13, v227, v228, v229
  v_max3_f32 v12, v12, v230, v231
  v_max3_f32 v13, v13, v232, v233
  v_max3_f32 v12, v12, v234, v235
  v_max3_f32 v13, v13, v236, v237
  v_max3_f32 v12, v12, v238, v239
  v_max_f32 v12, v12, v13
  v_mul_f32 v12, v147, v12
  v_fma_f32 v224, v224, v147, -v12
  v_fma_f32 v225, v225, v147, -v12
  v_fma_f32 v226, v226, v147, -v12
  v_fma_f32 v227, v227, v147, -v12
  v_fma_f32 v228, v228, v147, -v12
  v_fma_f32 v229, v229, v147, -v12
  v_fma_f32 v230, v230, v147, -v12
  v_fma_f32 v231, v231, v147, -v12
  v_fma_f32 v232, v232, v147, -v12
  v_fma_f32 v233, v233, v147, -v12
  v_fma_f32 v234, v234, v147, -v12
  v_fma_f32 v235, v235, v147, -v12
  v_fma_f32 v236, v236, v147, -v12
  v_fma_f32 v237, v237, v147, -v12
  v_fma_f32 v238, v238, v147, -v12
  v_fma_f32 v239, v239, v147, -v12
  v_exp_f32 v224, v224
  v_exp_f32 v225, v225
  v_exp_f32 v226, v226
  v_exp_f32 v227, v227
  v_exp_f32 v228, v228
  v_exp_f32 v229, v229
  v_exp_f32 v230, v230
  v_exp_f32 v231, v231
  v_exp_f32 v232, v232
  v_exp_f32 v233, v233
  v_exp_f32 v234, v234
  v_exp_f32 v235, v235
  v_exp_f32 v236, v236
  v_exp_f32 v237, v237
  v_exp_f32 v238, v238
  v_exp_f32 v239, v239
  v_add_f32 v12, v224, v225
  v_add_f32 v13, v226, v227
  v_add_f32 v12, v12, v228
  v_and_b32 v27, 31, v1
  v_lshlrev_b32 v27, 3, v27
  v_and_b32 v164, 32, v1
  v_lshl_add_u32 v27, v164, 5, v27
  buffer_load_dwordx2 v[168:169], v27, s[28:31], s8 offen offset:0 sc1
  buffer_load_dwordx2 v[170:171], v27, s[28:31], s8 offen offset:256 sc1
  buffer_load_dwordx2 v[172:173], v27, s[28:31], s8 offen offset:512 sc1
  buffer_load_dwordx2 v[174:175], v27, s[28:31], s8 offen offset:768 sc1
  buffer_load_dwordx2 v[176:177], v27, s[28:31], s9 offen offset:0 sc1
  buffer_load_dwordx2 v[178:179], v27, s[28:31], s9 offen offset:256 sc1
  buffer_load_dwordx2 v[180:181], v27, s[28:31], s9 offen offset:512 sc1
  buffer_load_dwordx2 v[182:183], v27, s[28:31], s9 offen offset:768 sc1
  v_add_f32 v13, v13, v229
  v_add_f32 v12, v12, v230
  v_add_f32 v13, v13, v231
  v_add_f32 v12, v12, v232
  s_add_u32 m0, s6, 49152
  s_add_u32 s7, s46, 0
  buffer_load_dwordx4 v2, s[48:51], s7 offen lds
  v_add_f32 v13, v13, v233
  v_add_f32 v12, v12, v234
  v_add_f32 v13, v13, v235
  v_add_f32 v12, v12, v236
  v_add_f32 v13, v13, v237
  v_add_f32 v12, v12, v238
  v_add_f32 v13, v13, v239
  v_add_f32 v12, v12, v13
  s_add_u32 m0, s6, 50176
  s_add_u32 s7, s46, 8192
  buffer_load_dwordx4 v2, s[48:51], s7 offen lds
  v_rcp_f32 v12, v12
  s_nop 0
  v_mul_f32 v224, v224, v12
  v_mul_f32 v225, v225, v12
  v_mul_f32 v226, v226, v12
  v_mul_f32 v227, v227, v12
  v_mul_f32 v228, v228, v12
  v_mul_f32 v229, v229, v12
  v_mul_f32 v230, v230, v12
  v_mul_f32 v231, v231, v12
  v_mul_f32 v232, v232, v12
  v_mul_f32 v233, v233, v12
  v_mul_f32 v234, v234, v12
  v_mul_f32 v235, v235, v12
  v_mul_f32 v236, v236, v12
  v_mul_f32 v237, v237, v12
  v_mul_f32 v238, v238, v12
  v_mul_f32 v239, v239, v12
  v_cvt_pk_bf16_f32 v48, v224, v225
  v_cvt_pk_bf16_f32 v49, v226, v227
  v_cvt_pk_bf16_f32 v50, v228, v229
  v_cvt_pk_bf16_f32 v51, v230, v231
  v_cvt_pk_bf16_f32 v52, v232, v233
  v_cvt_pk_bf16_f32 v53, v234, v235
  v_cvt_pk_bf16_f32 v54, v236, v237
  v_cvt_pk_bf16_f32 v55, v238, v239
  v_max3_f32 v12, v240, v241, v242
  v_max3_f32 v13, v243, v244, v245
  v_max3_f32 v12, v12, v246, v247
  v_max3_f32 v13, v13, v248, v249
  v_max3_f32 v12, v12, v250, v251
  v_max3_f32 v13, v13, v252, v253
  v_max3_f32 v12, v12, v254, v255
  v_max_f32 v12, v12, v13
  v_mul_f32 v12, v147, v12
  v_fma_f32 v240, v240, v147, -v12
  v_fma_f32 v241, v241, v147, -v12
  v_fma_f32 v242, v242, v147, -v12
  v_fma_f32 v243, v243, v147, -v12
  v_fma_f32 v244, v244, v147, -v12
  v_fma_f32 v245, v245, v147, -v12
  v_fma_f32 v246, v246, v147, -v12
  v_fma_f32 v247, v247, v147, -v12
  v_fma_f32 v248, v248, v147, -v12
  v_fma_f32 v249, v249, v147, -v12
  v_fma_f32 v250, v250, v147, -v12
  v_fma_f32 v251, v251, v147, -v12
  v_fma_f32 v252, v252, v147, -v12
  v_fma_f32 v253, v253, v147, -v12
  v_fma_f32 v254, v254, v147, -v12
  v_fma_f32 v255, v255, v147, -v12
  v_exp_f32 v240, v240
  v_exp_f32 v241, v241
  v_exp_f32 v242, v242
  v_exp_f32 v243, v243
  v_exp_f32 v244, v244
  v_exp_f32 v245, v245
  v_exp_f32 v246, v246
  v_exp_f32 v247, v247
  v_exp_f32 v248, v248
  v_exp_f32 v249, v249
  v_exp_f32 v250, v250
  v_exp_f32 v251, v251
  v_exp_f32 v252, v252
  v_exp_f32 v253, v253
  v_exp_f32 v254, v254
  v_exp_f32 v255, v255
  v_add_f32 v12, v240, v241
  v_add_f32 v13, v242, v243
  v_add_f32 v12, v12, v244
  v_add_f32 v13, v13, v245
  v_add_f32 v12, v12, v246
  v_add_f32 v13, v13, v247
  v_add_f32 v12, v12, v248
  s_add_u32 m0, s6, 57344
  s_add_u32 s7, s10, 0
  buffer_load_dwordx4 v2, s[48:51], s7 offen lds
  v_add_f32 v13, v13, v249
  v_add_f32 v12, v12, v250
  v_add_f32 v13, v13, v251
  v_add_f32 v12, v12, v252
  v_add_f32 v13, v13, v253
  v_add_f32 v12, v12, v254
  v_add_f32 v13, v13, v255
  v_add_f32 v12, v12, v13
  s_add_u32 m0, s6, 58368
  s_add_u32 s7, s10, 8192
  buffer_load_dwordx4 v2, s[48:51], s7 offen lds
  v_rcp_f32 v12, v12
  s_nop 0
  v_mul_f32 v240, v240, v12
  v_mul_f32 v241, v241, v12
  v_mul_f32 v242, v242, v12
  v_mul_f32 v243, v243, v12
  v_mul_f32 v244, v244, v12
  v_mul_f32 v245, v245, v12
  v_mul_f32 v246, v246, v12
  v_mul_f32 v247, v247, v12
  v_mul_f32 v248, v248, v12
  v_mul_f32 v249, v249, v12
  v_mul_f32 v250, v250, v12
  v_mul_f32 v251, v251, v12
  v_mul_f32 v252, v252, v12
  v_mul_f32 v253, v253, v12
  v_mul_f32 v254, v254, v12
  v_mul_f32 v255, v255, v12
  v_cvt_pk_bf16_f32 v56, v240, v241
  v_cvt_pk_bf16_f32 v57, v242, v243
  v_cvt_pk_bf16_f32 v58, v244, v245
  v_cvt_pk_bf16_f32 v59, v246, v247
  v_cvt_pk_bf16_f32 v60, v248, v249
  v_cvt_pk_bf16_f32 v61, v250, v251
  v_cvt_pk_bf16_f32 v62, v252, v253
  v_cvt_pk_bf16_f32 v63, v254, v255
  s_waitcnt vmcnt(11)
  v_xor_b32 v12, s12, v169
  s_waitcnt vmcnt(10)
  v_xor_b32 v13, s12, v171
  v_or_b32 v12, v12, v13
  s_waitcnt vmcnt(9)
  v_xor_b32 v13, s12, v173
  v_or_b32 v12, v12, v13
  s_waitcnt vmcnt(8)
  v_xor_b32 v13, s12, v175
  v_or_b32 v12, v12, v13
  s_waitcnt vmcnt(7)
  v_xor_b32 v13, s12, v177
  v_or_b32 v12, v12, v13
  s_waitcnt vmcnt(6)
  v_xor_b32 v13, s12, v179
  v_or_b32 v12, v12, v13
  s_waitcnt vmcnt(5)
  v_xor_b32 v13, s12, v181
  v_or_b32 v12, v12, v13
  s_waitcnt vmcnt(4)
  v_xor_b32 v13, s12, v183
  v_or_b32 v12, v12, v13
  v_cmp_ne_u32 vcc, 0, v12
  s_nop 1
  s_cbranch_vccz gr54x
  s_mov_b32 s14, 0x40000
gr54:
  buffer_load_dwordx2 v[168:169], v27, s[28:31], s8 offen offset:0 sc1
  buffer_load_dwordx2 v[170:171], v27, s[28:31], s8 offen offset:256 sc1
  buffer_load_dwordx2 v[172:173], v27, s[28:31], s8 offen offset:512 sc1
  buffer_load_dwordx2 v[174:175], v27, s[28:31], s8 offen offset:768 sc1
  buffer_load_dwordx2 v[176:177], v27, s[28:31], s9 offen offset:0 sc1
  buffer_load_dwordx2 v[178:179], v27, s[28:31], s9 offen offset:256 sc1
  buffer_load_dwordx2 v[180:181], v27, s[28:31], s9 offen offset:512 sc1
  buffer_load_dwordx2 v[182:183], v27, s[28:31], s9 offen offset:768 sc1
  s_sub_u32 s14, s14, 1
  s_waitcnt vmcnt(0)
  s_cbranch_scc1 gr54x
  v_xor_b32 v12, s12, v169
  v_xor_b32 v13, s12, v171
  v_or_b32 v12, v12, v13
  v_xor_b32 v13, s12, v173
  v_or_b32 v12, v12, v13
  v_xor_b32 v13, s12, v175
  v_or_b32 v12, v12, v13
  v_xor_b32 v13, s12, v177
  v_or_b32 v12, v12, v13
  v_xor_b32 v13, s12, v179
  v_or_b32 v12, v12, v13
  v_xor_b32 v13, s12, v181
  v_or_b32 v12, v12, v13
  v_xor_b32 v13, s12, v183
  v_or_b32 v12, v12, v13
  v_cmp_ne_u32 vcc, 0, v12
  s_nop 1
  s_cbranch_vccnz gr54
gr54x:
  v_subrev_u32 v165, 2560, v16
  s_lshl_b32 s64, s24, 9
  v_subrev_u32 v164, s64, v165
  v_add_f32 v168, v168, v170
  v_add_f32 v172, v172, v174
  v_add_f32 v168, v168, v172
  v_cvt_pk_bf16_f32 v12, v168, v168
  v_and_b32 v12, 0xffff0000, v12
  v_sub_f32 v168, v168, v12
  v_cvt_pk_bf16_f32 v168, v12, v168
  ds_write_b32 v165, v168 offset:0
  v_add_f32 v176, v176, v178
  v_add_f32 v180, v180, v182
  v_add_f32 v176, v176, v180
  v_cvt_pk_bf16_f32 v12, v176, v176
  v_and_b32 v12, 0xffff0000, v12
  v_sub_f32 v176, v176, v12
  v_cvt_pk_bf16_f32 v176, v12, v176
  ds_write_b32 v164, v176 offset:1024
  v_mov_b32 v12, 2
  ds_write_b32 v16, v12 offset:2048
  buffer_load_dword v15, v7, s[28:31], 0 offen sc1
  s_lshl2_add_u32 s67, s22, s27
  s_lshl_b32 s8, s67, 15
  s_add_u32 s8, s8, 0x1600000
  s_lshl_b32 s9, s67, 11
  s_add_u32 s9, s9, 0x1700000
  v_lshlrev_b32 v24, 4, v1
  s_and_b32 s66, s67, 30
  s_lshl_b32 s66, s66, 17
  s_add_u32 s66, s66, 0x1000000
  v_and_b32 v25, 48, v1
  v_lshl_add_u32 v25, v25, 4, v24
  s_lshl_b32 s64, s27, 11
  s_add_u32 s64, s64, 57344
  v_add_u32 v25, s64, v25
  s_and_b32 s64, s64, 0xfffff7ff
  v_add_u32 v26, s64, v24
  v_and_b32 v12, 56, v1
  v_lshl_add_u32 v24, v12, 4, v24
  s_lshl_b32 s3, s67, 11
  s_add_u32 s3, s3, 0xc00000
  s_add_u32 s64, s12, 0
  s_waitcnt vmcnt(0)
  v_subrev_u32 v14, s64, v15
  v_cmp_lt_u32 vcc, 7, v14
  s_nop 1
  s_cbranch_vccnz pb55
pb55x:
  ds_read_b64_tr_b16 v[96:97], v4 offset:32768
  ds_read_b64_tr_b16 v[98:99], v4 offset:33792
  ds_read_b64_tr_b16 v[100:101], v5 offset:32768
  ds_read_b64_tr_b16 v[102:103], v5 offset:33792
  ds_read_b64_tr_b16 v[104:105], v4 offset:40960
  ds_read_b64_tr_b16 v[106:107], v4 offset:41984
  ds_read_b64_tr_b16 v[108:109], v5 offset:40960
  ds_read_b64_tr_b16 v[110:111], v5 offset:41984
  ds_read_b64_tr_b16 v[112:113], v4 offset:49152
  ds_read_b64_tr_b16 v[114:115], v4 offset:50176
  ds_read_b64_tr_b16 v[116:117], v5 offset:49152
  ds_read_b64_tr_b16 v[118:119], v5 offset:50176
  ds_read_b64_tr_b16 v[120:121], v4 offset:57344
  ds_read_b64_tr_b16 v[122:123], v4 offset:58368
  ds_read_b64_tr_b16 v[124:125], v5 offset:57344
  ds_read_b64_tr_b16 v[126:127], v5 offset:58368
  s_waitcnt lgkmcnt(12)
  s_add_u32 m0, s6, 32768
  s_add_u32 s7, s44, 16384
  buffer_load_dwordx4 v2, s[48:51], s7 offen lds
  s_add_u32 m0, s6, 33792
  s_add_u32 s7, s44, 24576
  buffer_load_dwordx4 v2, s[48:51], s7 offen lds
  s_waitcnt lgkmcnt(8)
  s_add_u32 m0, s6, 40960
  s_add_u32 s7, s45, 16384
  buffer_load_dwordx4 v2, s[48:51], s7 offen lds
  s_add_u32 m0, s6, 41984
  s_add_u32 s7, s45, 24576
  buffer_load_dwordx4 v2, s[48:51], s7 offen lds
  s_waitcnt lgkmcnt(4)
  s_add_u32 m0, s6, 49152
  s_add_u32 s7, s46, 16384
  buffer_load_dwordx4 v2, s[48:51], s7 offen lds
  s_add_u32 m0, s6, 50176
  s_add_u32 s7, s46, 24576
  buffer_load_dwordx4 v2, s[48:51], s7 offen lds
  s_waitcnt lgkmcnt(0)
  s_add_u32 m0, s6, 57344
  s_add_u32 s7, s10, 16384
  buffer_load_dwordx4 v2, s[48:51], s7 offen lds
  s_add_u32 m0, s6, 58368
  s_add_u32 s7, s10, 24576
  buffer_load_dwordx4 v2, s[48:51], s7 offen lds
  ds_read_b32 v14, v17 offset:1024
  s_waitcnt lgkmcnt(0)
  v_cmp_gt_u32 vcc, 5, v14
  s_nop 1
  s_cbranch_vccnz lw56
lw56x:
  s_add_u32 m0, s6, 0
  s_add_u32 s7, s13, 0
  buffer_load_dwordx4 v2, s[52:55], s7 offen lds
  s_add_u32 m0, s6, 1024
  s_add_u32 s7, s13, 8192
  buffer_load_dwordx4 v2, s[52:55], s7 offen lds
  s_add_u32 m0, s6, 8192
  s_add_u32 s7, s13, 16384
  buffer_load_dwordx4 v2, s[52:55], s7 offen lds
  s_add_u32 m0, s6, 9216
  s_add_u32 s7, s13, 24576
  buffer_load_dwordx4 v2, s[52:55], s7 offen lds
  s_add_u32 m0, s6, 16384
  s_add_u32 s7, s13, 32768
  buffer_load_dwordx4 v2, s[52:55], s7 offen lds
  s_add_u32 m0, s6, 17408
  s_add_u32 s7, s13, 40960
  buffer_load_dwordx4 v2, s[52:55], s7 offen lds
  s_add_u32 m0, s6, 24576
  s_add_u32 s7, s13, 49152
  buffer_load_dwordx4 v2, s[52:55], s7 offen lds
  s_add_u32 m0, s6, 25600
  s_add_u32 s7, s13, 57344
  buffer_load_dwordx4 v2, s[52:55], s7 offen lds
  s_waitcnt vmcnt(14)
  ds_read_b64_tr_b16 v[128:129], v4 offset:32768
  ds_read_b64_tr_b16 v[130:131], v4 offset:33792
  ds_read_b64_tr_b16 v[132:133], v5 offset:32768
  ds_read_b64_tr_b16 v[134:135], v5 offset:33792
  s_waitcnt vmcnt(12)
  ds_read_b64_tr_b16 v[136:137], v4 offset:40960
  ds_read_b64_tr_b16 v[138:139], v4 offset:41984
  ds_read_b64_tr_b16 v[140:141], v5 offset:40960
  ds_read_b64_tr_b16 v[142:143], v5 offset:41984
  s_waitcnt lgkmcnt(4)
  s_add_u32 m0, s6, 32768
  s_add_u32 s7, s44, 32768
  buffer_load_dwordx4 v2, s[48:51], s7 offen lds
  s_add_u32 m0, s6, 33792
  s_add_u32 s7, s44, 40960
  buffer_load_dwordx4 v2, s[48:51], s7 offen lds
  s_waitcnt vmcnt(12)
  ds_read_b64_tr_b16 v[144:145], v4 offset:49152
  ds_read_b64_tr_b16 v[146:147], v4 offset:50176
  ds_read_b64_tr_b16 v[148:149], v5 offset:49152
  ds_read_b64_tr_b16 v[150:151], v5 offset:50176
  s_waitcnt lgkmcnt(4)
  s_add_u32 m0, s6, 40960
  s_add_u32 s7, s45, 32768
  buffer_load_dwordx4 v2, s[48:51], s7 offen lds
  s_add_u32 m0, s6, 41984
  s_add_u32 s7, s45, 40960
  buffer_load_dwordx4 v2, s[48:51], s7 offen lds
  s_waitcnt vmcnt(12)
  ds_read_b64_tr_b16 v[152:153], v4 offset:57344
  ds_read_b64_tr_b16 v[154:155], v4 offset:58368
  ds_read_b64_tr_b16 v[156:157], v5 offset:57344
  ds_read_b64_tr_b16 v[158:159], v5 offset:58368
  s_waitcnt lgkmcnt(4)
  s_add_u32 m0, s6, 49152
  s_add_u32 s7, s46, 32768
  buffer_load_dwordx4 v2, s[48:51], s7 offen lds
  s_add_u32 m0, s6, 50176
  s_add_u32 s7, s46, 40960
  buffer_load_dwordx4 v2, s[48:51], s7 offen lds
  s_waitcnt lgkmcnt(0)
  s_add_u32 m0, s6, 57344
  s_add_u32 s7, s47, 32768
  buffer_load_dwordx4 v2, s[48:51], s7 offen lds
  s_add_u32 m0, s6, 58368
  s_add_u32 s7, s47, 40960
  buffer_load_dwordx4 v2, s[48:51], s7 offen lds
  s_load_dword s36, s[70:71], s3 offset:0 glc
  s_load_dword s37, s[70:71], s3 offset:128 glc
  s_load_dword s38, s[70:71], s3 offset:256 glc
  s_load_dword s39, s[70:71], s3 offset:384 glc
  s_load_dword s40, s[70:71], s3 offset:512 glc
  s_load_dword s41, s[70:71], s3 offset:640 glc
  s_load_dword s42, s[70:71], s3 offset:768 glc
  s_load_dword s43, s[70:71], s3 offset:896 glc
  s_load_dword s56, s[70:71], s3 offset:1024 glc
  s_load_dword s57, s[70:71], s3 offset:1152 glc
  s_load_dword s58, s[70:71], s3 offset:1280 glc
  s_load_dword s59, s[70:71], s3 offset:1408 glc
  s_load_dword s0, s[70:71], s3 offset:1536 glc
  s_load_dword s1, s[70:71], s3 offset:1664 glc
  s_load_dword s18, s[70:71], s3 offset:1792 glc
  s_load_dword s19, s[70:71], s3 offset:1920 glc
  s_waitcnt lgkmcnt(0)
  s_xor_b64 s[36:37], s[36:37], s[100:101]
  s_xor_b64 s[38:39], s[38:39], s[100:101]
  s_xor_b64 s[40:41], s[40:41], s[100:101]
  s_xor_b64 s[42:43], s[42:43], s[100:101]
  s_xor_b64 s[56:57], s[56:57], s[100:101]
  s_xor_b64 s[58:59], s[58:59], s[100:101]
  s_xor_b64 s[0:1], s[0:1], s[100:101]
  s_xor_b64 s[18:19], s[18:19], s[100:101]
  s_or_b64 s[36:37], s[36:37], s[38:39]
  s_or_b64 s[36:37], s[36:37], s[40:41]
  s_or_b64 s[36:37], s[36:37], s[42:43]
  s_or_b64 s[36:37], s[36:37], s[56:57]
  s_or_b64 s[36:37], s[36:37], s[58:59]
  s_or_b64 s[36:37], s[36:37], s[0:1]
  s_or_b64 s[36:37], s[36:37], s[18:19]
  s_cbranch_scc1 sf57
sf57x:
  buffer_load_dwordx4 v[80:83], v24, s[28:31], s9 offen sc1
  buffer_load_dwordx2 v[254:255], v24, s[28:31], s8 offen offset:0 sc1
  buffer_load_dwordx2 v[192:193], v24, s[28:31], s8 offen offset:8 sc1
  buffer_load_dwordx4 v[194:197], v24, s[28:31], s8 offen offset:2048 sc1
  s_add_u32 s64, s8, 4096
  buffer_load_dwordx4 v[198:201], v24, s[28:31], s64 offen offset:0 sc1
  buffer_load_dwordx4 v[202:205], v24, s[28:31], s64 offen offset:2048 sc1
  s_add_u32 s64, s8, 8192
  buffer_load_dwordx4 v[206:209], v24, s[28:31], s64 offen offset:0 sc1
  buffer_load_dwordx4 v[210:213], v24, s[28:31], s64 offen offset:2048 sc1
  s_add_u32 s64, s8, 12288
  buffer_load_dwordx4 v[214:217], v24, s[28:31], s64 offen offset:0 sc1
  buffer_load_dwordx4 v[218:221], v24, s[28:31], s64 offen offset:2048 sc1
  s_add_u32 s64, s8, 16384
  buffer_load_dwordx4 v[222:225], v24, s[28:31], s64 offen offset:0 sc1
  buffer_load_dwordx4 v[226:229], v24, s[28:31], s64 offen offset:2048 sc1
  s_add_u32 s64, s8, 20480
  buffer_load_dwordx4 v[230:233], v24, s[28:31], s64 offen offset:0 sc1
  buffer_load_dwordx4 v[234:237], v24, s[28:31], s64 offen offset:2048 sc1
  s_add_u32 s64, s8, 24576
  buffer_load_dwordx4 v[238:241], v24, s[28:31], s64 offen offset:0 sc1
  buffer_load_dwordx4 v[242:245], v24, s[28:31], s64 offen offset:2048 sc1
  s_add_u32 s64, s8, 28672
  buffer_load_dwordx4 v[246:249], v24, s[28:31], s64 offen offset:0 sc1
  buffer_load_dwordx4 v[250:253], v24, s[28:31], s64 offen offset:2048 sc1
  s_waitcnt vmcnt(24)
  ds_read_b64_tr_b16 v[160:161], v4 offset:32768
  ds_read_b64_tr_b16 v[162:163], v4 offset:33792
  ds_read_b64_tr_b16 v[164:165], v5 offset:32768
  ds_read_b64_tr_b16 v[166:167], v5 offset:33792
  s_waitcnt vmcnt(22)
  ds_read_b64_tr_b16 v[168:169], v4 offset:40960
  ds_read_b64_tr_b16 v[170:171], v4 offset:41984
  ds_read_b64_tr_b16 v[172:173], v5 offset:40960
  ds_read_b64_tr_b16 v[174:175], v5 offset:41984
  s_waitcnt vmcnt(20)
  ds_read_b64_tr_b16 v[176:177], v4 offset:49152
  ds_read_b64_tr_b16 v[178:179], v4 offset:50176
  ds_read_b64_tr_b16 v[180:181], v5 offset:49152
  ds_read_b64_tr_b16 v[182:183], v5 offset:50176
  s_waitcnt vmcnt(18)
  ds_read_b64_tr_b16 v[184:185], v4 offset:57344
  ds_read_b64_tr_b16 v[186:187], v4 offset:58368
  ds_read_b64_tr_b16 v[188:189], v5 offset:57344
  ds_read_b64_tr_b16 v[190:191], v5 offset:58368
  s_waitcnt vmcnt(17)
  v_max3_u32 v12, v80, v81, v82
  v_max_u32 v12, v12, v83
  v_cmp_eq_u32 vcc, -1, v12
  s_nop 1
  s_cbranch_vccnz vf58
vf58x:
  s_setprio 3
  s_waitcnt lgkmcnt(0)
  s_add_u32 m0, s6, 32768
  s_add_u32 s7, s13, 65536
  buffer_load_dwordx4 v2, s[52:55], s7 offen lds
  s_add_u32 m0, s6, 33792
  s_add_u32 s7, s13, 73728
  buffer_load_dwordx4 v2, s[52:55], s7 offen lds
  s_add_u32 m0, s6, 40960
  s_add_u32 s7, s13, 81920
  buffer_load_dwordx4 v2, s[52:55], s7 offen lds
  s_add_u32 m0, s6, 41984
  s_add_u32 s7, s13, 90112
  buffer_load_dwordx4 v2, s[52:55], s7 offen lds
  s_add_u32 m0, s6, 49152
  s_add_u32 s7, s13, 98304
  buffer_load_dwordx4 v2, s[52:55], s7 offen lds
  s_add_u32 m0, s6, 50176
  s_add_u32 s7, s13, 106496
  buffer_load_dwordx4 v2, s[52:55], s7 offen lds
  s_add_u32 m0, s6, 57344
  s_add_u32 s7, s13, 114688
  buffer_load_dwordx4 v2, s[52:55], s7 offen lds
  s_add_u32 m0, s6, 58368
  s_add_u32 s7, s13, 122880
  buffer_load_dwordx4 v2, s[52:55], s7 offen lds
  v_lshlrev_b32 v88, 16, v80
  v_and_b32 v89, 0xffff0000, v80
  v_lshlrev_b32 v90, 16, v81
  v_and_b32 v91, 0xffff0000, v81
  v_lshlrev_b32 v92, 16, v82
  v_and_b32 v93, 0xffff0000, v82
  v_lshlrev_b32 v94, 16, v83
  v_and_b32 v95, 0xffff0000, v83
  v_add_f32_dpp v88, v88, v88 row_ror:8 row_mask:0xf bank_mask:0xf
  v_add_f32_dpp v89, v89, v89 row_ror:8 row_mask:0xf bank_mask:0xf
  v_add_f32_dpp v90, v90, v90 row_ror:8 row_mask:0xf bank_mask:0xf
  v_add_f32_dpp v91, v91, v91 row_ror:8 row_mask:0xf bank_mask:0xf
  v_add_f32_dpp v92, v92, v92 row_ror:8 row_mask:0xf bank_mask:0xf
  v_add_f32_dpp v93, v93, v93 row_ror:8 row_mask:0xf bank_mask:0xf
  v_add_f32_dpp v94, v94, v94 row_ror:8 row_mask:0xf bank_mask:0xf
  v_add_f32_dpp v95, v95, v95 row_ror:8 row_mask:0xf bank_mask:0xf
  v_add_f32_dpp v88, v88, v88 row_ror:4 row_mask:0xf bank_mask:0xf
  v_add_f32_dpp v89, v89, v89 row_ror:4 row_mask:0xf bank_mask:0xf
  v_add_f32_dpp v90, v90, v90 row_ror:4 row_mask:0xf bank_mask:0xf
  v_add_f32_dpp v91, v91, v91 row_ror:4 row_mask:0xf bank_mask:0xf
  v_add_f32_dpp v92, v92, v92 row_ror:4 row_mask:0xf bank_mask:0xf
  v_add_f32_dpp v93, v93, v93 row_ror:4 row_mask:0xf bank_mask:0xf
  v_add_f32_dpp v94, v94, v94 row_ror:4 row_mask:0xf bank_mask:0xf
  v_add_f32_dpp v95, v95, v95 row_ror:4 row_mask:0xf bank_mask:0xf
  v_add_f32_dpp v88, v88, v88 row_ror:2 row_mask:0xf bank_mask:0xf
  v_add_f32_dpp v89, v89, v89 row_ror:2 row_mask:0xf bank_mask:0xf
  v_add_f32_dpp v90, v90, v90 row_ror:2 row_mask:0xf bank_mask:0xf
  v_add_f32_dpp v91, v91, v91 row_ror:2 row_mask:0xf bank_mask:0xf
  v_add_f32_dpp v92, v92, v92 row_ror:2 row_mask:0xf bank_mask:0xf
  v_add_f32_dpp v93, v93, v93 row_ror:2 row_mask:0xf bank_mask:0xf
  v_add_f32_dpp v94, v94, v94 row_ror:2 row_mask:0xf bank_mask:0xf
  v_add_f32_dpp v95, v95, v95 row_ror:2 row_mask:0xf bank_mask:0xf
  v_add_f32_dpp v88, v88, v88 row_ror:1 row_mask:0xf bank_mask:0xf
  v_add_f32_dpp v89, v89, v89 row_ror:1 row_mask:0xf bank_mask:0xf
  v_add_f32_dpp v90, v90, v90 row_ror:1 row_mask:0xf bank_mask:0xf
  v_add_f32_dpp v91, v91, v91 row_ror:1 row_mask:0xf bank_mask:0xf
  v_add_f32_dpp v92, v92, v92 row_ror:1 row_mask:0xf bank_mask:0xf
  v_add_f32_dpp v93, v93, v93 row_ror:1 row_mask:0xf bank_mask:0xf
  v_add_f32_dpp v94, v94, v94 row_ror:1 row_mask:0xf bank_mask:0xf
  v_add_f32_dpp v95, v95, v95 row_ror:1 row_mask:0xf bank_mask:0xf
  v_cvt_pk_bf16_f32 v88, v88, v89
  v_cvt_pk_bf16_f32 v89, v90, v91
  v_cvt_pk_bf16_f32 v90, v92, v93
  v_cvt_pk_bf16_f32 v91, v94, v95
  ds_read_b32 v14, v17 offset:1024
  s_waitcnt vmcnt(22)
  v_mfma_f32_16x16x32_bf16 v[68:71], v[28:31], v[192:195], 0
  s_waitcnt vmcnt(21)
  v_mfma_f32_16x16x32_bf16 v[64:67], v[28:31], v[196:199], 0
  v_max3_u32 v12, v192, v193, v194
  v_max3_u32 v13, v195, v196, v197
  s_waitcnt vmcnt(20)
  v_mfma_f32_16x16x32_bf16 v[68:71], v[28:31], v[200:203], v[68:71]
  v_max3_u32 v12, v12, v198, v199
  v_max3_u32 v13, v13, v200, v201
  s_waitcnt vmcnt(19)
  v_mfma_f32_16x16x32_bf16 v[64:67], v[28:31], v[204:207], v[64:67]
  v_max3_u32 v12, v12, v202, v203
  v_max3_u32 v13, v13, v204, v205
  s_waitcnt vmcnt(18)
  v_mfma_f32_16x16x32_bf16 v[68:71], v[28:31], v[208:211], v[68:71]
  v_max3_u32 v12, v12, v206, v207
  v_max3_u32 v13, v13, v208, v209
  s_waitcnt vmcnt(17)
  v_mfma_f32_16x16x32_bf16 v[64:67], v[28:31], v[212:215], v[64:67]
  v_max3_u32 v12, v12, v210, v211
  v_max3_u32 v13, v13, v212, v213
  s_waitcnt vmcnt(16)
  v_mfma_f32_16x16x32_bf16 v[68:71], v[28:31], v[216:219], v[68:71]
  v_max3_u32 v12, v12, v214, v215
  v_max3_u32 v13, v13, v216, v217
  s_waitcnt vmcnt(15)
  v_mfma_f32_16x16x32_bf16 v[64:67], v[28:31], v[220:223], v[64:67]
  v_max3_u32 v12, v12, v218, v219
  v_max3_u32 v13, v13, v220, v221
  s_waitcnt vmcnt(14)
  v_mfma_f32_16x16x32_bf16 v[68:71], v[28:31], v[224:227], v[68:71]
  v_max3_u32 v12, v12, v222, v223
  v_max3_u32 v13, v13, v224, v225
  s_waitcnt vmcnt(13)
  v_mfma_f32_16x16x32_bf16 v[64:67], v[28:31], v[228:231], v[64:67]
  v_max3_u32 v12, v12, v226, v227
  v_max3_u32 v13, v13, v228, v229
  s_waitcnt vmcnt(12)
  v_mfma_f32_16x16x32_bf16 v[68:71], v[28:31], v[232:235], v[68:71]
  v_max3_u32 v12, v12, v230, v231
  v_max3_u32 v13, v13, v232, v233
  s_waitcnt vmcnt(11)
  v_mfma_f32_16x16x32_bf16 v[64:67], v[28:31], v[236:239], v[64:67]
  v_max3_u32 v12, v12, v234, v235
  v_max3_u32 v13, v13, v236, v237
  s_waitcnt vmcnt(10)
  v_mfma_f32_16x16x32_bf16 v[68:71], v[28:31], v[240:243], v[68:71]
  v_max3_u32 v12, v12, v238, v239
  v_max3_u32 v13, v13, v240, v241
  s_waitcnt vmcnt(9)
  v_mfma_f32_16x16x32_bf16 v[64:67], v[28:31], v[244:247], v[64:67]
  v_max3_u32 v12, v12, v242, v243
  v_max3_u32 v13, v13, v244, v245
  s_waitcnt vmcnt(8)
  v_mfma_f32_16x16x32_bf16 v[68:71], v[28:31], v[248:251], v[68:71]
  v_max3_u32 v12, v12, v246, v247
  v_max3_u32 v13, v13, v248, v249
  v_mfma_f32_16x16x32_bf16 v[64:67], v[28:31], v[252:255], v[64:67]
  v_max3_u32 v12, v12, v250, v251
  v_max3_u32 v13, v13, v252, v253
  v_max3_u32 v12, v12, v254, v255
  v_max_u32 v12, v12, v13
  v_cmp_eq_u32 vcc, -1, v12
  s_nop 1
  s_cbranch_vccnz vf59
vf59x:
  s_waitcnt lgkmcnt(0)
  v_cmp_gt_u32 vcc, 5, v14
  s_nop 1
  s_cbranch_vccnz lw60
lw60x:
  v_and_b32 v13, 1, v1
  s_and_b32 s64, s27, 2
  v_or_b32 v13, s64, v13
  v_mul_u32_u24 v13, 260, v13
  v_add_u32 v17, 160640, v13
  v_cvt_pk_bf16_f32 v64, v64, v65
  v_cvt_pk_bf16_f32 v65, v66, v67
  v_cvt_pk_bf16_f32 v66, v68, v69
  v_cvt_pk_bf16_f32 v67, v70, v71
  ds_write_b128 v25, v[88:91] offset:256
  ds_write_b128 v25, v[64:67]
  v_mov_b32 v12, 3
  ds_write_b32 v16, v12 offset:2048
  ds_read_b32 v14, v17 offset:2048
  s_waitcnt lgkmcnt(0)
  v_cmp_gt_u32 vcc, 3, v14
  s_nop 1
  s_cbranch_vccnz lw61
lw61x:
  ds_read_b128 v[64:67], v26 offset:0
  ds_read_b128 v[68:71], v26 offset:1024
  ds_read_b128 v[72:75], v26 offset:2048
  ds_read_b128 v[76:79], v26 offset:3072
  v_mov_b32 v12, 4
  ds_write_b32 v16, v12 offset:2048
  v_mov_b32 v24, s12
  s_waitcnt lgkmcnt(4)
  v_mfma_f32_32x32x16_bf16 v[192:207], v[64:67], v[32:35], 0
  s_waitcnt lgkmcnt(3)
  v_mfma_f32_32x32x16_bf16 v[192:207], v[68:71], v[36:39], v[192:207]
  s_waitcnt lgkmcnt(2)
  v_mfma_f32_32x32x16_bf16 v[208:223], v[72:75], v[40:43], 0
  s_waitcnt lgkmcnt(1)
  v_mfma_f32_32x32x16_bf16 v[208:223], v[76:79], v[44:47], v[208:223]
  s_nop 7
  v_add_f32 v200, 0x358637bd, v200
  v_rcp_f32 v200, v200
  v_mfma_f32_32x32x16_bf16 v[224:239], v[64:67], v[48:51], 0
  v_mul_f32 v192, v192, v200
  v_mul_f32 v193, v193, v200
  v_mul_f32 v194, v194, v200
  v_mul_f32 v195, v195, v200
  v_mul_f32 v196, v196, v200
  v_mul_f32 v197, v197, v200
  v_mfma_f32_32x32x16_bf16 v[224:239], v[68:71], v[52:55], v[224:239]
  v_mul_f32 v198, v198, v200
  v_mul_f32 v199, v199, v200
  v_cvt_pk_bf16_f32 v80, v192, v193
  v_cvt_pk_bf16_f32 v81, v194, v195
  v_cvt_pk_bf16_f32 v82, v196, v197
  v_cvt_pk_bf16_f32 v83, v198, v199
  s_add_u32 s64, s66, 0
  buffer_store_dwordx4 v[80:83], v18, s[28:31], s64 offen offset:0 sc1
  s_load_dword s36, s[70:71], s68 offset:0 glc
  s_load_dword s37, s[70:71], s68 offset:128 glc
  s_load_dword s38, s[70:71], s68 offset:256 glc
  s_load_dword s39, s[70:71], s68 offset:384 glc
  s_load_dword s40, s[70:71], s68 offset:512 glc
  s_load_dword s41, s[70:71], s68 offset:640 glc
  s_load_dword s42, s[70:71], s68 offset:768 glc
  s_load_dword s43, s[70:71], s68 offset:896 glc
  v_add_f32 v216, 0x358637bd, v216
  v_rcp_f32 v216, v216
  v_mfma_f32_32x32x16_bf16 v[240:255], v[72:75], v[56:59], 0
  v_mul_f32 v208, v208, v216
  v_mul_f32 v209, v209, v216
  v_mul_f32 v210, v210, v216
  v_mul_f32 v211, v211, v216
  v_mul_f32 v212, v212, v216
  v_mul_f32 v213, v213, v216
  v_mfma_f32_32x32x16_bf16 v[240:255], v[76:79], v[60:63], v[240:255]
  v_mul_f32 v214, v214, v216
  v_mul_f32 v215, v215, v216
  v_cvt_pk_bf16_f32 v84, v208, v209
  v_cvt_pk_bf16_f32 v85, v210, v211
  v_cvt_pk_bf16_f32 v86, v212, v213
  v_cvt_pk_bf16_f32 v87, v214, v215
  s_add_u32 s64, s66, 131072
  buffer_store_dwordx4 v[84:87], v18, s[28:31], s64 offen offset:0 sc1
  v_add_f32 v232, 0x358637bd, v232
  v_rcp_f32 v232, v232
  s_nop 0
  v_mul_f32 v224, v224, v232
  v_mul_f32 v225, v225, v232
  v_mul_f32 v226, v226, v232
  v_mul_f32 v227, v227, v232
  v_mul_f32 v228, v228, v232
  v_mul_f32 v229, v229, v232
  v_mul_f32 v230, v230, v232
  v_mul_f32 v231, v231, v232
  v_cvt_pk_bf16_f32 v88, v224, v225
  v_cvt_pk_bf16_f32 v89, v226, v227
  v_cvt_pk_bf16_f32 v90, v228, v229
  v_cvt_pk_bf16_f32 v91, v230, v231
  s_add_u32 s64, s66, 0
  buffer_store_dwordx4 v[88:91], v18, s[28:31], s64 offen offset:2048 sc1
  v_add_f32 v248, 0x358637bd, v248
  v_rcp_f32 v248, v248
  s_nop 0
  v_mul_f32 v240, v240, v248
  v_mul_f32 v241, v241, v248
  v_mul_f32 v242, v242, v248
  v_mul_f32 v243, v243, v248
  v_mul_f32 v244, v244, v248
  v_mul_f32 v245, v245, v248
  v_mul_f32 v246, v246, v248
  v_mul_f32 v247, v247, v248
  v_cvt_pk_bf16_f32 v92, v240, v241
  v_cvt_pk_bf16_f32 v93, v242, v243
  v_cvt_pk_bf16_f32 v94, v244, v245
  v_cvt_pk_bf16_f32 v95, v246, v247
  s_add_u32 s64, s66, 131072
  buffer_store_dwordx4 v[92:95], v18, s[28:31], s64 offen offset:2048 sc1
  s_waitcnt lgkmcnt(0)
  s_xor_b64 s[36:37], s[36:37], s[100:101]
  s_xor_b64 s[38:39], s[38:39], s[100:101]
  s_xor_b64 s[40:41], s[40:41], s[100:101]
  s_xor_b64 s[42:43], s[42:43], s[100:101]
  s_or_b64 s[36:37], s[36:37], s[38:39]
  s_or_b64 s[36:37], s[36:37], s[40:41]
  s_or_b64 s[36:37], s[36:37], s[42:43]
  s_cbranch_scc1 sf62
sf62x:
  s_lshl3_add_u32 s64, s44, 0x0
  buffer_load_dwordx4 v[192:195], v3, s[32:35], s64 offen offset:0 sc1
  buffer_load_dwordx4 v[196:199], v3, s[32:35], s64 offen offset:2048 sc1
  s_lshl3_add_u32 s64, s45, 0x0
  buffer_load_dwordx4 v[200:203], v3, s[32:35], s64 offen offset:0 sc1
  buffer_load_dwordx4 v[204:207], v3, s[32:35], s64 offen offset:2048 sc1
  s_lshl3_add_u32 s64, s46, 0x0
  buffer_load_dwordx4 v[208:211], v3, s[32:35], s64 offen offset:0 sc1
  buffer_load_dwordx4 v[212:215], v3, s[32:35], s64 offen offset:2048 sc1
  s_lshl3_add_u32 s64, s10, 0x0
  buffer_load_dwordx4 v[216:219], v3, s[32:35], s64 offen offset:0 sc1
  buffer_load_dwordx4 v[220:223], v3, s[32:35], s64 offen offset:2048 sc1
  s_lshl3_add_u32 s64, s44, 0x20000
  buffer_load_dwordx4 v[224:227], v3, s[32:35], s64 offen offset:0 sc1
  buffer_load_dwordx4 v[228:231], v3, s[32:35], s64 offen offset:2048 sc1
  s_lshl3_add_u32 s64, s45, 0x20000
  buffer_load_dwordx4 v[232:235], v3, s[32:35], s64 offen offset:0 sc1
  buffer_load_dwordx4 v[236:239], v3, s[32:35], s64 offen offset:2048 sc1
  s_lshl3_add_u32 s64, s46, 0x20000
  buffer_load_dwordx4 v[240:243], v3, s[32:35], s64 offen offset:0 sc1
  buffer_load_dwordx4 v[244:247], v3, s[32:35], s64 offen offset:2048 sc1
  s_lshl3_add_u32 s64, s10, 0x20000
  buffer_load_dwordx4 v[248:251], v3, s[32:35], s64 offen offset:0 sc1
  buffer_load_dwordx4 v[252:255], v3, s[32:35], s64 offen offset:2048 sc1
  s_waitcnt vmcnt(16)
  s_mov_b64 exec, 1
  buffer_store_dword v24, off, s[28:31], s69 offset:2048 sc1
  s_mov_b64 exec, -1
  s_setprio 0
  s_waitcnt vmcnt(16)
  v_mfma_f32_32x32x16_bf16 v[32:47], v[96:99], v[192:195], 0
  v_mfma_f32_32x32x16_bf16 v[48:63], v[100:103], v[192:195], 0
  s_waitcnt vmcnt(15)
  v_mfma_f32_32x32x16_bf16 v[80:95], v[100:103], v[196:199], 0
  v_mfma_f32_32x32x16_bf16 v[64:79], v[96:99], v[196:199], 0
  s_lshl3_add_u32 s64, s44, 0x40000
  buffer_load_dwordx4 v[192:195], v3, s[32:35], s64 offen offset:0 sc1
  buffer_load_dwordx4 v[196:199], v3, s[32:35], s64 offen offset:2048 sc1
  ds_read_b64_tr_b16 v[96:97], v4 offset:0
  ds_read_b64_tr_b16 v[98:99], v4 offset:1024
  ds_read_b64_tr_b16 v[100:101], v5 offset:0
  ds_read_b64_tr_b16 v[102:103], v5 offset:1024
  s_waitcnt vmcnt(16)
  v_mfma_f32_32x32x16_bf16 v[32:47], v[104:107], v[200:203], v[32:47]
  v_mfma_f32_32x32x16_bf16 v[48:63], v[108:111], v[200:203], v[48:63]
  s_waitcnt vmcnt(15)
  v_mfma_f32_32x32x16_bf16 v[80:95], v[108:111], v[204:207], v[80:95]
  v_mfma_f32_32x32x16_bf16 v[64:79], v[104:107], v[204:207], v[64:79]
  s_lshl3_add_u32 s64, s45, 0x40000
  buffer_load_dwordx4 v[200:203], v3, s[32:35], s64 offen offset:0 sc1
  buffer_load_dwordx4 v[204:207], v3, s[32:35], s64 offen offset:2048 sc1
  ds_read_b64_tr_b16 v[104:105], v4 offset:8192
  ds_read_b64_tr_b16 v[106:107], v4 offset:9216
  ds_read_b64_tr_b16 v[108:109], v5 offset:8192
  ds_read_b64_tr_b16 v[110:111], v5 offset:9216
  s_waitcnt vmcnt(16)
  v_mfma_f32_32x32x16_bf16 v[32:47], v[112:115], v[208:211], v[32:47]
  v_mfma_f32_32x32x16_bf16 v[48:63], v[116:119], v[208:211], v[48:63]
  s_waitcnt vmcnt(15)
  v_mfma_f32_32x32x16_bf16 v[80:95], v[116:119], v[212:215], v[80:95]
  v_mfma_f32_32x32x16_bf16 v[64:79], v[112:115], v[212:215], v[64:79]
  s_lshl3_add_u32 s64, s46, 0x40000
  buffer_load_dwordx4 v[208:211], v3, s[32:35], s64 offen offset:0 sc1
  buffer_load_dwordx4 v[212:215], v3, s[32:35], s64 offen offset:2048 sc1
  ds_read_b64_tr_b16 v[112:113], v4 offset:16384
  ds_read_b64_tr_b16 v[114:115], v4 offset:17408
  ds_read_b64_tr_b16 v[116:117], v5 offset:16384
  ds_read_b64_tr_b16 v[118:119], v5 offset:17408
  s_waitcnt vmcnt(16)
  v_mfma_f32_32x32x16_bf16 v[32:47], v[120:123], v[216:219], v[32:47]
  v_mfma_f32_32x32x16_bf16 v[48:63], v[124:127], v[216:219], v[48:63]
  s_waitcnt vmcnt(15)
  v_mfma_f32_32x32x16_bf16 v[80:95], v[124:127], v[220:223], v[80:95]
  v_mfma_f32_32x32x16_bf16 v[64:79], v[120:123], v[220:223], v[64:79]
  s_lshl3_add_u32 s64, s47, 0x40000
  buffer_load_dwordx4 v[216:219], v3, s[32:35], s64 offen offset:0 sc1
  buffer_load_dwordx4 v[220:223], v3, s[32:35], s64 offen offset:2048 sc1
  ds_read_b64_tr_b16 v[120:121], v4 offset:24576
  ds_read_b64_tr_b16 v[122:123], v4 offset:25600
  ds_read_b64_tr_b16 v[124:125], v5 offset:24576
  ds_read_b64_tr_b16 v[126:127], v5 offset:25600
  s_waitcnt vmcnt(16)
  v_mfma_f32_32x32x16_bf16 v[32:47], v[128:131], v[224:227], v[32:47]
  v_mfma_f32_32x32x16_bf16 v[48:63], v[132:135], v[224:227], v[48:63]
  s_waitcnt vmcnt(15)
  v_mfma_f32_32x32x16_bf16 v[80:95], v[132:135], v[228:231], v[80:95]
  v_mfma_f32_32x32x16_bf16 v[64:79], v[128:131], v[228:231], v[64:79]
  ds_read_b64_tr_b16 v[128:129], v4 offset:32768
  ds_read_b64_tr_b16 v[130:131], v4 offset:33792
  ds_read_b64_tr_b16 v[132:133], v5 offset:32768
  ds_read_b64_tr_b16 v[134:135], v5 offset:33792
  s_waitcnt vmcnt(14)
  v_mfma_f32_32x32x16_bf16 v[32:47], v[136:139], v[232:235], v[32:47]
  v_mfma_f32_32x32x16_bf16 v[48:63], v[140:143], v[232:235], v[48:63]
  s_waitcnt vmcnt(13)
  v_mfma_f32_32x32x16_bf16 v[80:95], v[140:143], v[236:239], v[80:95]
  v_mfma_f32_32x32x16_bf16 v[64:79], v[136:139], v[236:239], v[64:79]
  ds_read_b64_tr_b16 v[136:137], v4 offset:40960
  ds_read_b64_tr_b16 v[138:139], v4 offset:41984
  ds_read_b64_tr_b16 v[140:141], v5 offset:40960
  ds_read_b64_tr_b16 v[142:143], v5 offset:41984
  s_waitcnt vmcnt(12)
  v_mfma_f32_32x32x16_bf16 v[32:47], v[144:147], v[240:243], v[32:47]
  v_mfma_f32_32x32x16_bf16 v[48:63], v[148:151], v[240:243], v[48:63]
  s_waitcnt vmcnt(11)
  v_mfma_f32_32x32x16_bf16 v[80:95], v[148:151], v[244:247], v[80:95]
  v_mfma_f32_32x32x16_bf16 v[64:79], v[144:147], v[244:247], v[64:79]
  ds_read_b64_tr_b16 v[144:145], v4 offset:49152
  ds_read_b64_tr_b16 v[146:147], v4 offset:50176
  ds_read_b64_tr_b16 v[148:149], v5 offset:49152
  ds_read_b64_tr_b16 v[150:151], v5 offset:50176
  s_load_dword s36, s[70:71], s68 offset:2048 glc
  s_load_dword s37, s[70:71], s68 offset:2176 glc
  s_load_dword s38, s[70:71], s68 offset:2304 glc
  s_load_dword s39, s[70:71], s68 offset:2432 glc
  s_waitcnt vmcnt(10)
  v_mfma_f32_32x32x16_bf16 v[32:47], v[152:155], v[248:251], v[32:47]
  v_mfma_f32_32x32x16_bf16 v[48:63], v[156:159], v[248:251], v[48:63]
  s_waitcnt vmcnt(9)
  v_mfma_f32_32x32x16_bf16 v[80:95], v[156:159], v[252:255], v[80:95]
  v_mfma_f32_32x32x16_bf16 v[64:79], v[152:155], v[252:255], v[64:79]
  ds_read_b64_tr_b16 v[152:153], v4 offset:57344
  ds_read_b64_tr_b16 v[154:155], v4 offset:58368
  ds_read_b64_tr_b16 v[156:157], v5 offset:57344
  ds_read_b64_tr_b16 v[158:159], v5 offset:58368
  s_waitcnt vmcnt(7)
  v_mfma_f32_32x32x16_bf16 v[32:47], v[160:163], v[192:195], v[32:47]
  v_mfma_f32_32x32x16_bf16 v[48:63], v[164:167], v[192:195], v[48:63]
  s_waitcnt vmcnt(6)
  v_mfma_f32_32x32x16_bf16 v[80:95], v[164:167], v[196:199], v[80:95]
  v_mfma_f32_32x32x16_bf16 v[64:79], v[160:163], v[196:199], v[64:79]
  s_waitcnt vmcnt(5)
  v_mfma_f32_32x32x16_bf16 v[32:47], v[168:171], v[200:203], v[32:47]
  v_mfma_f32_32x32x16_bf16 v[48:63], v[172:175], v[200:203], v[48:63]
  s_waitcnt vmcnt(4)
  v_mfma_f32_32x32x16_bf16 v[80:95], v[172:175], v[204:207], v[80:95]
  v_mfma_f32_32x32x16_bf16 v[64:79], v[168:171], v[204:207], v[64:79]
  s_waitcnt vmcnt(3)
  v_mfma_f32_32x32x16_bf16 v[32:47], v[176:179], v[208:211], v[32:47]
  v_mfma_f32_32x32x16_bf16 v[48:63], v[180:183], v[208:211], v[48:63]
  s_waitcnt vmcnt(2)
  v_mfma_f32_32x32x16_bf16 v[80:95], v[180:183], v[212:215], v[80:95]
  v_mfma_f32_32x32x16_bf16 v[64:79], v[176:179], v[212:215], v[64:79]
  s_waitcnt vmcnt(1)
  v_mfma_f32_32x32x16_bf16 v[32:47], v[184:187], v[216:219], v[32:47]
  v_mfma_f32_32x32x16_bf16 v[48:63], v[188:191], v[216:219], v[48:63]
  s_waitcnt vmcnt(0)
  v_mfma_f32_32x32x16_bf16 v[80:95], v[188:191], v[220:223], v[80:95]
  v_mfma_f32_32x32x16_bf16 v[64:79], v[184:187], v[220:223], v[64:79]
  s_waitcnt lgkmcnt(0)
  s_xor_b64 s[36:37], s[36:37], s[100:101]
  s_xor_b64 s[38:39], s[38:39], s[100:101]
  s_or_b64 s[36:37], s[36:37], s[38:39]
  s_cbranch_scc1 sf63
sf63x:
  s_lshl3_add_u32 s64, s13, 0x1000000
  buffer_load_dwordx4 v[224:227], v3, s[28:31], s64 offen offset:0 sc1
  buffer_load_dwordx4 v[228:231], v3, s[28:31], s64 offen offset:2048 sc1
  s_lshl3_add_u32 s64, s13, 0x1020000
  buffer_load_dwordx4 v[232:235], v3, s[28:31], s64 offen offset:0 sc1
  buffer_load_dwordx4 v[236:239], v3, s[28:31], s64 offen offset:2048 sc1
  s_lshl3_add_u32 s64, s13, 0x1040000
  buffer_load_dwordx4 v[240:243], v3, s[28:31], s64 offen offset:0 sc1
  buffer_load_dwordx4 v[244:247], v3, s[28:31], s64 offen offset:2048 sc1
  s_lshl3_add_u32 s64, s13, 0x1060000
  buffer_load_dwordx4 v[248:251], v3, s[28:31], s64 offen offset:0 sc1
  buffer_load_dwordx4 v[252:255], v3, s[28:31], s64 offen offset:2048 sc1
  s_lshl3_add_u32 s64, s13, 0x1080000
  buffer_load_dwordx4 v[192:195], v3, s[28:31], s64 offen offset:0 sc1
  buffer_load_dwordx4 v[196:199], v3, s[28:31], s64 offen offset:2048 sc1
  s_lshl3_add_u32 s64, s13, 0x10a0000
  buffer_load_dwordx4 v[200:203], v3, s[28:31], s64 offen offset:0 sc1
  buffer_load_dwordx4 v[204:207], v3, s[28:31], s64 offen offset:2048 sc1
  s_lshl3_add_u32 s64, s13, 0x10c0000
  buffer_load_dwordx4 v[208:211], v3, s[28:31], s64 offen offset:0 sc1
  buffer_load_dwordx4 v[212:215], v3, s[28:31], s64 offen offset:2048 sc1
  s_lshl3_add_u32 s64, s13, 0x10e0000
  buffer_load_dwordx4 v[216:219], v3, s[28:31], s64 offen offset:0 sc1
  buffer_load_dwordx4 v[220:223], v3, s[28:31], s64 offen offset:2048 sc1
  s_waitcnt vmcnt(15)
  v_mfma_f32_32x32x16_bf16 v[32:47], v[96:99], v[224:227], v[32:47]
  v_mfma_f32_32x32x16_bf16 v[48:63], v[100:103], v[224:227], v[48:63]
  s_waitcnt vmcnt(14)
  v_mfma_f32_32x32x16_bf16 v[80:95], v[100:103], v[228:231], v[80:95]
  v_mfma_f32_32x32x16_bf16 v[64:79], v[96:99], v[228:231], v[64:79]
  s_waitcnt vmcnt(13)
  v_mfma_f32_32x32x16_bf16 v[32:47], v[104:107], v[232:235], v[32:47]
  v_mfma_f32_32x32x16_bf16 v[48:63], v[108:111], v[232:235], v[48:63]
  s_waitcnt vmcnt(12)
  v_mfma_f32_32x32x16_bf16 v[80:95], v[108:111], v[236:239], v[80:95]
  v_mfma_f32_32x32x16_bf16 v[64:79], v[104:107], v[236:239], v[64:79]
  s_waitcnt vmcnt(11)
  v_mfma_f32_32x32x16_bf16 v[32:47], v[112:115], v[240:243], v[32:47]
  v_mfma_f32_32x32x16_bf16 v[48:63], v[116:119], v[240:243], v[48:63]
  s_waitcnt vmcnt(10)
  v_mfma_f32_32x32x16_bf16 v[80:95], v[116:119], v[244:247], v[80:95]
  v_mfma_f32_32x32x16_bf16 v[64:79], v[112:115], v[244:247], v[64:79]
  s_waitcnt vmcnt(9)
  v_mfma_f32_32x32x16_bf16 v[32:47], v[120:123], v[248:251], v[32:47]
  v_mfma_f32_32x32x16_bf16 v[48:63], v[124:127], v[248:251], v[48:63]
  s_waitcnt vmcnt(8)
  v_mfma_f32_32x32x16_bf16 v[80:95], v[124:127], v[252:255], v[80:95]
  v_mfma_f32_32x32x16_bf16 v[64:79], v[120:123], v[252:255], v[64:79]
  s_waitcnt vmcnt(7)
  v_mfma_f32_32x32x16_bf16 v[32:47], v[128:131], v[192:195], v[32:47]
  v_mfma_f32_32x32x16_bf16 v[48:63], v[132:135], v[192:195], v[48:63]
  s_waitcnt vmcnt(6)
  v_mfma_f32_32x32x16_bf16 v[80:95], v[132:135], v[196:199], v[80:95]
  v_mfma_f32_32x32x16_bf16 v[64:79], v[128:131], v[196:199], v[64:79]
  s_waitcnt vmcnt(5)
  v_mfma_f32_32x32x16_bf16 v[32:47], v[136:139], v[200:203], v[32:47]
  v_mfma_f32_32x32x16_bf16 v[48:63], v[140:143], v[200:203], v[48:63]
  s_waitcnt vmcnt(4)
  v_mfma_f32_32x32x16_bf16 v[80:95], v[140:143], v[204:207], v[80:95]
  v_mfma_f32_32x32x16_bf16 v[64:79], v[136:139], v[204:207], v[64:79]
  s_waitcnt vmcnt(3)
  v_mfma_f32_32x32x16_bf16 v[32:47], v[144:147], v[208:211], v[32:47]
  v_mfma_f32_32x32x16_bf16 v[48:63], v[148:151], v[208:211], v[48:63]
  s_waitcnt vmcnt(2)
  v_mfma_f32_32x32x16_bf16 v[80:95], v[148:151], v[212:215], v[80:95]
  v_mfma_f32_32x32x16_bf16 v[64:79], v[144:147], v[212:215], v[64:79]
  s_waitcnt vmcnt(1)
  v_mfma_f32_32x32x16_bf16 v[32:47], v[152:155], v[216:219], v[32:47]
  v_mfma_f32_32x32x16_bf16 v[48:63], v[156:159], v[216:219], v[48:63]
  s_waitcnt vmcnt(0)
  v_mfma_f32_32x32x16_bf16 v[80:95], v[156:159], v[220:223], v[80:95]
  v_mfma_f32_32x32x16_bf16 v[64:79], v[152:155], v[220:223], v[64:79]
parallel_sum__linear_kernel_hedgehog__glu_gated_glu__prompt_kernel_tail:
  v_and_b32 v12, 15, v1
  v_lshrrev_b32 v13, 5, v1
  v_xor_b32 v12, v12, v13
  v_lshlrev_b32 v12, 4, v12
  v_and_b32 v13, 7, v1
  v_lshl_add_u32 v12, v13, 8, v12
  v_bfe_u32 v14, v1, 3, 2
  v_lshl_add_u32 v12, v14, 13, v12
  v_add_u32 v96, s6, v12
  v_xor_b32 v97, 32, v96
  v_xor_b32 v98, 64, v96
  v_xor_b32 v99, 96, v96
  v_xor_b32 v100, 128, v96
  v_xor_b32 v101, 160, v96
  v_xor_b32 v102, 192, v96
  v_xor_b32 v103, 224, v96
  ds_write_b128 v96, v[32:35] offset:0
  ds_write_b128 v97, v[36:39] offset:0
  ds_write_b128 v98, v[40:43] offset:0
  ds_write_b128 v99, v[44:47] offset:0
  ds_write_b128 v100, v[48:51] offset:0
  ds_write_b128 v101, v[52:55] offset:0
  ds_write_b128 v102, v[56:59] offset:0
  ds_write_b128 v103, v[60:63] offset:0
  ds_write_b128 v96, v[64:67] offset:32768
  ds_write_b128 v97, v[68:71] offset:32768
  ds_write_b128 v98, v[72:75] offset:32768
  ds_write_b128 v99, v[76:79] offset:32768
  ds_write_b128 v100, v[80:83] offset:32768
  ds_write_b128 v101, v[84:87] offset:32768
  ds_write_b128 v102, v[88:91] offset:32768
  ds_write_b128 v103, v[92:95] offset:32768
  v_lshrrev_b32 v12, 3, v1
  s_lshl_b32 s64, s23, 3
  v_or_b32 v14, s64, v12
  v_lshlrev_b32 v13, 1, v13
  v_xor_b32 v13, v13, v14
  v_lshlrev_b32 v13, 4, v13
  v_lshl_add_u32 v12, v12, 8, v13
  s_lshl_b32 s64, s20, 13
  v_add_u32 v12, s64, v12
  v_xor_b32 v13, 16, v12
  v_add_u32 v14, 65792, v12
  v_add_u32 v15, 65792, v13
  s_waitcnt lgkmcnt(0)
  s_barrier
  ds_read_b128 v[192:195], v12 offset:0
  ds_read_b128 v[196:199], v13 offset:0
  ds_read_b128 v[200:203], v12 offset:2048
  ds_read_b128 v[204:207], v13 offset:2048
  ds_read_b128 v[208:211], v12 offset:4096
  ds_read_b128 v[212:215], v13 offset:4096
  ds_read_b128 v[216:219], v12 offset:6144
  ds_read_b128 v[220:223], v13 offset:6144
  ds_read_b128 v[224:227], v14 offset:0
  ds_read_b128 v[228:231], v15 offset:0
  ds_read_b128 v[232:235], v14 offset:2048
  ds_read_b128 v[236:239], v15 offset:2048
  ds_read_b128 v[240:243], v14 offset:4096
  ds_read_b128 v[244:247], v15 offset:4096
  ds_read_b128 v[248:251], v14 offset:6144
  ds_read_b128 v[252:255], v15 offset:6144
  v_lshlrev_b32 v32, 16, v8
  v_and_b32 v33, 0xffff0000, v8
  v_lshlrev_b32 v34, 16, v9
  v_and_b32 v35, 0xffff0000, v9
  v_lshlrev_b32 v36, 16, v10
  v_and_b32 v37, 0xffff0000, v10
  v_lshlrev_b32 v38, 16, v11
  v_and_b32 v39, 0xffff0000, v11
  s_waitcnt lgkmcnt(15)
  v_add_f32 v32, v32, v192
  v_add_f32 v33, v33, v193
  v_add_f32 v34, v34, v194
  v_add_f32 v35, v35, v195
  s_waitcnt lgkmcnt(14)
  v_add_f32 v36, v36, v196
  v_add_f32 v37, v37, v197
  v_add_f32 v38, v38, v198
  v_add_f32 v39, v39, v199
  s_waitcnt lgkmcnt(13)
  v_add_f32 v32, v32, v200
  v_add_f32 v33, v33, v201
  v_add_f32 v34, v34, v202
  v_add_f32 v35, v35, v203
  s_waitcnt lgkmcnt(12)
  v_add_f32 v36, v36, v204
  v_add_f32 v37, v37, v205
  v_add_f32 v38, v38, v206
  v_add_f32 v39, v39, v207
  s_waitcnt lgkmcnt(11)
  v_add_f32 v32, v32, v208
  v_add_f32 v33, v33, v209
  v_add_f32 v34, v34, v210
  v_add_f32 v35, v35, v211
  s_waitcnt lgkmcnt(10)
  v_add_f32 v36, v36, v212
  v_add_f32 v37, v37, v213
  v_add_f32 v38, v38, v214
  v_add_f32 v39, v39, v215
  s_waitcnt lgkmcnt(9)
  v_add_f32 v32, v32, v216
  v_add_f32 v33, v33, v217
  v_add_f32 v34, v34, v218
  v_add_f32 v35, v35, v219
  s_waitcnt lgkmcnt(8)
  v_add_f32 v36, v36, v220
  v_add_f32 v37, v37, v221
  v_add_f32 v38, v38, v222
  v_add_f32 v39, v39, v223
  s_waitcnt lgkmcnt(7)
  v_add_f32 v32, v32, v224
  v_add_f32 v33, v33, v225
  v_add_f32 v34, v34, v226
  v_add_f32 v35, v35, v227
  s_waitcnt lgkmcnt(6)
  v_add_f32 v36, v36, v228
  v_add_f32 v37, v37, v229
  v_add_f32 v38, v38, v230
  v_add_f32 v39, v39, v231
  s_waitcnt lgkmcnt(5)
  v_add_f32 v32, v32, v232
  v_add_f32 v33, v33, v233
  v_add_f32 v34, v34, v234
  v_add_f32 v35, v35, v235
  s_waitcnt lgkmcnt(4)
  v_add_f32 v36, v36, v236
  v_add_f32 v37, v37, v237
  v_add_f32 v38, v38, v238
  v_add_f32 v39, v39, v239
  s_waitcnt lgkmcnt(3)
  v_add_f32 v32, v32, v240
  v_add_f32 v33, v33, v241
  v_add_f32 v34, v34, v242
  v_add_f32 v35, v35, v243
  s_waitcnt lgkmcnt(2)
  v_add_f32 v36, v36, v244
  v_add_f32 v37, v37, v245
  v_add_f32 v38, v38, v246
  v_add_f32 v39, v39, v247
  s_waitcnt lgkmcnt(1)
  v_add_f32 v32, v32, v248
  v_add_f32 v33, v33, v249
  v_add_f32 v34, v34, v250
  v_add_f32 v35, v35, v251
  s_waitcnt lgkmcnt(0)
  v_add_f32 v36, v36, v252
  v_add_f32 v37, v37, v253
  v_add_f32 v38, v38, v254
  v_add_f32 v39, v39, v255
  v_cvt_pk_bf16_f32 v40, v32, v33
  v_cvt_pk_bf16_f32 v41, v34, v35
  v_cvt_pk_bf16_f32 v42, v36, v37
  v_cvt_pk_bf16_f32 v43, v38, v39
  buffer_store_dwordx4 v[40:43], v6, s[60:63], 0 offen
  s_or_b32 s64, s2, s20
  s_cbranch_scc1 parallel_sum__linear_kernel_hedgehog__glu_gated_glu__prompt_kernel_nb
  s_mov_b32 s65, 0
  v_mov_b32 v14, s12
  s_add_u32 s64, s65, 0xaf0000
  s_mov_b64 exec, 1
  buffer_store_dword v14, off, s[28:31], s64 sc1
  s_mov_b64 exec, -1
parallel_sum__linear_kernel_hedgehog__glu_gated_glu__prompt_kernel_nb:
parallel_sum__linear_kernel_hedgehog__glu_gated_glu__prompt_kernel_end:
  s_endpgm
pb55:
  s_mov_b32 s14, 0x40000
pb55l:
  buffer_load_dword v15, v7, s[28:31], 0 offen sc1
  s_sub_u32 s14, s14, 1
  s_waitcnt vmcnt(0)
  s_cbranch_scc1 pb55x
  v_subrev_u32 v14, s64, v15
  v_cmp_lt_u32 vcc, 7, v14
  s_nop 1
  s_cbranch_vccnz pb55l
  s_branch pb55x
lw56:
  s_mov_b32 s14, 0x40000
lw56l:
  ds_read_b32 v14, v17 offset:1024
  s_sub_u32 s14, s14, 1
  s_waitcnt lgkmcnt(0)
  s_cbranch_scc1 lw56x
  v_cmp_gt_u32 vcc, 5, v14
  s_nop 1
  s_cbranch_vccnz lw56l
  s_branch lw56x
sf57:
  s_mov_b32 s14, 0x40000
sf57l:
  s_load_dword s36, s[70:71], s3 offset:0 glc
  s_load_dword s37, s[70:71], s3 offset:128 glc
  s_load_dword s38, s[70:71], s3 offset:256 glc
  s_load_dword s39, s[70:71], s3 offset:384 glc
  s_load_dword s40, s[70:71], s3 offset:512 glc
  s_load_dword s41, s[70:71], s3 offset:640 glc
  s_load_dword s42, s[70:71], s3 offset:768 glc
  s_load_dword s43, s[70:71], s3 offset:896 glc
  s_load_dword s56, s[70:71], s3 offset:1024 glc
  s_load_dword s57, s[70:71], s3 offset:1152 glc
  s_load_dword s58, s[70:71], s3 offset:1280 glc
  s_load_dword s59, s[70:71], s3 offset:1408 glc
  s_load_dword s0, s[70:71], s3 offset:1536 glc
  s_load_dword s1, s[70:71], s3 offset:1664 glc
  s_load_dword s18, s[70:71], s3 offset:1792 glc
  s_load_dword s19, s[70:71], s3 offset:1920 glc
  s_sub_u32 s14, s14, 1
  s_waitcnt lgkmcnt(0)
  s_cbranch_scc1 sf57x
  s_xor_b64 s[36:37], s[36:37], s[100:101]
  s_xor_b64 s[38:39], s[38:39], s[100:101]
  s_xor_b64 s[40:41], s[40:41], s[100:101]
  s_xor_b64 s[42:43], s[42:43], s[100:101]
  s_xor_b64 s[56:57], s[56:57], s[100:101]
  s_xor_b64 s[58:59], s[58:59], s[100:101]
  s_xor_b64 s[0:1], s[0:1], s[100:101]
  s_xor_b64 s[18:19], s[18:19], s[100:101]
  s_or_b64 s[36:37], s[36:37], s[38:39]
  s_or_b64 s[36:37], s[36:37], s[40:41]
  s_or_b64 s[36:37], s[36:37], s[42:43]
  s_or_b64 s[36:37], s[36:37], s[56:57]
  s_or_b64 s[36:37], s[36:37], s[58:59]
  s_or_b64 s[36:37], s[36:37], s[0:1]
  s_or_b64 s[36:37], s[36:37], s[18:19]
  s_cbranch_scc1 sf57l
  s_branch sf57x
vf58:
  s_mov_b32 s14, 0x40000
  s_nop 7
  s_nop 7
vf58l:
  buffer_load_dwordx4 v[80:83], v24, s[28:31], s9 offen sc1
  s_sub_u32 s14, s14, 1
  s_waitcnt vmcnt(0)
  s_cbranch_scc1 vf58r
  v_max3_u32 v12, v80, v81, v82
  v_max_u32 v12, v12, v83
  v_cmp_eq_u32 vcc, -1, v12
  s_nop 1
  s_cbranch_vccnz vf58l
vf58r:
  buffer_load_dwordx2 v[254:255], v24, s[28:31], s8 offen offset:0 sc1
  buffer_load_dwordx2 v[192:193], v24, s[28:31], s8 offen offset:8 sc1
  buffer_load_dwordx4 v[194:197], v24, s[28:31], s8 offen offset:2048 sc1
  s_add_u32 s64, s8, 4096
  buffer_load_dwordx4 v[198:201], v24, s[28:31], s64 offen offset:0 sc1
  buffer_load_dwordx4 v[202:205], v24, s[28:31], s64 offen offset:2048 sc1
  s_add_u32 s64, s8, 8192
  buffer_load_dwordx4 v[206:209], v24, s[28:31], s64 offen offset:0 sc1
  buffer_load_dwordx4 v[210:213], v24, s[28:31], s64 offen offset:2048 sc1
  s_add_u32 s64, s8, 12288
  buffer_load_dwordx4 v[214:217], v24, s[28:31], s64 offen offset:0 sc1
  buffer_load_dwordx4 v[218:221], v24, s[28:31], s64 offen offset:2048 sc1
  s_add_u32 s64, s8, 16384
  buffer_load_dwordx4 v[222:225], v24, s[28:31], s64 offen offset:0 sc1
  buffer_load_dwordx4 v[226:229], v24, s[28:31], s64 offen offset:2048 sc1
  s_add_u32 s64, s8, 20480
  buffer_load_dwordx4 v[230:233], v24, s[28:31], s64 offen offset:0 sc1
  buffer_load_dwordx4 v[234:237], v24, s[28:31], s64 offen offset:2048 sc1
  s_add_u32 s64, s8, 24576
  buffer_load_dwordx4 v[238:241], v24, s[28:31], s64 offen offset:0 sc1
  buffer_load_dwordx4 v[242:245], v24, s[28:31], s64 offen offset:2048 sc1
  s_add_u32 s64, s8, 28672
  buffer_load_dwordx4 v[246:249], v24, s[28:31], s64 offen offset:0 sc1
  buffer_load_dwordx4 v[250:253], v24, s[28:31], s64 offen offset:2048 sc1
  s_nop 7
  s_nop 7
  s_branch vf58x
vf59:
  s_mov_b32 s14, 0x40000
  s_nop 7
  s_nop 7
vf59l:
  buffer_load_dwordx2 v[254:255], v24, s[28:31], s8 offen offset:0 sc1
  buffer_load_dwordx2 v[192:193], v24, s[28:31], s8 offen offset:8 sc1
  buffer_load_dwordx4 v[194:197], v24, s[28:31], s8 offen offset:2048 sc1
  s_add_u32 s64, s8, 4096
  buffer_load_dwordx4 v[198:201], v24, s[28:31], s64 offen offset:0 sc1
  buffer_load_dwordx4 v[202:205], v24, s[28:31], s64 offen offset:2048 sc1
  s_add_u32 s64, s8, 8192
  buffer_load_dwordx4 v[206:209], v24, s[28:31], s64 offen offset:0 sc1
  buffer_load_dwordx4 v[210:213], v24, s[28:31], s64 offen offset:2048 sc1
  s_add_u32 s64, s8, 12288
  buffer_load_dwordx4 v[214:217], v24, s[28:31], s64 offen offset:0 sc1
  buffer_load_dwordx4 v[218:221], v24, s[28:31], s64 offen offset:2048 sc1
  s_add_u32 s64, s8, 16384
  buffer_load_dwordx4 v[222:225], v24, s[28:31], s64 offen offset:0 sc1
  buffer_load_dwordx4 v[226:229], v24, s[28:31], s64 offen offset:2048 sc1
  s_add_u32 s64, s8, 20480
  buffer_load_dwordx4 v[230:233], v24, s[28:31], s64 offen offset:0 sc1
  buffer_load_dwordx4 v[234:237], v24, s[28:31], s64 offen offset:2048 sc1
  s_add_u32 s64, s8, 24576
  buffer_load_dwordx4 v[238:241], v24, s[28:31], s64 offen offset:0 sc1
  buffer_load_dwordx4 v[242:245], v24, s[28:31], s64 offen offset:2048 sc1
  s_add_u32 s64, s8, 28672
  buffer_load_dwordx4 v[246:249], v24, s[28:31], s64 offen offset:0 sc1
  buffer_load_dwordx4 v[250:253], v24, s[28:31], s64 offen offset:2048 sc1
  s_sub_u32 s14, s14, 1
  s_waitcnt vmcnt(0)
  s_cbranch_scc1 vf59r
  v_max3_u32 v12, v192, v193, v194
  v_max3_u32 v13, v195, v196, v197
  v_max3_u32 v12, v12, v198, v199
  v_max3_u32 v13, v13, v200, v201
  v_max3_u32 v12, v12, v202, v203
  v_max3_u32 v13, v13, v204, v205
  v_max3_u32 v12, v12, v206, v207
  v_max3_u32 v13, v13, v208, v209
  v_max3_u32 v12, v12, v210, v211
  v_max3_u32 v13, v13, v212, v213
  v_max3_u32 v12, v12, v214, v215
  v_max3_u32 v13, v13, v216, v217
  v_max3_u32 v12, v12, v218, v219
  v_max3_u32 v13, v13, v220, v221
  v_max3_u32 v12, v12, v222, v223
  v_max3_u32 v13, v13, v224, v225
  v_max3_u32 v12, v12, v226, v227
  v_max3_u32 v13, v13, v228, v229
  v_max3_u32 v12, v12, v230, v231
  v_max3_u32 v13, v13, v232, v233
  v_max3_u32 v12, v12, v234, v235
  v_max3_u32 v13, v13, v236, v237
  v_max3_u32 v12, v12, v238, v239
  v_max3_u32 v13, v13, v240, v241
  v_max3_u32 v12, v12, v242, v243
  v_max3_u32 v13, v13, v244, v245
  v_max3_u32 v12, v12, v246, v247
  v_max3_u32 v13, v13, v248, v249
  v_max3_u32 v12, v12, v250, v251
  v_max3_u32 v13, v13, v252, v253
  v_max3_u32 v12, v12, v254, v255
  v_max_u32 v12, v12, v13
  v_cmp_eq_u32 vcc, -1, v12
  s_nop 1
  s_cbranch_vccnz vf59l
vf59r:
  v_mfma_f32_16x16x32_bf16 v[68:71], v[28:31], v[192:195], 0
  v_mfma_f32_16x16x32_bf16 v[64:67], v[28:31], v[196:199], 0
  v_mfma_f32_16x16x32_bf16 v[68:71], v[28:31], v[200:203], v[68:71]
  v_mfma_f32_16x16x32_bf16 v[64:67], v[28:31], v[204:207], v[64:67]
  v_mfma_f32_16x16x32_bf16 v[68:71], v[28:31], v[208:211], v[68:71]
  v_mfma_f32_16x16x32_bf16 v[64:67], v[28:31], v[212:215], v[64:67]
  v_mfma_f32_16x16x32_bf16 v[68:71], v[28:31], v[216:219], v[68:71]
  v_mfma_f32_16x16x32_bf16 v[64:67], v[28:31], v[220:223], v[64:67]
  v_mfma_f32_16x16x32_bf16 v[68:71], v[28:31], v[224:227], v[68:71]
  v_mfma_f32_16x16x32_bf16 v[64:67], v[28:31], v[228:231], v[64:67]
  v_mfma_f32_16x16x32_bf16 v[68:71], v[28:31], v[232:235], v[68:71]
  v_mfma_f32_16x16x32_bf16 v[64:67], v[28:31], v[236:239], v[64:67]
  v_mfma_f32_16x16x32_bf16 v[68:71], v[28:31], v[240:243], v[68:71]
  v_mfma_f32_16x16x32_bf16 v[64:67], v[28:31], v[244:247], v[64:67]
  v_mfma_f32_16x16x32_bf16 v[68:71], v[28:31], v[248:251], v[68:71]
  v_mfma_f32_16x16x32_bf16 v[64:67], v[28:31], v[252:255], v[64:67]
  s_nop 7
  s_nop 7
  s_branch vf59x
lw60:
  s_mov_b32 s14, 0x40000
lw60l:
  ds_read_b32 v14, v17 offset:1024
  s_sub_u32 s14, s14, 1
  s_waitcnt lgkmcnt(0)
  s_cbranch_scc1 lw60x
  v_cmp_gt_u32 vcc, 5, v14
  s_nop 1
  s_cbranch_vccnz lw60l
  s_branch lw60x
lw61:
  s_mov_b32 s14, 0x40000
lw61l:
  ds_read_b32 v14, v17 offset:2048
  s_sub_u32 s14, s14, 1
  s_waitcnt lgkmcnt(0)
  s_cbranch_scc1 lw61x
  v_cmp_gt_u32 vcc, 3, v14
  s_nop 1
  s_cbranch_vccnz lw61l
  s_branch lw61x
sf62:
  s_waitcnt vmcnt(0)
  s_mov_b64 exec, 1
  buffer_store_dword v24, off, s[28:31], s69 offset:2048 sc1
  s_mov_b64 exec, -1
  s_mov_b32 s14, 0x40000
sf62l:
  s_load_dword s36, s[70:71], s68 offset:0 glc
  s_load_dword s37, s[70:71], s68 offset:128 glc
  s_load_dword s38, s[70:71], s68 offset:256 glc
  s_load_dword s39, s[70:71], s68 offset:384 glc
  s_load_dword s40, s[70:71], s68 offset:512 glc
  s_load_dword s41, s[70:71], s68 offset:640 glc
  s_load_dword s42, s[70:71], s68 offset:768 glc
  s_load_dword s43, s[70:71], s68 offset:896 glc
  s_sub_u32 s14, s14, 1
  s_waitcnt lgkmcnt(0)
  s_cbranch_scc1 sf62x
  s_xor_b64 s[36:37], s[36:37], s[100:101]
  s_xor_b64 s[38:39], s[38:39], s[100:101]
  s_xor_b64 s[40:41], s[40:41], s[100:101]
  s_xor_b64 s[42:43], s[42:43], s[100:101]
  s_or_b64 s[36:37], s[36:37], s[38:39]
  s_or_b64 s[36:37], s[36:37], s[40:41]
  s_or_b64 s[36:37], s[36:37], s[42:43]
  s_cbranch_scc1 sf62l
  s_branch sf62x
sf63:
  s_mov_b32 s14, 0x40000
sf63l:
  s_load_dword s36, s[70:71], s68 offset:2048 glc
  s_load_dword s37, s[70:71], s68 offset:2176 glc
  s_load_dword s38, s[70:71], s68 offset:2304 glc
  s_load_dword s39, s[70:71], s68 offset:2432 glc
  s_sub_u32 s14, s14, 1
  s_waitcnt lgkmcnt(0)
  s_cbranch_scc1 sf63x
  s_xor_b64 s[36:37], s[36:37], s[100:101]
  s_xor_b64 s[38:39], s[38:39], s[100:101]
  s_or_b64 s[36:37], s[36:37], s[38:39]
  s_cbranch_scc1 sf63l
  s_branch sf63x
.p2align 8
.fill 64, 4, 0xBF810000
.section .rodata,"a"
.p2align 6
.amdhsa_kernel parallel_sum__linear_kernel_hedgehog__glu_gated_glu__prompt_kernel
  .amdhsa_next_free_vgpr 256
  .amdhsa_next_free_sgpr 102
  .amdhsa_accum_offset 256
  .amdhsa_group_segment_fixed_size 0
  .amdhsa_kernarg_size 88
  .amdhsa_user_sgpr_count 2
  .amdhsa_user_sgpr_kernarg_segment_ptr 1
  .amdhsa_system_sgpr_workgroup_id_x 1
.end_amdhsa_kernel
```
